```python
import torch

def _softmax(x, axis=-1):
    return torch.softmax(x, dim=axis)
def _gelu(x):
    return torch.nn.functional.gelu(x, approximate="tanh")
def _silu(x):
    return torch.nn.functional.silu(x)
def _sigmoid(x):
    return torch.sigmoid(x)
def _layernorm(x, axis=-1, eps=1e-5):
    m = x.mean(dim=axis, keepdim=True)
    v = x.var(dim=axis, keepdim=True, unbiased=False)
    return (x - m) / torch.sqrt(v + eps)
def _scatter_add(tgt, idx, src, axis=0):
    return tgt.clone().index_add_(axis, idx, src)
def _segment_sum(src, seg, n):
    out = torch.zeros((n,) + src.shape[1:], dtype=src.dtype)
    return out.index_add_(0, seg, src)
def _pad(x, pw):
    flat = tuple(v for pair in reversed(pw) for v in pair)
    return torch.nn.functional.pad(x, flat)

kernel_name = 'concat_heads__mha_block__linear_attn_block__prompt'

def setup_inputs():

    _w = (lambda a: (lambda t: t.to(torch.bfloat16) if t.is_floating_point() else t)(torch.as_tensor(a)))
    def _A_setup():
        B, S, D, H = 1, 2048, 1024, 32
        return {
            "x": _w((lambda *s: torch.randn(*s, dtype=torch.bfloat16) * 0.2)(B, S, D)),
            "wqkv": _w((lambda *s: torch.randn(*s, dtype=torch.bfloat16) * 0.2)(D, 3 * D)),
            "wo": _w((lambda *s: torch.randn(*s, dtype=torch.bfloat16) * 0.05)(D, D)),
        }
    _A_in = _A_setup()

    def _B_setup():
        B, S, D = 1, 2048, 1024
        return {
            "x": _w((lambda *s: torch.randn(*s, dtype=torch.bfloat16) * 0.05)(B, S, D)),
            "wqkv": _w((lambda *s: torch.randn(*s, dtype=torch.bfloat16) * 1.6)(D, 3 * D)),
            "wo": _w((lambda *s: torch.randn(*s, dtype=torch.bfloat16) * 0.1)(D, D)),
        }
    _B_in = _B_setup()

    return {
        "A_x": _A_in["x"],
        "A_wqkv": _A_in["wqkv"],
        "A_wo": _A_in["wo"],
        "B_x": _B_in["x"],
        "B_wqkv": _B_in["wqkv"],
        "B_wo": _B_in["wo"],
    }

def reference(A_x, A_wqkv, A_wo, B_x, B_wqkv, B_wo):
    def _A_ref(x, wqkv, wo):
        B, S, D = x.shape
        H = 32
        Dh = D // H
        qkv = (lambda x, *d: x.permute(*d))((x @ wqkv).reshape(B, S, 3, H, Dh), 2, 0, 3, 1, 4)
        q, k, v = qkv[0], qkv[1], qkv[2]
        scores = torch.einsum("bhqd,bhkd->bhqk", q, k) * (Dh ** -0.5)
        p = _softmax(scores, axis=-1)
        o = torch.einsum("bhqk,bhkd->bhqd", p, v)
        return (lambda x, *d: x.permute(*d))(o, 0, 2, 1, 3).reshape(B, S, D) @ wo

    def _B_ref(x, wqkv, wo):
        B, S, D = x.shape
        H = 32; Dh = D // H
        qkv = (lambda x, *d: x.permute(*d))((x @ wqkv).reshape(B, S, 3, H, Dh), 2, 0, 3, 1, 4)
        q, k, v = qkv[0], qkv[1], qkv[2]
        phi = lambda t: torch.where(t > 0, t + 1, torch.exp(t)) + 1e-6
        pq, pk = phi(q), phi(k)
        kv = torch.einsum("bhsd,bhse->bhde", pk, v)
        z = torch.einsum("bhsd->bhd", pk)
        num = torch.einsum("bhqd,bhde->bhqe", pq, kv)
        den = torch.einsum("bhqd,bhd->bhq", pq, z)[..., None] + 1e-6
        o = num / den
        return (lambda x, *d: x.permute(*d))(o, 0, 2, 1, 3).reshape(B, S, D) @ wo

    a = _A_ref(A_x, A_wqkv, A_wo)
    b = _B_ref(B_x, B_wqkv, B_wo)
    return torch.concatenate([a, b], axis=-1)
```

```asm
; @launch kernel=qkv_kernel grid=(256,1,1) block=(256,1,1) lds=159744
; @launch kernel=attn_kernel grid=(256,1,1) block=(512,1,1) lds=135232
; @launch kernel=oproj_kernel grid=(256,1,1) block=(256,1,1) lds=163840
.amdgcn_target "amdgcn-amd-amdhsa--gfx950"
.text
.globl qkv_kernel
.p2align 8
.type qkv_kernel,@function
qkv_kernel:

    s_cmp_ge_u32 s2, 256
    s_cbranch_scc1 L_qkv_kernel_end

    s_load_dwordx4 s[20:23], s[0:1], 0
    s_load_dwordx4 s[24:27], s[0:1], 24
    s_load_dwordx2 s[12:13], s[0:1], 64
    v_lshrrev_b32 v1, 6, v0
    v_and_b32 v0, 63, v0
    s_and_b32 s28, s2, 7
    s_lshr_b32 s29, s2, 3
    v_readfirstlane_b32 s16, v1
    s_lshr_b32 s19, s28, 2
    s_xor_b32 s19, s19, 1
    s_bfe_u32 s17, s28, 0x10001
    s_lshl_b32 s17, s17, 2
    s_and_b32 s30, s29, 3
    s_add_u32 s17, s17, s30
    s_and_b32 s18, s28, 1
    s_lshl_b32 s18, s18, 3
    s_lshr_b32 s30, s29, 2
    s_add_u32 s18, s18, s30

    s_getpc_b64 s[62:63]
    L_qkv_kernel_pc:
    s_lshr_b32 s29, s2, 3
    s_lshl_b32 s29, s29, 2
    s_add_u32 s29, s29, s16
    s_lshl_b32 s29, s29, 2
    v_add_u32 v31, s29, v0
    v_lshlrev_b32 v31, 7, v31
    v_mov_b32 v30, L_code_end-L_qkv_kernel_pc-4
    v_min_u32 v31, v31, v30
    s_mov_b64 exec, 15
    global_load_dword v31, v31, s[62:63]
    s_mov_b64 exec, -1

    v_lshrrev_b32 v1, 3, v0
    s_lshl_b32 s28, s17, 8
    s_lshl_b32 s29, s16, 6
    s_add_u32 s28, s28, s29
    v_add_u32 v1, s28, v1
    v_lshlrev_b32 v1, 11, v1
    v_lshrrev_b32 v18, 4, v0
    v_and_b32 v19, 7, v0
    v_xor_b32 v20, v18, v19
    v_xor_b32 v21, 4, v20
    v_lshl_add_u32 v2, v20, 4, v1
    v_lshl_add_u32 v3, v21, 4, v1
    v_add_u32 v4, 30720, v2
    v_add_u32 v5, 46080, v3
    v_add_u32 v3, 15360, v3

    v_lshrrev_b32 v1, 5, v0
    v_lshlrev_b32 v1, 2, v1
    v_bfe_u32 v18, v0, 2, 2
    v_add_u32 v1, v1, v18
    v_mul_u32_u24 v1, 6144, v1
    v_bfe_u32 v18, v0, 4, 1
    v_lshl_add_u32 v1, v18, 6, v1
    v_and_b32 v18, 3, v0
    v_lshlrev_b32 v18, 4, v18
    s_lshl_b32 s28, s18, 7
    s_mul_i32 s29, s16, 3

    s_add_u32 s30, s29, 0
    s_lshr_b32 s31, s30, 2
    s_and_b32 s30, s30, 3
    s_and_b32 s32, s30, 1
    s_lshl_b32 s32, s32, 5
    s_mul_i32 s30, s30, 49152
    s_lshl_b32 s31, s31, 11
    s_add_u32 s30, s30, s31
    s_add_u32 s30, s30, s28
    s_sub_u32 s30, s30, 0
    v_xor_b32 v19, s32, v18
    v_add3_u32 v6, s30, v1, v19

    s_add_u32 s30, s29, 1
    s_lshr_b32 s31, s30, 2
    s_and_b32 s30, s30, 3
    s_and_b32 s32, s30, 1
    s_lshl_b32 s32, s32, 5
    s_mul_i32 s30, s30, 49152
    s_lshl_b32 s31, s31, 11
    s_add_u32 s30, s30, s31
    s_add_u32 s30, s30, s28
    s_sub_u32 s30, s30, 1024
    v_xor_b32 v19, s32, v18
    v_add3_u32 v7, s30, v1, v19

    s_add_u32 s30, s29, 2
    s_lshr_b32 s31, s30, 2
    s_and_b32 s30, s30, 3
    s_and_b32 s32, s30, 1
    s_lshl_b32 s32, s32, 5
    s_mul_i32 s30, s30, 49152
    s_lshl_b32 s31, s31, 11
    s_add_u32 s30, s30, s31
    s_add_u32 s30, s30, s28
    s_sub_u32 s30, s30, 2048
    v_xor_b32 v19, s32, v18
    v_add3_u32 v8, s30, v1, v19

    v_and_b32 v1, 15, v0
    s_lshr_b32 s28, s16, 1
    s_lshl_b32 s28, s28, 14
    s_add_u32 s28, s28, 61440
    v_lshlrev_b32 v18, 7, v1
    v_add_u32 v18, s28, v18
    v_bfe_u32 v1, v0, 1, 3
    v_lshrrev_b32 v19, 4, v0
    v_xor_b32 v1, v1, v19
    v_lshl_add_u32 v10, v1, 4, v18
    v_xor_b32 v1, 4, v1
    v_lshl_add_u32 v11, v1, 4, v18
    s_and_b32 s28, s16, 1
    s_lshl_b32 s28, s28, 8
    s_add_u32 s28, s28, 0
    v_lshlrev_b32 v18, 10, v19
    v_add_u32 v18, s28, v18
    v_bfe_u32 v1, v0, 2, 2
    v_lshl_add_u32 v18, v1, 6, v18
    v_and_b32 v1, 3, v0
    v_lshl_add_u32 v18, v1, 3, v18
    v_bfe_u32 v1, v0, 4, 1
    v_lshl_add_u32 v14, v1, 5, v18
    v_xor_b32 v15, 32, v14
    s_lshl_b32 s30, s16, 13
    s_add_u32 s30, s30, 61440
    s_mul_i32 s31, s16, 3072
    s_add_u32 s31, s31, 0
    s_waitcnt lgkmcnt(0)

    s_cmp_eq_u32 s19, 0
    s_cselect_b32 s4, s20, s24
    s_cselect_b32 s5, s21, s25
    s_cselect_b32 s8, s22, s26
    s_cselect_b32 s9, s23, s27
    s_mov_b32 s6, 4194304
    s_mov_b32 s7, 0x20000
    s_mov_b32 s10, 6291456
    s_mov_b32 s11, 0x20000
    s_mov_b32 s14, 29360128
    s_mov_b32 s15, 0x20000
    s_mov_b32 s22, s30
    s_mov_b32 s23, s31
    s_mul_i32 s33, s17, 1
    s_mul_i32 s28, s18, 1
    s_add_u32 s33, s33, s28
    s_and_b32 s33, s33, 0
    s_and_b32 s28, s2, 7
    s_lshl_b32 s28, s28, 2
    s_lshr_b32 s28, 0xce8a0246, s28
    s_add_u32 s33, s33, s28
    s_and_b32 s33, s33, 15
    s_lshl_b32 s20, s33, 7
    s_mul_i32 s21, s33, 393216
    s_mov_b32 s34, s20
    s_add_u32 s38, s20, 65536
    s_mov_b32 s35, s21
    s_mov_b32 s36, 16
    s_mov_b32 s37, 32
    s_mov_b32 s24, 0
    s_mov_b32 s25, 0
    s_mov_b32 s26, 0
    s_mov_b32 s27, 0

    s_add_u32 s57, s22, 4096
    s_add_u32 m0, s22, s24
    s_nop 0
    buffer_load_dwordx4 v2, s[4:7], s34 offen offset:0 lds
    buffer_load_dwordx4 v3, s[4:7], s34 offen offset:1024 lds
    buffer_load_dwordx4 v4, s[4:7], s34 offen offset:2048 lds
    buffer_load_dwordx4 v5, s[4:7], s34 offen offset:3072 lds
    s_add_u32 m0, s57, s24
    s_nop 0
    buffer_load_dwordx4 v2, s[4:7], s38 offen offset:0 lds
    s_add_u32 s24, s24, 32768
    s_cmp_ge_u32 s24, 98304
    s_cselect_b32 s24, 0, s24
    buffer_load_dwordx4 v3, s[4:7], s38 offen offset:1024 lds
    s_add_u32 s20, s20, 128
    s_and_b32 s20, s20, 2047
    s_sub_u32 s36, s36, 1
    buffer_load_dwordx4 v4, s[4:7], s38 offen offset:2048 lds
    s_cmp_gt_i32 s36, 0
    s_cselect_b32 s34, s20, 0x40000000
    buffer_load_dwordx4 v5, s[4:7], s38 offen offset:3072 lds
    s_add_u32 s38, s34, 65536
    s_add_u32 m0, s23, s25
    s_nop 0
    buffer_load_dwordx4 v6, s[8:11], s35 offen offset:0 lds
    s_add_u32 s25, s25, 12288
    s_cmp_ge_u32 s25, 61440
    s_cselect_b32 s25, 0, s25
    buffer_load_dwordx4 v7, s[8:11], s35 offen offset:1024 lds
    s_add_u32 s21, s21, 196608
    s_cmp_ge_u32 s21, 6291456
    s_cselect_b32 s21, 0, s21
    s_sub_u32 s37, s37, 1
    buffer_load_dwordx4 v8, s[8:11], s35 offen offset:2048 lds
    s_cmp_gt_i32 s37, 0
    s_cselect_b32 s35, s21, 0x40000000
    s_add_u32 m0, s23, s25
    s_nop 0
    buffer_load_dwordx4 v6, s[8:11], s35 offen offset:0 lds
    s_add_u32 s25, s25, 12288
    s_cmp_ge_u32 s25, 61440
    s_cselect_b32 s25, 0, s25
    buffer_load_dwordx4 v7, s[8:11], s35 offen offset:1024 lds
    s_add_u32 s21, s21, 196608
    s_cmp_ge_u32 s21, 6291456
    s_cselect_b32 s21, 0, s21
    s_sub_u32 s37, s37, 1
    buffer_load_dwordx4 v8, s[8:11], s35 offen offset:2048 lds
    s_cmp_gt_i32 s37, 0
    s_cselect_b32 s35, s21, 0x40000000
    s_add_u32 m0, s22, s24
    s_nop 0
    buffer_load_dwordx4 v2, s[4:7], s34 offen offset:0 lds
    buffer_load_dwordx4 v3, s[4:7], s34 offen offset:1024 lds
    buffer_load_dwordx4 v4, s[4:7], s34 offen offset:2048 lds
    buffer_load_dwordx4 v5, s[4:7], s34 offen offset:3072 lds
    s_add_u32 m0, s57, s24
    s_nop 0
    buffer_load_dwordx4 v2, s[4:7], s38 offen offset:0 lds
    s_add_u32 s24, s24, 32768
    s_cmp_ge_u32 s24, 98304
    s_cselect_b32 s24, 0, s24
    buffer_load_dwordx4 v3, s[4:7], s38 offen offset:1024 lds
    s_add_u32 s20, s20, 128
    s_and_b32 s20, s20, 2047
    s_sub_u32 s36, s36, 1
    buffer_load_dwordx4 v4, s[4:7], s38 offen offset:2048 lds
    s_cmp_gt_i32 s36, 0
    s_cselect_b32 s34, s20, 0x40000000
    buffer_load_dwordx4 v5, s[4:7], s38 offen offset:3072 lds
    s_add_u32 s38, s34, 65536
    s_add_u32 m0, s23, s25
    s_nop 0
    buffer_load_dwordx4 v6, s[8:11], s35 offen offset:0 lds
    s_add_u32 s25, s25, 12288
    s_cmp_ge_u32 s25, 61440
    s_cselect_b32 s25, 0, s25
    buffer_load_dwordx4 v7, s[8:11], s35 offen offset:1024 lds
    s_add_u32 s21, s21, 196608
    s_cmp_ge_u32 s21, 6291456
    s_cselect_b32 s21, 0, s21
    s_sub_u32 s37, s37, 1
    buffer_load_dwordx4 v8, s[8:11], s35 offen offset:2048 lds
    s_cmp_gt_i32 s37, 0
    s_cselect_b32 s35, s21, 0x40000000
    s_lshr_b32 s28, s2, 3
    s_lshl_b32 s28, s28, 2
    s_add_u32 s28, s28, s16
    v_mul_u32_u24 v26, 43, v0
    v_lshrrev_b32 v26, 7, v26
    v_mul_u32_u24 v27, 3, v26
    v_sub_u32 v27, v0, v27
    v_mul_u32_u24 v26, 6144, v26
    v_lshl_add_u32 v26, v27, 11, v26
    v_lshlrev_b32 v27, 11, v0
    v_mov_b32 v28, 0x40000000
    v_cmp_gt_u32 vcc, 6, v0
    v_cndmask_b32 v26, v28, v26, vcc
    v_cmp_gt_u32 vcc, 8, v0
    v_cndmask_b32 v27, v28, v27, vcc
    s_lshr_b32 s29, s8, 7
    s_sub_u32 s29, 3, s29
    s_and_b32 s29, s29, 7
    s_and_b32 s30, s2, 1
    s_lshl_b32 s30, s30, 3
    s_add_u32 s29, s29, s30
    s_lshl_b32 s29, s29, 7
    s_lshl_b32 s30, s33, 6
    s_lshl_b32 s31, s28, 1
    s_add_u32 s30, s30, s31

    s_add_u32 s31, s30, 128
    s_and_b32 s31, s31, 1023
    s_mul_i32 s31, s31, 6144
    s_add_u32 s64, s31, s29

    s_add_u32 s31, s30, 384
    s_and_b32 s31, s31, 1023
    s_mul_i32 s31, s31, 6144
    s_add_u32 s65, s31, s29

    s_add_u32 s31, s30, 640
    s_and_b32 s31, s31, 1023
    s_mul_i32 s31, s31, 6144
    s_add_u32 s66, s31, s29

    s_add_u32 s31, s30, 896
    s_and_b32 s31, s31, 1023
    s_mul_i32 s31, s31, 6144
    s_add_u32 s67, s31, s29

    s_bfe_u32 s29, s2, 0x10001
    s_lshl_b32 s29, s29, 7
    s_add_u32 s28, s28, s29
    s_lshl_b32 s28, s28, 14
    s_lshr_b32 s29, s4, 7
    s_add_u32 s29, s29, s33
    s_sub_u32 s29, 3, s29
    s_and_b32 s29, s29, 7
    s_add_u32 s29, s29, s33
    s_and_b32 s29, s29, 15
    s_lshl_b32 s29, s29, 7
    s_add_u32 s68, s28, s29
    s_xor_b32 s69, s68, 1024

    buffer_load_dword v28, v26, s[8:11], s64 offen
    buffer_load_dword v28, v27, s[4:7], s68 offen
    v_mov_b32 v12, v10
    v_mov_b32 v13, v11
    v_mov_b32 v16, v14
    v_mov_b32 v17, v15

    s_waitcnt vmcnt(16)
    s_barrier
    ds_read_b128 a[0:3], v12 offset:0
    ds_read_b64_tr_b16 a[32:33], v16 offset:0
    ds_read_b64_tr_b16 a[34:35], v16 offset:512
    ds_read_b64_tr_b16 a[36:37], v17 offset:0
    ds_read_b64_tr_b16 a[38:39], v17 offset:512
    ds_read_b64_tr_b16 a[40:41], v16 offset:4096
    ds_read_b64_tr_b16 a[42:43], v16 offset:4608
    ds_read_b64_tr_b16 a[44:45], v17 offset:4096
    ds_read_b64_tr_b16 a[46:47], v17 offset:4608
    ds_read_b64_tr_b16 a[48:49], v16 offset:8192
    ds_read_b64_tr_b16 a[50:51], v16 offset:8704
    ds_read_b64_tr_b16 a[52:53], v17 offset:8192
    ds_read_b64_tr_b16 a[54:55], v17 offset:8704
    ds_read_b128 a[4:7], v12 offset:2048
    ds_read_b128 a[8:11], v12 offset:4096
    ds_read_b128 a[12:15], v12 offset:6144
    ds_read_b128 a[16:19], v12 offset:8192
    ds_read_b128 a[20:23], v12 offset:10240
    ds_read_b128 a[24:27], v12 offset:12288
    ds_read_b128 a[28:31], v12 offset:14336
    s_add_u32 s27, s27, 12288
    s_cmp_ge_u32 s27, 61440
    s_cselect_b32 s27, 0, s27
    v_add_u32 v16, s27, v14
    v_add_u32 v17, s27, v15
    s_cmp_lg_u32 s19, 0
    s_cbranch_scc1 L_qkv_kernel_B
    s_waitcnt lgkmcnt(15)
    v_mfma_f32_16x16x32_bf16 v[32:35], a[32:35], a[0:3], 0
    s_add_u32 s27, s27, 12288
    s_cmp_ge_u32 s27, 61440
    s_cselect_b32 s27, 0, s27
    v_mfma_f32_16x16x32_bf16 v[36:39], a[36:39], a[0:3], 0
    s_add_u32 s26, s26, 32768
    s_cmp_ge_u32 s26, 98304
    s_cselect_b32 s26, 0, s26
    s_waitcnt lgkmcnt(13)
    v_mfma_f32_16x16x32_bf16 v[40:43], a[40:43], a[0:3], 0
    s_waitcnt lgkmcnt(0)
    s_waitcnt vmcnt(13)
    s_barrier
    v_mfma_f32_16x16x32_bf16 v[44:47], a[44:47], a[0:3], 0
    ds_read_b128 a[56:59], v13 offset:0
    s_add_u32 m0, s23, s25
    v_mfma_f32_16x16x32_bf16 v[48:51], a[0:3], a[48:51], 0
    buffer_load_dwordx4 v6, s[8:11], s35 offen offset:0 lds
    v_mfma_f32_16x16x32_bf16 v[52:55], a[0:3], a[52:55], 0
    ds_read_b64_tr_b16 a[88:89], v16 offset:0
    s_add_u32 s25, s25, 12288
    v_mfma_f32_16x16x32_bf16 v[56:59], a[32:35], a[4:7], 0
    s_cmp_ge_u32 s25, 61440
    s_cselect_b32 s25, 0, s25
    v_mfma_f32_16x16x32_bf16 v[60:63], a[36:39], a[4:7], 0
    ds_read_b64_tr_b16 a[90:91], v16 offset:512
    buffer_load_dwordx4 v7, s[8:11], s35 offen offset:1024 lds
    v_mfma_f32_16x16x32_bf16 v[64:67], a[40:43], a[4:7], 0
    s_add_u32 s21, s21, 196608
    v_mfma_f32_16x16x32_bf16 v[68:71], a[44:47], a[4:7], 0
    ds_read_b64_tr_b16 a[92:93], v17 offset:0
    v_mfma_f32_16x16x32_bf16 v[72:75], a[4:7], a[48:51], 0
    s_cmp_ge_u32 s21, 6291456
    s_cselect_b32 s21, 0, s21
    v_mfma_f32_16x16x32_bf16 v[76:79], a[4:7], a[52:55], 0
    ds_read_b64_tr_b16 a[94:95], v17 offset:512
    s_sub_u32 s37, s37, 1
    v_mfma_f32_16x16x32_bf16 v[80:83], a[32:35], a[8:11], 0
    buffer_load_dwordx4 v8, s[8:11], s35 offen offset:2048 lds
    v_mfma_f32_16x16x32_bf16 v[84:87], a[36:39], a[8:11], 0
    ds_read_b64_tr_b16 a[96:97], v16 offset:4096
    v_mfma_f32_16x16x32_bf16 v[88:91], a[40:43], a[8:11], 0
    s_cmp_gt_i32 s37, 0
    s_cselect_b32 s35, s21, 0x40000000
    v_mfma_f32_16x16x32_bf16 v[92:95], a[44:47], a[8:11], 0
    ds_read_b64_tr_b16 a[98:99], v16 offset:4608
    s_add_u32 m0, s22, s24
    v_mfma_f32_16x16x32_bf16 v[96:99], a[8:11], a[48:51], 0
    buffer_load_dwordx4 v2, s[4:7], s34 offen offset:0 lds
    v_mfma_f32_16x16x32_bf16 v[100:103], a[8:11], a[52:55], 0
    ds_read_b64_tr_b16 a[100:101], v17 offset:4096
    v_mfma_f32_16x16x32_bf16 v[104:107], a[32:35], a[12:15], 0
    buffer_load_dwordx4 v3, s[4:7], s34 offen offset:1024 lds
    v_mfma_f32_16x16x32_bf16 v[108:111], a[36:39], a[12:15], 0
    ds_read_b64_tr_b16 a[102:103], v17 offset:4608
    v_mfma_f32_16x16x32_bf16 v[112:115], a[40:43], a[12:15], 0
    buffer_load_dwordx4 v4, s[4:7], s34 offen offset:2048 lds
    v_mfma_f32_16x16x32_bf16 v[116:119], a[44:47], a[12:15], 0
    ds_read_b64_tr_b16 a[104:105], v16 offset:8192
    v_mfma_f32_16x16x32_bf16 v[120:123], a[12:15], a[48:51], 0
    buffer_load_dwordx4 v5, s[4:7], s34 offen offset:3072 lds
    v_mfma_f32_16x16x32_bf16 v[124:127], a[12:15], a[52:55], 0
    ds_read_b64_tr_b16 a[106:107], v16 offset:8704
    s_add_u32 m0, s57, s24
    v_mfma_f32_16x16x32_bf16 v[128:131], a[32:35], a[16:19], 0
    buffer_load_dwordx4 v2, s[4:7], s38 offen offset:0 lds
    v_mfma_f32_16x16x32_bf16 v[132:135], a[36:39], a[16:19], 0
    ds_read_b64_tr_b16 a[108:109], v17 offset:8192
    s_add_u32 s24, s24, 32768
    v_mfma_f32_16x16x32_bf16 v[136:139], a[40:43], a[16:19], 0
    s_cmp_ge_u32 s24, 98304
    s_cselect_b32 s24, 0, s24
    v_mfma_f32_16x16x32_bf16 v[140:143], a[44:47], a[16:19], 0
    ds_read_b64_tr_b16 a[110:111], v17 offset:8704
    buffer_load_dwordx4 v3, s[4:7], s38 offen offset:1024 lds
    v_mfma_f32_16x16x32_bf16 v[144:147], a[16:19], a[48:51], 0
    s_add_u32 s20, s20, 128
    s_and_b32 s20, s20, 2047
    v_mfma_f32_16x16x32_bf16 v[148:151], a[16:19], a[52:55], 0
    ds_read_b128 a[60:63], v13 offset:2048
    s_sub_u32 s36, s36, 1
    v_mfma_f32_16x16x32_bf16 v[152:155], a[32:35], a[20:23], 0
    buffer_load_dwordx4 v4, s[4:7], s38 offen offset:2048 lds
    v_mfma_f32_16x16x32_bf16 v[156:159], a[36:39], a[20:23], 0
    ds_read_b128 a[64:67], v13 offset:4096
    v_mfma_f32_16x16x32_bf16 v[160:163], a[40:43], a[20:23], 0
    s_cmp_gt_i32 s36, 0
    s_cselect_b32 s34, s20, 0x40000000
    v_mfma_f32_16x16x32_bf16 v[164:167], a[44:47], a[20:23], 0
    ds_read_b128 a[68:71], v13 offset:6144
    buffer_load_dwordx4 v5, s[4:7], s38 offen offset:3072 lds
    v_mfma_f32_16x16x32_bf16 v[168:171], a[20:23], a[48:51], 0
    s_add_u32 s38, s34, 65536
    s_add_u32 m0, s23, s25
    v_mfma_f32_16x16x32_bf16 v[172:175], a[20:23], a[52:55], 0
    ds_read_b128 a[72:75], v13 offset:8192
    buffer_load_dwordx4 v6, s[8:11], s35 offen offset:0 lds
    v_mfma_f32_16x16x32_bf16 v[176:179], a[32:35], a[24:27], 0
    s_add_u32 s25, s25, 12288
    v_mfma_f32_16x16x32_bf16 v[180:183], a[36:39], a[24:27], 0
    ds_read_b128 a[76:79], v13 offset:10240
    v_mfma_f32_16x16x32_bf16 v[184:187], a[40:43], a[24:27], 0
    s_cmp_ge_u32 s25, 61440
    s_cselect_b32 s25, 0, s25
    v_mfma_f32_16x16x32_bf16 v[188:191], a[44:47], a[24:27], 0
    ds_read_b128 a[80:83], v13 offset:12288
    buffer_load_dwordx4 v7, s[8:11], s35 offen offset:1024 lds
    v_mfma_f32_16x16x32_bf16 v[192:195], a[24:27], a[48:51], 0
    s_add_u32 s21, s21, 196608
    v_mfma_f32_16x16x32_bf16 v[196:199], a[24:27], a[52:55], 0
    ds_read_b128 a[84:87], v13 offset:14336
    v_mfma_f32_16x16x32_bf16 v[200:203], a[32:35], a[28:31], 0
    v_add_u32 v16, s27, v14
    v_add_u32 v17, s27, v15
    v_mfma_f32_16x16x32_bf16 v[204:207], a[36:39], a[28:31], 0
    v_add_u32 v12, s26, v10
    v_add_u32 v13, s26, v11
    v_mfma_f32_16x16x32_bf16 v[208:211], a[40:43], a[28:31], 0
    s_cmp_ge_u32 s21, 6291456
    s_cselect_b32 s21, 0, s21
    v_mfma_f32_16x16x32_bf16 v[212:215], a[44:47], a[28:31], 0
    s_sub_u32 s37, s37, 1
    buffer_load_dwordx4 v8, s[8:11], s35 offen offset:2048 lds
    v_mfma_f32_16x16x32_bf16 v[216:219], a[28:31], a[48:51], 0
    s_cmp_gt_i32 s37, 0
    s_cselect_b32 s35, s21, 0x40000000
    v_mfma_f32_16x16x32_bf16 v[220:223], a[28:31], a[52:55], 0
    s_add_u32 m0, s23, s25
    s_nop 0
    buffer_load_dwordx4 v6, s[8:11], s35 offen offset:0 lds
    s_waitcnt lgkmcnt(15)
    v_mfma_f32_16x16x32_bf16 v[32:35], a[88:91], a[56:59], v[32:35]
    s_add_u32 s27, s27, 12288
    s_cmp_ge_u32 s27, 61440
    s_cselect_b32 s27, 0, s27
    v_mfma_f32_16x16x32_bf16 v[36:39], a[92:95], a[56:59], v[36:39]
    s_waitcnt lgkmcnt(13)
    v_mfma_f32_16x16x32_bf16 v[40:43], a[96:99], a[56:59], v[40:43]
    s_waitcnt lgkmcnt(0)
    s_waitcnt vmcnt(17)
    s_barrier
    v_mfma_f32_16x16x32_bf16 v[44:47], a[100:103], a[56:59], v[44:47]
    ds_read_b128 a[0:3], v12 offset:0
    s_add_u32 s25, s25, 12288
    v_mfma_f32_16x16x32_bf16 v[48:51], a[56:59], a[104:107], v[48:51]
    s_cmp_ge_u32 s25, 61440
    s_cselect_b32 s25, 0, s25
    v_mfma_f32_16x16x32_bf16 v[52:55], a[56:59], a[108:111], v[52:55]
    ds_read_b64_tr_b16 a[32:33], v16 offset:0
    buffer_load_dwordx4 v7, s[8:11], s35 offen offset:1024 lds
    v_mfma_f32_16x16x32_bf16 v[56:59], a[88:91], a[60:63], v[56:59]
    s_add_u32 s21, s21, 196608
    v_mfma_f32_16x16x32_bf16 v[60:63], a[92:95], a[60:63], v[60:63]
    ds_read_b64_tr_b16 a[34:35], v16 offset:512
    v_mfma_f32_16x16x32_bf16 v[64:67], a[96:99], a[60:63], v[64:67]
    s_cmp_ge_u32 s21, 6291456
    s_cselect_b32 s21, 0, s21
    v_mfma_f32_16x16x32_bf16 v[68:71], a[100:103], a[60:63], v[68:71]
    ds_read_b64_tr_b16 a[36:37], v17 offset:0
    s_sub_u32 s37, s37, 1
    v_mfma_f32_16x16x32_bf16 v[72:75], a[60:63], a[104:107], v[72:75]
    buffer_load_dwordx4 v8, s[8:11], s35 offen offset:2048 lds
    v_mfma_f32_16x16x32_bf16 v[76:79], a[60:63], a[108:111], v[76:79]
    ds_read_b64_tr_b16 a[38:39], v17 offset:512
    v_mfma_f32_16x16x32_bf16 v[80:83], a[88:91], a[64:67], v[80:83]
    s_cmp_gt_i32 s37, 0
    s_cselect_b32 s35, s21, 0x40000000
    v_mfma_f32_16x16x32_bf16 v[84:87], a[92:95], a[64:67], v[84:87]
    ds_read_b64_tr_b16 a[40:41], v16 offset:4096
    s_add_u32 m0, s23, s25
    v_mfma_f32_16x16x32_bf16 v[88:91], a[96:99], a[64:67], v[88:91]
    buffer_load_dwordx4 v6, s[8:11], s35 offen offset:0 lds
    v_mfma_f32_16x16x32_bf16 v[92:95], a[100:103], a[64:67], v[92:95]
    ds_read_b64_tr_b16 a[42:43], v16 offset:4608
    s_add_u32 s25, s25, 12288
    v_mfma_f32_16x16x32_bf16 v[96:99], a[64:67], a[104:107], v[96:99]
    s_cmp_ge_u32 s25, 61440
    s_cselect_b32 s25, 0, s25
    v_mfma_f32_16x16x32_bf16 v[100:103], a[64:67], a[108:111], v[100:103]
    ds_read_b64_tr_b16 a[44:45], v17 offset:4096
    buffer_load_dwordx4 v7, s[8:11], s35 offen offset:1024 lds
    v_mfma_f32_16x16x32_bf16 v[104:107], a[88:91], a[68:71], v[104:107]
    s_add_u32 s21, s21, 196608
    v_mfma_f32_16x16x32_bf16 v[108:111], a[92:95], a[68:71], v[108:111]
    ds_read_b64_tr_b16 a[46:47], v17 offset:4608
    v_mfma_f32_16x16x32_bf16 v[112:115], a[96:99], a[68:71], v[112:115]
    s_cmp_ge_u32 s21, 6291456
    s_cselect_b32 s21, 0, s21
    v_mfma_f32_16x16x32_bf16 v[116:119], a[100:103], a[68:71], v[116:119]
    ds_read_b64_tr_b16 a[48:49], v16 offset:8192
    s_sub_u32 s37, s37, 1
    v_mfma_f32_16x16x32_bf16 v[120:123], a[68:71], a[104:107], v[120:123]
    buffer_load_dwordx4 v8, s[8:11], s35 offen offset:2048 lds
    v_mfma_f32_16x16x32_bf16 v[124:127], a[68:71], a[108:111], v[124:127]
    ds_read_b64_tr_b16 a[50:51], v16 offset:8704
    v_mfma_f32_16x16x32_bf16 v[128:131], a[88:91], a[72:75], v[128:131]
    s_cmp_gt_i32 s37, 0
    s_cselect_b32 s35, s21, 0x40000000
    v_mfma_f32_16x16x32_bf16 v[132:135], a[92:95], a[72:75], v[132:135]
    ds_read_b64_tr_b16 a[52:53], v17 offset:8192
    s_add_u32 m0, s22, s24
    v_mfma_f32_16x16x32_bf16 v[136:139], a[96:99], a[72:75], v[136:139]
    buffer_load_dwordx4 v2, s[4:7], s34 offen offset:0 lds
    v_mfma_f32_16x16x32_bf16 v[140:143], a[100:103], a[72:75], v[140:143]
    ds_read_b64_tr_b16 a[54:55], v17 offset:8704
    v_mfma_f32_16x16x32_bf16 v[144:147], a[72:75], a[104:107], v[144:147]
    buffer_load_dwordx4 v3, s[4:7], s34 offen offset:1024 lds
    v_mfma_f32_16x16x32_bf16 v[148:151], a[72:75], a[108:111], v[148:151]
    ds_read_b128 a[4:7], v12 offset:2048
    v_mfma_f32_16x16x32_bf16 v[152:155], a[88:91], a[76:79], v[152:155]
    buffer_load_dwordx4 v4, s[4:7], s34 offen offset:2048 lds
    v_mfma_f32_16x16x32_bf16 v[156:159], a[92:95], a[76:79], v[156:159]
    ds_read_b128 a[8:11], v12 offset:4096
    v_mfma_f32_16x16x32_bf16 v[160:163], a[96:99], a[76:79], v[160:163]
    buffer_load_dwordx4 v5, s[4:7], s34 offen offset:3072 lds
    v_mfma_f32_16x16x32_bf16 v[164:167], a[100:103], a[76:79], v[164:167]
    ds_read_b128 a[12:15], v12 offset:6144
    v_mfma_f32_16x16x32_bf16 v[168:171], a[76:79], a[104:107], v[168:171]
    buffer_load_dword v28, v26, s[8:11], s65 offen
    v_mfma_f32_16x16x32_bf16 v[172:175], a[76:79], a[108:111], v[172:175]
    ds_read_b128 a[16:19], v12 offset:8192
    v_mfma_f32_16x16x32_bf16 v[176:179], a[88:91], a[80:83], v[176:179]
    v_mfma_f32_16x16x32_bf16 v[180:183], a[92:95], a[80:83], v[180:183]
    ds_read_b128 a[20:23], v12 offset:10240
    v_mfma_f32_16x16x32_bf16 v[184:187], a[96:99], a[80:83], v[184:187]
    v_mfma_f32_16x16x32_bf16 v[188:191], a[100:103], a[80:83], v[188:191]
    ds_read_b128 a[24:27], v12 offset:12288
    v_mfma_f32_16x16x32_bf16 v[192:195], a[80:83], a[104:107], v[192:195]
    v_mfma_f32_16x16x32_bf16 v[196:199], a[80:83], a[108:111], v[196:199]
    ds_read_b128 a[28:31], v12 offset:14336
    v_mfma_f32_16x16x32_bf16 v[200:203], a[88:91], a[84:87], v[200:203]
    v_add_u32 v16, s27, v14
    v_add_u32 v17, s27, v15
    v_mfma_f32_16x16x32_bf16 v[204:207], a[92:95], a[84:87], v[204:207]
    v_mfma_f32_16x16x32_bf16 v[208:211], a[96:99], a[84:87], v[208:211]
    v_mfma_f32_16x16x32_bf16 v[212:215], a[100:103], a[84:87], v[212:215]
    v_mfma_f32_16x16x32_bf16 v[216:219], a[84:87], a[104:107], v[216:219]
    v_mfma_f32_16x16x32_bf16 v[220:223], a[84:87], a[108:111], v[220:223]
    s_waitcnt lgkmcnt(15)
    v_mfma_f32_16x16x32_bf16 v[32:35], a[32:35], a[0:3], v[32:35]
    s_add_u32 s27, s27, 12288
    s_cmp_ge_u32 s27, 61440
    s_cselect_b32 s27, 0, s27
    v_mfma_f32_16x16x32_bf16 v[36:39], a[36:39], a[0:3], v[36:39]
    s_add_u32 s26, s26, 32768
    s_cmp_ge_u32 s26, 98304
    s_cselect_b32 s26, 0, s26
    s_waitcnt lgkmcnt(13)
    v_mfma_f32_16x16x32_bf16 v[40:43], a[40:43], a[0:3], v[40:43]
    s_waitcnt lgkmcnt(0)
    s_waitcnt vmcnt(22)
    s_barrier
    v_mfma_f32_16x16x32_bf16 v[44:47], a[44:47], a[0:3], v[44:47]
    ds_read_b128 a[56:59], v13 offset:0
    s_add_u32 m0, s23, s25
    v_mfma_f32_16x16x32_bf16 v[48:51], a[0:3], a[48:51], v[48:51]
    buffer_load_dwordx4 v6, s[8:11], s35 offen offset:0 lds
    v_mfma_f32_16x16x32_bf16 v[52:55], a[0:3], a[52:55], v[52:55]
    ds_read_b64_tr_b16 a[88:89], v16 offset:0
    s_add_u32 s25, s25, 12288
    v_mfma_f32_16x16x32_bf16 v[56:59], a[32:35], a[4:7], v[56:59]
    s_cmp_ge_u32 s25, 61440
    s_cselect_b32 s25, 0, s25
    v_mfma_f32_16x16x32_bf16 v[60:63], a[36:39], a[4:7], v[60:63]
    ds_read_b64_tr_b16 a[90:91], v16 offset:512
    v_mfma_f32_16x16x32_bf16 v[64:67], a[40:43], a[4:7], v[64:67]
    buffer_load_dwordx4 v7, s[8:11], s35 offen offset:1024 lds
    v_mfma_f32_16x16x32_bf16 v[68:71], a[44:47], a[4:7], v[68:71]
    ds_read_b64_tr_b16 a[92:93], v17 offset:0
    s_add_u32 s21, s21, 196608
    v_mfma_f32_16x16x32_bf16 v[72:75], a[4:7], a[48:51], v[72:75]
    s_cmp_ge_u32 s21, 6291456
    s_cselect_b32 s21, 0, s21
    v_mfma_f32_16x16x32_bf16 v[76:79], a[4:7], a[52:55], v[76:79]
    ds_read_b64_tr_b16 a[94:95], v17 offset:512
    s_sub_u32 s37, s37, 1
    v_mfma_f32_16x16x32_bf16 v[80:83], a[32:35], a[8:11], v[80:83]
    buffer_load_dwordx4 v8, s[8:11], s35 offen offset:2048 lds
    v_mfma_f32_16x16x32_bf16 v[84:87], a[36:39], a[8:11], v[84:87]
    ds_read_b64_tr_b16 a[96:97], v16 offset:4096
    v_mfma_f32_16x16x32_bf16 v[88:91], a[40:43], a[8:11], v[88:91]
    s_cmp_gt_i32 s37, 0
    s_cselect_b32 s35, s21, 0x40000000
    v_mfma_f32_16x16x32_bf16 v[92:95], a[44:47], a[8:11], v[92:95]
    ds_read_b64_tr_b16 a[98:99], v16 offset:4608
    s_add_u32 m0, s57, s24
    v_mfma_f32_16x16x32_bf16 v[96:99], a[8:11], a[48:51], v[96:99]
    buffer_load_dwordx4 v2, s[4:7], s38 offen offset:0 lds
    v_mfma_f32_16x16x32_bf16 v[100:103], a[8:11], a[52:55], v[100:103]
    ds_read_b64_tr_b16 a[100:101], v17 offset:4096
    s_add_u32 s24, s24, 32768
    v_mfma_f32_16x16x32_bf16 v[104:107], a[32:35], a[12:15], v[104:107]
    s_cmp_ge_u32 s24, 98304
    s_cselect_b32 s24, 0, s24
    v_mfma_f32_16x16x32_bf16 v[108:111], a[36:39], a[12:15], v[108:111]
    ds_read_b64_tr_b16 a[102:103], v17 offset:4608
    v_mfma_f32_16x16x32_bf16 v[112:115], a[40:43], a[12:15], v[112:115]
    buffer_load_dwordx4 v3, s[4:7], s38 offen offset:1024 lds
    v_mfma_f32_16x16x32_bf16 v[116:119], a[44:47], a[12:15], v[116:119]
    ds_read_b64_tr_b16 a[104:105], v16 offset:8192
    s_add_u32 s20, s20, 128
    v_mfma_f32_16x16x32_bf16 v[120:123], a[12:15], a[48:51], v[120:123]
    s_and_b32 s20, s20, 2047
    s_sub_u32 s36, s36, 1
    v_mfma_f32_16x16x32_bf16 v[124:127], a[12:15], a[52:55], v[124:127]
    ds_read_b64_tr_b16 a[106:107], v16 offset:8704
    v_mfma_f32_16x16x32_bf16 v[128:131], a[32:35], a[16:19], v[128:131]
    buffer_load_dwordx4 v4, s[4:7], s38 offen offset:2048 lds
    v_mfma_f32_16x16x32_bf16 v[132:135], a[36:39], a[16:19], v[132:135]
    ds_read_b64_tr_b16 a[108:109], v17 offset:8192
    v_mfma_f32_16x16x32_bf16 v[136:139], a[40:43], a[16:19], v[136:139]
    s_cmp_gt_i32 s36, 0
    s_cselect_b32 s34, s20, 0x40000000
    v_mfma_f32_16x16x32_bf16 v[140:143], a[44:47], a[16:19], v[140:143]
    ds_read_b64_tr_b16 a[110:111], v17 offset:8704
    v_mfma_f32_16x16x32_bf16 v[144:147], a[16:19], a[48:51], v[144:147]
    buffer_load_dwordx4 v5, s[4:7], s38 offen offset:3072 lds
    v_mfma_f32_16x16x32_bf16 v[148:151], a[16:19], a[52:55], v[148:151]
    ds_read_b128 a[60:63], v13 offset:2048
    s_add_u32 s38, s34, 65536
    v_mfma_f32_16x16x32_bf16 v[152:155], a[32:35], a[20:23], v[152:155]
    v_mfma_f32_16x16x32_bf16 v[156:159], a[36:39], a[20:23], v[156:159]
    ds_read_b128 a[64:67], v13 offset:4096
    v_mfma_f32_16x16x32_bf16 v[160:163], a[40:43], a[20:23], v[160:163]
    buffer_load_dword v28, v26, s[8:11], s66 offen
    v_mfma_f32_16x16x32_bf16 v[164:167], a[44:47], a[20:23], v[164:167]
    ds_read_b128 a[68:71], v13 offset:6144
    v_mfma_f32_16x16x32_bf16 v[168:171], a[20:23], a[48:51], v[168:171]
    v_mfma_f32_16x16x32_bf16 v[172:175], a[20:23], a[52:55], v[172:175]
    ds_read_b128 a[72:75], v13 offset:8192
    v_mfma_f32_16x16x32_bf16 v[176:179], a[32:35], a[24:27], v[176:179]
    buffer_load_dword v28, v27, s[4:7], s69 offen
    v_mfma_f32_16x16x32_bf16 v[180:183], a[36:39], a[24:27], v[180:183]
    ds_read_b128 a[76:79], v13 offset:10240
    v_mfma_f32_16x16x32_bf16 v[184:187], a[40:43], a[24:27], v[184:187]
    v_mfma_f32_16x16x32_bf16 v[188:191], a[44:47], a[24:27], v[188:191]
    ds_read_b128 a[80:83], v13 offset:12288
    v_mfma_f32_16x16x32_bf16 v[192:195], a[24:27], a[48:51], v[192:195]
    v_mfma_f32_16x16x32_bf16 v[196:199], a[24:27], a[52:55], v[196:199]
    ds_read_b128 a[84:87], v13 offset:14336
    v_mfma_f32_16x16x32_bf16 v[200:203], a[32:35], a[28:31], v[200:203]
    v_add_u32 v16, s27, v14
    v_add_u32 v17, s27, v15
    v_mfma_f32_16x16x32_bf16 v[204:207], a[36:39], a[28:31], v[204:207]
    v_add_u32 v12, s26, v10
    v_add_u32 v13, s26, v11
    v_mfma_f32_16x16x32_bf16 v[208:211], a[40:43], a[28:31], v[208:211]
    v_mfma_f32_16x16x32_bf16 v[212:215], a[44:47], a[28:31], v[212:215]
    v_mfma_f32_16x16x32_bf16 v[216:219], a[28:31], a[48:51], v[216:219]
    v_mfma_f32_16x16x32_bf16 v[220:223], a[28:31], a[52:55], v[220:223]
    s_waitcnt lgkmcnt(15)
    v_mfma_f32_16x16x32_bf16 v[32:35], a[88:91], a[56:59], v[32:35]
    s_add_u32 s27, s27, 12288
    s_cmp_ge_u32 s27, 61440
    s_cselect_b32 s27, 0, s27
    v_mfma_f32_16x16x32_bf16 v[36:39], a[92:95], a[56:59], v[36:39]
    s_waitcnt lgkmcnt(13)
    v_mfma_f32_16x16x32_bf16 v[40:43], a[96:99], a[56:59], v[40:43]
    s_waitcnt lgkmcnt(0)
    s_waitcnt vmcnt(20)
    s_barrier
    v_mfma_f32_16x16x32_bf16 v[44:47], a[100:103], a[56:59], v[44:47]
    ds_read_b128 a[0:3], v12 offset:0
    s_add_u32 m0, s23, s25
    v_mfma_f32_16x16x32_bf16 v[48:51], a[56:59], a[104:107], v[48:51]
    buffer_load_dwordx4 v6, s[8:11], s35 offen offset:0 lds
    v_mfma_f32_16x16x32_bf16 v[52:55], a[56:59], a[108:111], v[52:55]
    ds_read_b64_tr_b16 a[32:33], v16 offset:0
    s_add_u32 s25, s25, 12288
    v_mfma_f32_16x16x32_bf16 v[56:59], a[88:91], a[60:63], v[56:59]
    s_cmp_ge_u32 s25, 61440
    s_cselect_b32 s25, 0, s25
    v_mfma_f32_16x16x32_bf16 v[60:63], a[92:95], a[60:63], v[60:63]
    ds_read_b64_tr_b16 a[34:35], v16 offset:512
    v_mfma_f32_16x16x32_bf16 v[64:67], a[96:99], a[60:63], v[64:67]
    buffer_load_dwordx4 v7, s[8:11], s35 offen offset:1024 lds
    v_mfma_f32_16x16x32_bf16 v[68:71], a[100:103], a[60:63], v[68:71]
    ds_read_b64_tr_b16 a[36:37], v17 offset:0
    s_add_u32 s21, s21, 196608
    v_mfma_f32_16x16x32_bf16 v[72:75], a[60:63], a[104:107], v[72:75]
    s_cmp_ge_u32 s21, 6291456
    s_cselect_b32 s21, 0, s21
    v_mfma_f32_16x16x32_bf16 v[76:79], a[60:63], a[108:111], v[76:79]
    ds_read_b64_tr_b16 a[38:39], v17 offset:512
    s_sub_u32 s37, s37, 1
    v_mfma_f32_16x16x32_bf16 v[80:83], a[88:91], a[64:67], v[80:83]
    buffer_load_dwordx4 v8, s[8:11], s35 offen offset:2048 lds
    v_mfma_f32_16x16x32_bf16 v[84:87], a[92:95], a[64:67], v[84:87]
    ds_read_b64_tr_b16 a[40:41], v16 offset:4096
    v_mfma_f32_16x16x32_bf16 v[88:91], a[96:99], a[64:67], v[88:91]
    s_cmp_gt_i32 s37, 0
    s_cselect_b32 s35, s21, 0x40000000
    v_mfma_f32_16x16x32_bf16 v[92:95], a[100:103], a[64:67], v[92:95]
    ds_read_b64_tr_b16 a[42:43], v16 offset:4608
    s_add_u32 m0, s22, s24
    v_mfma_f32_16x16x32_bf16 v[96:99], a[64:67], a[104:107], v[96:99]
    buffer_load_dwordx4 v2, s[4:7], s34 offen offset:0 lds
    v_mfma_f32_16x16x32_bf16 v[100:103], a[64:67], a[108:111], v[100:103]
    ds_read_b64_tr_b16 a[44:45], v17 offset:4096
    v_mfma_f32_16x16x32_bf16 v[104:107], a[88:91], a[68:71], v[104:107]
    v_mfma_f32_16x16x32_bf16 v[108:111], a[92:95], a[68:71], v[108:111]
    ds_read_b64_tr_b16 a[46:47], v17 offset:4608
    v_mfma_f32_16x16x32_bf16 v[112:115], a[96:99], a[68:71], v[112:115]
    buffer_load_dwordx4 v3, s[4:7], s34 offen offset:1024 lds
    v_mfma_f32_16x16x32_bf16 v[116:119], a[100:103], a[68:71], v[116:119]
    ds_read_b64_tr_b16 a[48:49], v16 offset:8192
    v_mfma_f32_16x16x32_bf16 v[120:123], a[68:71], a[104:107], v[120:123]
    v_mfma_f32_16x16x32_bf16 v[124:127], a[68:71], a[108:111], v[124:127]
    ds_read_b64_tr_b16 a[50:51], v16 offset:8704
    v_mfma_f32_16x16x32_bf16 v[128:131], a[88:91], a[72:75], v[128:131]
    buffer_load_dwordx4 v4, s[4:7], s34 offen offset:2048 lds
    v_mfma_f32_16x16x32_bf16 v[132:135], a[92:95], a[72:75], v[132:135]
    ds_read_b64_tr_b16 a[52:53], v17 offset:8192
    v_mfma_f32_16x16x32_bf16 v[136:139], a[96:99], a[72:75], v[136:139]
    v_mfma_f32_16x16x32_bf16 v[140:143], a[100:103], a[72:75], v[140:143]
    ds_read_b64_tr_b16 a[54:55], v17 offset:8704
    v_mfma_f32_16x16x32_bf16 v[144:147], a[72:75], a[104:107], v[144:147]
    buffer_load_dwordx4 v5, s[4:7], s34 offen offset:3072 lds
    v_mfma_f32_16x16x32_bf16 v[148:151], a[72:75], a[108:111], v[148:151]
    ds_read_b128 a[4:7], v12 offset:2048
    v_mfma_f32_16x16x32_bf16 v[152:155], a[88:91], a[76:79], v[152:155]
    v_mfma_f32_16x16x32_bf16 v[156:159], a[92:95], a[76:79], v[156:159]
    ds_read_b128 a[8:11], v12 offset:4096
    v_mfma_f32_16x16x32_bf16 v[160:163], a[96:99], a[76:79], v[160:163]
    buffer_load_dword v28, v26, s[8:11], s67 offen
    v_mfma_f32_16x16x32_bf16 v[164:167], a[100:103], a[76:79], v[164:167]
    ds_read_b128 a[12:15], v12 offset:6144
    v_mfma_f32_16x16x32_bf16 v[168:171], a[76:79], a[104:107], v[168:171]
    v_mfma_f32_16x16x32_bf16 v[172:175], a[76:79], a[108:111], v[172:175]
    ds_read_b128 a[16:19], v12 offset:8192
    v_mfma_f32_16x16x32_bf16 v[176:179], a[88:91], a[80:83], v[176:179]
    v_mfma_f32_16x16x32_bf16 v[180:183], a[92:95], a[80:83], v[180:183]
    ds_read_b128 a[20:23], v12 offset:10240
    v_mfma_f32_16x16x32_bf16 v[184:187], a[96:99], a[80:83], v[184:187]
    v_mfma_f32_16x16x32_bf16 v[188:191], a[100:103], a[80:83], v[188:191]
    ds_read_b128 a[24:27], v12 offset:12288
    v_mfma_f32_16x16x32_bf16 v[192:195], a[80:83], a[104:107], v[192:195]
    v_mfma_f32_16x16x32_bf16 v[196:199], a[80:83], a[108:111], v[196:199]
    ds_read_b128 a[28:31], v12 offset:14336
    v_mfma_f32_16x16x32_bf16 v[200:203], a[88:91], a[84:87], v[200:203]
    v_add_u32 v16, s27, v14
    v_add_u32 v17, s27, v15
    v_mfma_f32_16x16x32_bf16 v[204:207], a[92:95], a[84:87], v[204:207]
    v_mfma_f32_16x16x32_bf16 v[208:211], a[96:99], a[84:87], v[208:211]
    v_mfma_f32_16x16x32_bf16 v[212:215], a[100:103], a[84:87], v[212:215]
    v_mfma_f32_16x16x32_bf16 v[216:219], a[84:87], a[104:107], v[216:219]
    v_mfma_f32_16x16x32_bf16 v[220:223], a[84:87], a[108:111], v[220:223]
    s_mov_b32 s39, 10
L_qkv_kernel_loopA:
    s_waitcnt lgkmcnt(15)
    v_mfma_f32_16x16x32_bf16 v[32:35], a[32:35], a[0:3], v[32:35]
    s_add_u32 s27, s27, 12288
    s_cmp_ge_u32 s27, 61440
    s_cselect_b32 s27, 0, s27
    v_mfma_f32_16x16x32_bf16 v[36:39], a[36:39], a[0:3], v[36:39]
    s_add_u32 s26, s26, 32768
    s_cmp_ge_u32 s26, 98304
    s_cselect_b32 s26, 0, s26
    s_waitcnt lgkmcnt(13)
    v_mfma_f32_16x16x32_bf16 v[40:43], a[40:43], a[0:3], v[40:43]
    s_waitcnt lgkmcnt(0)
    s_waitcnt vmcnt(25)
    s_barrier
    v_mfma_f32_16x16x32_bf16 v[44:47], a[44:47], a[0:3], v[44:47]
    ds_read_b128 a[56:59], v13 offset:0
    s_add_u32 m0, s23, s25
    v_mfma_f32_16x16x32_bf16 v[48:51], a[0:3], a[48:51], v[48:51]
    buffer_load_dwordx4 v6, s[8:11], s35 offen offset:0 lds
    v_mfma_f32_16x16x32_bf16 v[52:55], a[0:3], a[52:55], v[52:55]
    ds_read_b64_tr_b16 a[88:89], v16 offset:0
    s_add_u32 s25, s25, 12288
    v_mfma_f32_16x16x32_bf16 v[56:59], a[32:35], a[4:7], v[56:59]
    s_cmp_ge_u32 s25, 61440
    s_cselect_b32 s25, 0, s25
    v_mfma_f32_16x16x32_bf16 v[60:63], a[36:39], a[4:7], v[60:63]
    ds_read_b64_tr_b16 a[90:91], v16 offset:512
    v_mfma_f32_16x16x32_bf16 v[64:67], a[40:43], a[4:7], v[64:67]
    v_mfma_f32_16x16x32_bf16 v[68:71], a[44:47], a[4:7], v[68:71]
    ds_read_b64_tr_b16 a[92:93], v17 offset:0
    v_mfma_f32_16x16x32_bf16 v[72:75], a[4:7], a[48:51], v[72:75]
    buffer_load_dwordx4 v7, s[8:11], s35 offen offset:1024 lds
    v_mfma_f32_16x16x32_bf16 v[76:79], a[4:7], a[52:55], v[76:79]
    ds_read_b64_tr_b16 a[94:95], v17 offset:512
    s_add_u32 s21, s21, 196608
    v_mfma_f32_16x16x32_bf16 v[80:83], a[32:35], a[8:11], v[80:83]
    s_cmp_ge_u32 s21, 6291456
    s_cselect_b32 s21, 0, s21
    v_mfma_f32_16x16x32_bf16 v[84:87], a[36:39], a[8:11], v[84:87]
    ds_read_b64_tr_b16 a[96:97], v16 offset:4096
    s_sub_u32 s37, s37, 1
    v_mfma_f32_16x16x32_bf16 v[88:91], a[40:43], a[8:11], v[88:91]
    v_mfma_f32_16x16x32_bf16 v[92:95], a[44:47], a[8:11], v[92:95]
    ds_read_b64_tr_b16 a[98:99], v16 offset:4608
    v_mfma_f32_16x16x32_bf16 v[96:99], a[8:11], a[48:51], v[96:99]
    buffer_load_dwordx4 v8, s[8:11], s35 offen offset:2048 lds
    v_mfma_f32_16x16x32_bf16 v[100:103], a[8:11], a[52:55], v[100:103]
    ds_read_b64_tr_b16 a[100:101], v17 offset:4096
    v_mfma_f32_16x16x32_bf16 v[104:107], a[32:35], a[12:15], v[104:107]
    s_cmp_gt_i32 s37, 0
    s_cselect_b32 s35, s21, 0x40000000
    v_mfma_f32_16x16x32_bf16 v[108:111], a[36:39], a[12:15], v[108:111]
    ds_read_b64_tr_b16 a[102:103], v17 offset:4608
    s_add_u32 m0, s57, s24
    v_mfma_f32_16x16x32_bf16 v[112:115], a[40:43], a[12:15], v[112:115]
    v_mfma_f32_16x16x32_bf16 v[116:119], a[44:47], a[12:15], v[116:119]
    ds_read_b64_tr_b16 a[104:105], v16 offset:8192
    v_mfma_f32_16x16x32_bf16 v[120:123], a[12:15], a[48:51], v[120:123]
    buffer_load_dwordx4 v2, s[4:7], s38 offen offset:0 lds
    v_mfma_f32_16x16x32_bf16 v[124:127], a[12:15], a[52:55], v[124:127]
    ds_read_b64_tr_b16 a[106:107], v16 offset:8704
    s_add_u32 s24, s24, 32768
    v_mfma_f32_16x16x32_bf16 v[128:131], a[32:35], a[16:19], v[128:131]
    s_cmp_ge_u32 s24, 98304
    s_cselect_b32 s24, 0, s24
    v_mfma_f32_16x16x32_bf16 v[132:135], a[36:39], a[16:19], v[132:135]
    ds_read_b64_tr_b16 a[108:109], v17 offset:8192
    v_mfma_f32_16x16x32_bf16 v[136:139], a[40:43], a[16:19], v[136:139]
    v_mfma_f32_16x16x32_bf16 v[140:143], a[44:47], a[16:19], v[140:143]
    ds_read_b64_tr_b16 a[110:111], v17 offset:8704
    v_mfma_f32_16x16x32_bf16 v[144:147], a[16:19], a[48:51], v[144:147]
    buffer_load_dwordx4 v3, s[4:7], s38 offen offset:1024 lds
    v_mfma_f32_16x16x32_bf16 v[148:151], a[16:19], a[52:55], v[148:151]
    ds_read_b128 a[60:63], v13 offset:2048
    s_add_u32 s20, s20, 128
    v_mfma_f32_16x16x32_bf16 v[152:155], a[32:35], a[20:23], v[152:155]
    s_and_b32 s20, s20, 2047
    s_sub_u32 s36, s36, 1
    v_mfma_f32_16x16x32_bf16 v[156:159], a[36:39], a[20:23], v[156:159]
    ds_read_b128 a[64:67], v13 offset:4096
    v_mfma_f32_16x16x32_bf16 v[160:163], a[40:43], a[20:23], v[160:163]
    v_mfma_f32_16x16x32_bf16 v[164:167], a[44:47], a[20:23], v[164:167]
    ds_read_b128 a[68:71], v13 offset:6144
    v_mfma_f32_16x16x32_bf16 v[168:171], a[20:23], a[48:51], v[168:171]
    buffer_load_dwordx4 v4, s[4:7], s38 offen offset:2048 lds
    v_mfma_f32_16x16x32_bf16 v[172:175], a[20:23], a[52:55], v[172:175]
    ds_read_b128 a[72:75], v13 offset:8192
    v_mfma_f32_16x16x32_bf16 v[176:179], a[32:35], a[24:27], v[176:179]
    s_cmp_gt_i32 s36, 0
    s_cselect_b32 s34, s20, 0x40000000
    v_mfma_f32_16x16x32_bf16 v[180:183], a[36:39], a[24:27], v[180:183]
    ds_read_b128 a[76:79], v13 offset:10240
    v_mfma_f32_16x16x32_bf16 v[184:187], a[40:43], a[24:27], v[184:187]
    v_mfma_f32_16x16x32_bf16 v[188:191], a[44:47], a[24:27], v[188:191]
    ds_read_b128 a[80:83], v13 offset:12288
    v_mfma_f32_16x16x32_bf16 v[192:195], a[24:27], a[48:51], v[192:195]
    buffer_load_dwordx4 v5, s[4:7], s38 offen offset:3072 lds
    v_mfma_f32_16x16x32_bf16 v[196:199], a[24:27], a[52:55], v[196:199]
    ds_read_b128 a[84:87], v13 offset:14336
    s_add_u32 s38, s34, 65536
    v_mfma_f32_16x16x32_bf16 v[200:203], a[32:35], a[28:31], v[200:203]
    v_add_u32 v16, s27, v14
    v_add_u32 v17, s27, v15
    v_mfma_f32_16x16x32_bf16 v[204:207], a[36:39], a[28:31], v[204:207]
    v_add_u32 v12, s26, v10
    v_add_u32 v13, s26, v11
    v_mfma_f32_16x16x32_bf16 v[208:211], a[40:43], a[28:31], v[208:211]
    v_mfma_f32_16x16x32_bf16 v[212:215], a[44:47], a[28:31], v[212:215]
    v_mfma_f32_16x16x32_bf16 v[216:219], a[28:31], a[48:51], v[216:219]
    v_mfma_f32_16x16x32_bf16 v[220:223], a[28:31], a[52:55], v[220:223]
    s_waitcnt lgkmcnt(15)
    v_mfma_f32_16x16x32_bf16 v[32:35], a[88:91], a[56:59], v[32:35]
    s_add_u32 s27, s27, 12288
    s_cmp_ge_u32 s27, 61440
    s_cselect_b32 s27, 0, s27
    v_mfma_f32_16x16x32_bf16 v[36:39], a[92:95], a[56:59], v[36:39]
    s_waitcnt lgkmcnt(13)
    v_mfma_f32_16x16x32_bf16 v[40:43], a[96:99], a[56:59], v[40:43]
    s_waitcnt lgkmcnt(0)
    s_waitcnt vmcnt(14)
    s_barrier
    v_mfma_f32_16x16x32_bf16 v[44:47], a[100:103], a[56:59], v[44:47]
    ds_read_b128 a[0:3], v12 offset:0
    s_add_u32 m0, s23, s25
    v_mfma_f32_16x16x32_bf16 v[48:51], a[56:59], a[104:107], v[48:51]
    buffer_load_dwordx4 v6, s[8:11], s35 offen offset:0 lds
    v_mfma_f32_16x16x32_bf16 v[52:55], a[56:59], a[108:111], v[52:55]
    ds_read_b64_tr_b16 a[32:33], v16 offset:0
    s_add_u32 s25, s25, 12288
    v_mfma_f32_16x16x32_bf16 v[56:59], a[88:91], a[60:63], v[56:59]
    s_cmp_ge_u32 s25, 61440
    s_cselect_b32 s25, 0, s25
    v_mfma_f32_16x16x32_bf16 v[60:63], a[92:95], a[60:63], v[60:63]
    ds_read_b64_tr_b16 a[34:35], v16 offset:512
    v_mfma_f32_16x16x32_bf16 v[64:67], a[96:99], a[60:63], v[64:67]
    v_mfma_f32_16x16x32_bf16 v[68:71], a[100:103], a[60:63], v[68:71]
    ds_read_b64_tr_b16 a[36:37], v17 offset:0
    v_mfma_f32_16x16x32_bf16 v[72:75], a[60:63], a[104:107], v[72:75]
    buffer_load_dwordx4 v7, s[8:11], s35 offen offset:1024 lds
    v_mfma_f32_16x16x32_bf16 v[76:79], a[60:63], a[108:111], v[76:79]
    ds_read_b64_tr_b16 a[38:39], v17 offset:512
    s_add_u32 s21, s21, 196608
    v_mfma_f32_16x16x32_bf16 v[80:83], a[88:91], a[64:67], v[80:83]
    s_cmp_ge_u32 s21, 6291456
    s_cselect_b32 s21, 0, s21
    v_mfma_f32_16x16x32_bf16 v[84:87], a[92:95], a[64:67], v[84:87]
    ds_read_b64_tr_b16 a[40:41], v16 offset:4096
    s_sub_u32 s37, s37, 1
    v_mfma_f32_16x16x32_bf16 v[88:91], a[96:99], a[64:67], v[88:91]
    v_mfma_f32_16x16x32_bf16 v[92:95], a[100:103], a[64:67], v[92:95]
    ds_read_b64_tr_b16 a[42:43], v16 offset:4608
    v_mfma_f32_16x16x32_bf16 v[96:99], a[64:67], a[104:107], v[96:99]
    buffer_load_dwordx4 v8, s[8:11], s35 offen offset:2048 lds
    v_mfma_f32_16x16x32_bf16 v[100:103], a[64:67], a[108:111], v[100:103]
    ds_read_b64_tr_b16 a[44:45], v17 offset:4096
    v_mfma_f32_16x16x32_bf16 v[104:107], a[88:91], a[68:71], v[104:107]
    s_cmp_gt_i32 s37, 0
    s_cselect_b32 s35, s21, 0x40000000
    v_mfma_f32_16x16x32_bf16 v[108:111], a[92:95], a[68:71], v[108:111]
    ds_read_b64_tr_b16 a[46:47], v17 offset:4608
    s_add_u32 m0, s22, s24
    v_mfma_f32_16x16x32_bf16 v[112:115], a[96:99], a[68:71], v[112:115]
    v_mfma_f32_16x16x32_bf16 v[116:119], a[100:103], a[68:71], v[116:119]
    ds_read_b64_tr_b16 a[48:49], v16 offset:8192
    v_mfma_f32_16x16x32_bf16 v[120:123], a[68:71], a[104:107], v[120:123]
    buffer_load_dwordx4 v2, s[4:7], s34 offen offset:0 lds
    v_mfma_f32_16x16x32_bf16 v[124:127], a[68:71], a[108:111], v[124:127]
    ds_read_b64_tr_b16 a[50:51], v16 offset:8704
    v_mfma_f32_16x16x32_bf16 v[128:131], a[88:91], a[72:75], v[128:131]
    v_mfma_f32_16x16x32_bf16 v[132:135], a[92:95], a[72:75], v[132:135]
    ds_read_b64_tr_b16 a[52:53], v17 offset:8192
    v_mfma_f32_16x16x32_bf16 v[136:139], a[96:99], a[72:75], v[136:139]
    v_mfma_f32_16x16x32_bf16 v[140:143], a[100:103], a[72:75], v[140:143]
    ds_read_b64_tr_b16 a[54:55], v17 offset:8704
    v_mfma_f32_16x16x32_bf16 v[144:147], a[72:75], a[104:107], v[144:147]
    buffer_load_dwordx4 v3, s[4:7], s34 offen offset:1024 lds
    v_mfma_f32_16x16x32_bf16 v[148:151], a[72:75], a[108:111], v[148:151]
    ds_read_b128 a[4:7], v12 offset:2048
    v_mfma_f32_16x16x32_bf16 v[152:155], a[88:91], a[76:79], v[152:155]
    v_mfma_f32_16x16x32_bf16 v[156:159], a[92:95], a[76:79], v[156:159]
    ds_read_b128 a[8:11], v12 offset:4096
    v_mfma_f32_16x16x32_bf16 v[160:163], a[96:99], a[76:79], v[160:163]
    v_mfma_f32_16x16x32_bf16 v[164:167], a[100:103], a[76:79], v[164:167]
    ds_read_b128 a[12:15], v12 offset:6144
    v_mfma_f32_16x16x32_bf16 v[168:171], a[76:79], a[104:107], v[168:171]
    buffer_load_dwordx4 v4, s[4:7], s34 offen offset:2048 lds
    v_mfma_f32_16x16x32_bf16 v[172:175], a[76:79], a[108:111], v[172:175]
    ds_read_b128 a[16:19], v12 offset:8192
    v_mfma_f32_16x16x32_bf16 v[176:179], a[88:91], a[80:83], v[176:179]
    v_mfma_f32_16x16x32_bf16 v[180:183], a[92:95], a[80:83], v[180:183]
    ds_read_b128 a[20:23], v12 offset:10240
    v_mfma_f32_16x16x32_bf16 v[184:187], a[96:99], a[80:83], v[184:187]
    v_mfma_f32_16x16x32_bf16 v[188:191], a[100:103], a[80:83], v[188:191]
    ds_read_b128 a[24:27], v12 offset:12288
    v_mfma_f32_16x16x32_bf16 v[192:195], a[80:83], a[104:107], v[192:195]
    buffer_load_dwordx4 v5, s[4:7], s34 offen offset:3072 lds
    v_mfma_f32_16x16x32_bf16 v[196:199], a[80:83], a[108:111], v[196:199]
    ds_read_b128 a[28:31], v12 offset:14336
    v_mfma_f32_16x16x32_bf16 v[200:203], a[88:91], a[84:87], v[200:203]
    v_add_u32 v16, s27, v14
    v_add_u32 v17, s27, v15
    v_mfma_f32_16x16x32_bf16 v[204:207], a[92:95], a[84:87], v[204:207]
    v_mfma_f32_16x16x32_bf16 v[208:211], a[96:99], a[84:87], v[208:211]
    v_mfma_f32_16x16x32_bf16 v[212:215], a[100:103], a[84:87], v[212:215]
    v_mfma_f32_16x16x32_bf16 v[216:219], a[84:87], a[104:107], v[216:219]
    v_mfma_f32_16x16x32_bf16 v[220:223], a[84:87], a[108:111], v[220:223]
    s_sub_u32 s39, s39, 1
    s_cmp_lg_u32 s39, 0
    s_cbranch_scc1 L_qkv_kernel_loopA
    v_add_u32 v12, 0x10000, v10
    v_add_u32 v13, 0x10000, v11
    s_waitcnt lgkmcnt(15)
    v_mfma_f32_16x16x32_bf16 v[32:35], a[32:35], a[0:3], v[32:35]
    v_mfma_f32_16x16x32_bf16 v[36:39], a[36:39], a[0:3], v[36:39]
    s_waitcnt lgkmcnt(13)
    v_mfma_f32_16x16x32_bf16 v[40:43], a[40:43], a[0:3], v[40:43]
    s_waitcnt lgkmcnt(0)
    s_waitcnt vmcnt(18)
    s_barrier
    v_mfma_f32_16x16x32_bf16 v[44:47], a[44:47], a[0:3], v[44:47]
    ds_read_b64_tr_b16 a[112:113], v14 offset:12288
    s_add_u32 m0, s23, s25
    v_mfma_f32_16x16x32_bf16 v[48:51], a[0:3], a[48:51], v[48:51]
    ds_read_b64_tr_b16 a[114:115], v14 offset:12800
    buffer_load_dwordx4 v6, s[8:11], s35 offen offset:0 lds
    s_add_u32 s25, s25, 12288
    v_mfma_f32_16x16x32_bf16 v[52:55], a[0:3], a[52:55], v[52:55]
    ds_read_b64_tr_b16 a[116:117], v15 offset:12288
    s_cmp_ge_u32 s25, 61440
    s_cselect_b32 s25, 0, s25
    v_mfma_f32_16x16x32_bf16 v[56:59], a[32:35], a[4:7], v[56:59]
    ds_read_b64_tr_b16 a[118:119], v15 offset:12800
    v_mfma_f32_16x16x32_bf16 v[60:63], a[36:39], a[4:7], v[60:63]
    ds_read_b64_tr_b16 a[120:121], v14 offset:16384
    v_mfma_f32_16x16x32_bf16 v[64:67], a[40:43], a[4:7], v[64:67]
    ds_read_b64_tr_b16 a[122:123], v14 offset:16896
    v_mfma_f32_16x16x32_bf16 v[68:71], a[44:47], a[4:7], v[68:71]
    ds_read_b64_tr_b16 a[124:125], v15 offset:16384
    v_mfma_f32_16x16x32_bf16 v[72:75], a[4:7], a[48:51], v[72:75]
    ds_read_b64_tr_b16 a[126:127], v15 offset:16896
    buffer_load_dwordx4 v7, s[8:11], s35 offen offset:1024 lds
    s_add_u32 s21, s21, 196608
    v_mfma_f32_16x16x32_bf16 v[76:79], a[4:7], a[52:55], v[76:79]
    ds_read_b64_tr_b16 a[128:129], v14 offset:20480
    s_cmp_ge_u32 s21, 6291456
    s_cselect_b32 s21, 0, s21
    v_mfma_f32_16x16x32_bf16 v[80:83], a[32:35], a[8:11], v[80:83]
    ds_read_b64_tr_b16 a[130:131], v14 offset:20992
    s_sub_u32 s37, s37, 1
    v_mfma_f32_16x16x32_bf16 v[84:87], a[36:39], a[8:11], v[84:87]
    ds_read_b64_tr_b16 a[132:133], v15 offset:20480
    v_mfma_f32_16x16x32_bf16 v[88:91], a[40:43], a[8:11], v[88:91]
    ds_read_b64_tr_b16 a[134:135], v15 offset:20992
    v_mfma_f32_16x16x32_bf16 v[92:95], a[44:47], a[8:11], v[92:95]
    ds_read_b128 a[56:59], v11 offset:0
    v_mfma_f32_16x16x32_bf16 v[96:99], a[8:11], a[48:51], v[96:99]
    ds_read_b64_tr_b16 a[88:89], v14 offset:0
    buffer_load_dwordx4 v8, s[8:11], s35 offen offset:2048 lds
    v_mfma_f32_16x16x32_bf16 v[100:103], a[8:11], a[52:55], v[100:103]
    ds_read_b64_tr_b16 a[90:91], v14 offset:512
    s_cmp_gt_i32 s37, 0
    s_cselect_b32 s35, s21, 0x40000000
    v_mfma_f32_16x16x32_bf16 v[104:107], a[32:35], a[12:15], v[104:107]
    ds_read_b64_tr_b16 a[92:93], v15 offset:0
    s_add_u32 m0, s57, s24
    v_mfma_f32_16x16x32_bf16 v[108:111], a[36:39], a[12:15], v[108:111]
    ds_read_b64_tr_b16 a[94:95], v15 offset:512
    v_mfma_f32_16x16x32_bf16 v[112:115], a[40:43], a[12:15], v[112:115]
    ds_read_b64_tr_b16 a[96:97], v14 offset:4096
    v_mfma_f32_16x16x32_bf16 v[116:119], a[44:47], a[12:15], v[116:119]
    ds_read_b64_tr_b16 a[98:99], v14 offset:4608
    v_mfma_f32_16x16x32_bf16 v[120:123], a[12:15], a[48:51], v[120:123]
    ds_read_b64_tr_b16 a[100:101], v15 offset:4096
    buffer_load_dwordx4 v2, s[4:7], s38 offen offset:0 lds
    s_add_u32 s24, s24, 32768
    v_mfma_f32_16x16x32_bf16 v[124:127], a[12:15], a[52:55], v[124:127]
    ds_read_b64_tr_b16 a[102:103], v15 offset:4608
    s_cmp_ge_u32 s24, 98304
    s_cselect_b32 s24, 0, s24
    v_mfma_f32_16x16x32_bf16 v[128:131], a[32:35], a[16:19], v[128:131]
    ds_read_b64_tr_b16 a[104:105], v14 offset:8192
    v_mfma_f32_16x16x32_bf16 v[132:135], a[36:39], a[16:19], v[132:135]
    ds_read_b64_tr_b16 a[106:107], v14 offset:8704
    v_mfma_f32_16x16x32_bf16 v[136:139], a[40:43], a[16:19], v[136:139]
    ds_read_b64_tr_b16 a[108:109], v15 offset:8192
    v_mfma_f32_16x16x32_bf16 v[140:143], a[44:47], a[16:19], v[140:143]
    ds_read_b64_tr_b16 a[110:111], v15 offset:8704
    v_mfma_f32_16x16x32_bf16 v[144:147], a[16:19], a[48:51], v[144:147]
    ds_read_b128 a[60:63], v11 offset:2048
    buffer_load_dwordx4 v3, s[4:7], s38 offen offset:1024 lds
    s_add_u32 s20, s20, 128
    v_mfma_f32_16x16x32_bf16 v[148:151], a[16:19], a[52:55], v[148:151]
    ds_read_b128 a[64:67], v11 offset:4096
    s_and_b32 s20, s20, 2047
    s_sub_u32 s36, s36, 1
    v_mfma_f32_16x16x32_bf16 v[152:155], a[32:35], a[20:23], v[152:155]
    ds_read_b128 a[68:71], v11 offset:6144
    v_mfma_f32_16x16x32_bf16 v[156:159], a[36:39], a[20:23], v[156:159]
    ds_read_b128 a[72:75], v11 offset:8192
    v_mfma_f32_16x16x32_bf16 v[160:163], a[40:43], a[20:23], v[160:163]
    ds_read_b128 a[76:79], v11 offset:10240
    v_mfma_f32_16x16x32_bf16 v[164:167], a[44:47], a[20:23], v[164:167]
    ds_read_b128 a[80:83], v11 offset:12288
    v_mfma_f32_16x16x32_bf16 v[168:171], a[20:23], a[48:51], v[168:171]
    ds_read_b128 a[84:87], v11 offset:14336
    buffer_load_dwordx4 v4, s[4:7], s38 offen offset:2048 lds
    v_mfma_f32_16x16x32_bf16 v[172:175], a[20:23], a[52:55], v[172:175]
    s_cmp_gt_i32 s36, 0
    s_cselect_b32 s34, s20, 0x40000000
    v_mfma_f32_16x16x32_bf16 v[176:179], a[32:35], a[24:27], v[176:179]
    v_mfma_f32_16x16x32_bf16 v[180:183], a[36:39], a[24:27], v[180:183]
    v_mfma_f32_16x16x32_bf16 v[184:187], a[40:43], a[24:27], v[184:187]
    v_mfma_f32_16x16x32_bf16 v[188:191], a[44:47], a[24:27], v[188:191]
    v_mfma_f32_16x16x32_bf16 v[192:195], a[24:27], a[48:51], v[192:195]
    buffer_load_dwordx4 v5, s[4:7], s38 offen offset:3072 lds
    s_add_u32 s38, s34, 65536
    v_mfma_f32_16x16x32_bf16 v[196:199], a[24:27], a[52:55], v[196:199]
    v_mfma_f32_16x16x32_bf16 v[200:203], a[32:35], a[28:31], v[200:203]
    v_mfma_f32_16x16x32_bf16 v[204:207], a[36:39], a[28:31], v[204:207]
    v_mfma_f32_16x16x32_bf16 v[208:211], a[40:43], a[28:31], v[208:211]
    v_mfma_f32_16x16x32_bf16 v[212:215], a[44:47], a[28:31], v[212:215]
    v_mfma_f32_16x16x32_bf16 v[216:219], a[28:31], a[48:51], v[216:219]
    v_mfma_f32_16x16x32_bf16 v[220:223], a[28:31], a[52:55], v[220:223]
    s_waitcnt lgkmcnt(15)
    v_mfma_f32_16x16x32_bf16 v[32:35], a[88:91], a[56:59], v[32:35]
    v_mfma_f32_16x16x32_bf16 v[36:39], a[92:95], a[56:59], v[36:39]
    s_waitcnt lgkmcnt(13)
    v_mfma_f32_16x16x32_bf16 v[40:43], a[96:99], a[56:59], v[40:43]
    s_waitcnt lgkmcnt(0)
    s_waitcnt vmcnt(14)
    s_barrier
    v_mfma_f32_16x16x32_bf16 v[44:47], a[100:103], a[56:59], v[44:47]
    ds_read_b128 a[0:3], v10 offset:32768
    s_add_u32 m0, s22, s24
    v_mfma_f32_16x16x32_bf16 v[48:51], a[56:59], a[104:107], v[48:51]
    ds_read_b128 a[4:7], v10 offset:34816
    buffer_load_dwordx4 v2, s[4:7], s34 offen offset:0 lds
    v_mfma_f32_16x16x32_bf16 v[52:55], a[56:59], a[108:111], v[52:55]
    ds_read_b128 a[8:11], v11 offset:32768
    v_mfma_f32_16x16x32_bf16 v[56:59], a[88:91], a[60:63], v[56:59]
    ds_read_b64_tr_b16 a[136:137], v14 offset:24576
    v_mfma_f32_16x16x32_bf16 v[60:63], a[92:95], a[60:63], v[60:63]
    ds_read_b64_tr_b16 a[138:139], v14 offset:25088
    buffer_load_dwordx4 v3, s[4:7], s34 offen offset:1024 lds
    v_mfma_f32_16x16x32_bf16 v[64:67], a[96:99], a[60:63], v[64:67]
    ds_read_b64_tr_b16 a[140:141], v15 offset:24576
    v_mfma_f32_16x16x32_bf16 v[68:71], a[100:103], a[60:63], v[68:71]
    ds_read_b64_tr_b16 a[142:143], v15 offset:25088
    v_mfma_f32_16x16x32_bf16 v[72:75], a[60:63], a[104:107], v[72:75]
    ds_read_b64_tr_b16 a[144:145], v14 offset:28672
    buffer_load_dwordx4 v4, s[4:7], s34 offen offset:2048 lds
    v_mfma_f32_16x16x32_bf16 v[76:79], a[60:63], a[108:111], v[76:79]
    ds_read_b64_tr_b16 a[146:147], v14 offset:29184
    v_mfma_f32_16x16x32_bf16 v[80:83], a[88:91], a[64:67], v[80:83]
    ds_read_b64_tr_b16 a[148:149], v15 offset:28672
    v_mfma_f32_16x16x32_bf16 v[84:87], a[92:95], a[64:67], v[84:87]
    ds_read_b64_tr_b16 a[150:151], v15 offset:29184
    buffer_load_dwordx4 v5, s[4:7], s34 offen offset:3072 lds
    s_add_u32 m0, s23, s25
    v_mfma_f32_16x16x32_bf16 v[88:91], a[96:99], a[64:67], v[88:91]
    ds_read_b64_tr_b16 a[152:153], v14 offset:32768
    v_mfma_f32_16x16x32_bf16 v[92:95], a[100:103], a[64:67], v[92:95]
    ds_read_b64_tr_b16 a[154:155], v14 offset:33280
    v_mfma_f32_16x16x32_bf16 v[96:99], a[64:67], a[104:107], v[96:99]
    ds_read_b64_tr_b16 a[156:157], v15 offset:32768
    buffer_load_dwordx4 v6, s[8:11], s35 offen offset:0 lds
    s_add_u32 s25, s25, 12288
    v_mfma_f32_16x16x32_bf16 v[100:103], a[64:67], a[108:111], v[100:103]
    ds_read_b64_tr_b16 a[158:159], v15 offset:33280
    s_cmp_ge_u32 s25, 61440
    s_cselect_b32 s25, 0, s25
    v_mfma_f32_16x16x32_bf16 v[104:107], a[88:91], a[68:71], v[104:107]
    ds_read_b128 a[12:15], v11 offset:34816
    v_mfma_f32_16x16x32_bf16 v[108:111], a[92:95], a[68:71], v[108:111]
    ds_read_b128 a[56:59], v10 offset:36864
    buffer_load_dwordx4 v7, s[8:11], s35 offen offset:1024 lds
    s_add_u32 s21, s21, 196608
    v_mfma_f32_16x16x32_bf16 v[112:115], a[96:99], a[68:71], v[112:115]
    ds_read_b128 a[60:63], v10 offset:38912
    s_cmp_ge_u32 s21, 6291456
    s_cselect_b32 s21, 0, s21
    v_mfma_f32_16x16x32_bf16 v[116:119], a[100:103], a[68:71], v[116:119]
    ds_read_b128 a[64:67], v11 offset:36864
    s_sub_u32 s37, s37, 1
    v_mfma_f32_16x16x32_bf16 v[120:123], a[68:71], a[104:107], v[120:123]
    buffer_load_dwordx4 v8, s[8:11], s35 offen offset:2048 lds
    s_cmp_gt_i32 s37, 0
    s_cselect_b32 s35, s21, 0x40000000
    v_mfma_f32_16x16x32_bf16 v[124:127], a[68:71], a[108:111], v[124:127]
    s_add_u32 m0, s57, s24
    v_mfma_f32_16x16x32_bf16 v[128:131], a[88:91], a[72:75], v[128:131]
    ds_read_b128 a[68:71], v11 offset:38912
    v_mfma_f32_16x16x32_bf16 v[132:135], a[92:95], a[72:75], v[132:135]
    buffer_load_dwordx4 v2, s[4:7], s38 offen offset:0 lds
    s_add_u32 s24, s24, 32768
    v_mfma_f32_16x16x32_bf16 v[136:139], a[96:99], a[72:75], v[136:139]
    s_cmp_ge_u32 s24, 98304
    s_cselect_b32 s24, 0, s24
    v_mfma_f32_16x16x32_bf16 v[140:143], a[100:103], a[72:75], v[140:143]
    v_mfma_f32_16x16x32_bf16 v[144:147], a[72:75], a[104:107], v[144:147]
    buffer_load_dwordx4 v3, s[4:7], s38 offen offset:1024 lds
    s_add_u32 s20, s20, 128
    s_and_b32 s20, s20, 2047
    v_mfma_f32_16x16x32_bf16 v[148:151], a[72:75], a[108:111], v[148:151]
    s_sub_u32 s36, s36, 1
    v_mfma_f32_16x16x32_bf16 v[152:155], a[88:91], a[76:79], v[152:155]
    v_mfma_f32_16x16x32_bf16 v[156:159], a[92:95], a[76:79], v[156:159]
    buffer_load_dwordx4 v4, s[4:7], s38 offen offset:2048 lds
    s_cmp_gt_i32 s36, 0
    s_cselect_b32 s34, s20, 0x40000000
    v_mfma_f32_16x16x32_bf16 v[160:163], a[96:99], a[76:79], v[160:163]
    v_mfma_f32_16x16x32_bf16 v[164:167], a[100:103], a[76:79], v[164:167]
    v_mfma_f32_16x16x32_bf16 v[168:171], a[76:79], a[104:107], v[168:171]
    buffer_load_dwordx4 v5, s[4:7], s38 offen offset:3072 lds
    s_add_u32 m0, s23, s25
    v_mfma_f32_16x16x32_bf16 v[172:175], a[76:79], a[108:111], v[172:175]
    v_mfma_f32_16x16x32_bf16 v[176:179], a[88:91], a[80:83], v[176:179]
    v_mfma_f32_16x16x32_bf16 v[180:183], a[92:95], a[80:83], v[180:183]
    buffer_load_dwordx4 v6, s[8:11], s35 offen offset:0 lds
    s_add_u32 s25, s25, 12288
    v_mfma_f32_16x16x32_bf16 v[184:187], a[96:99], a[80:83], v[184:187]
    s_cmp_ge_u32 s25, 61440
    s_cselect_b32 s25, 0, s25
    v_mfma_f32_16x16x32_bf16 v[188:191], a[100:103], a[80:83], v[188:191]
    v_mfma_f32_16x16x32_bf16 v[192:195], a[80:83], a[104:107], v[192:195]
    buffer_load_dwordx4 v7, s[8:11], s35 offen offset:1024 lds
    s_add_u32 s21, s21, 196608
    v_mfma_f32_16x16x32_bf16 v[196:199], a[80:83], a[108:111], v[196:199]
    s_cmp_ge_u32 s21, 6291456
    s_cselect_b32 s21, 0, s21
    s_sub_u32 s37, s37, 1
    v_mfma_f32_16x16x32_bf16 v[200:203], a[88:91], a[84:87], v[200:203]
    v_mfma_f32_16x16x32_bf16 v[204:207], a[92:95], a[84:87], v[204:207]
    buffer_load_dwordx4 v8, s[8:11], s35 offen offset:2048 lds
    v_mfma_f32_16x16x32_bf16 v[208:211], a[96:99], a[84:87], v[208:211]
    v_mfma_f32_16x16x32_bf16 v[212:215], a[100:103], a[84:87], v[212:215]
    v_mfma_f32_16x16x32_bf16 v[216:219], a[84:87], a[104:107], v[216:219]
    v_mfma_f32_16x16x32_bf16 v[220:223], a[84:87], a[108:111], v[220:223]
    s_waitcnt lgkmcnt(15)
    v_mfma_f32_16x16x32_bf16 v[32:35], a[112:115], a[0:3], v[32:35]
    v_mfma_f32_16x16x32_bf16 v[36:39], a[116:119], a[0:3], v[36:39]
    v_mfma_f32_16x16x32_bf16 v[40:43], a[120:123], a[0:3], v[40:43]
    s_waitcnt vmcnt(14)
    s_barrier
    v_mfma_f32_16x16x32_bf16 v[44:47], a[124:127], a[0:3], v[44:47]
    ds_read_b128 a[16:19], v12 offset:0
    s_and_b32 s28, s16, 1
    v_mfma_f32_16x16x32_bf16 v[48:51], a[0:3], a[128:131], v[48:51]
    ds_read_b64_tr_b16 a[160:161], v14 offset:36864
    s_lshl_b32 s29, s18, 1
    v_mfma_f32_16x16x32_bf16 v[52:55], a[0:3], a[132:135], v[52:55]
    ds_read_b64_tr_b16 a[162:163], v14 offset:37376
    s_add_u32 s28, s28, s29
    v_mfma_f32_16x16x32_bf16 v[56:59], a[112:115], a[4:7], v[56:59]
    ds_read_b64_tr_b16 a[164:165], v15 offset:36864
    s_lshr_b32 s29, s16, 1
    v_mfma_f32_16x16x32_bf16 v[60:63], a[116:119], a[4:7], v[60:63]
    ds_read_b64_tr_b16 a[166:167], v15 offset:37376
    s_lshl_b32 s29, s29, 2
    v_mfma_f32_16x16x32_bf16 v[64:67], a[120:123], a[4:7], v[64:67]
    ds_read_b64_tr_b16 a[168:169], v14 offset:40960
    s_lshl_b32 s30, s17, 3
    v_mfma_f32_16x16x32_bf16 v[68:71], a[124:127], a[4:7], v[68:71]
    ds_read_b64_tr_b16 a[170:171], v14 offset:41472
    s_add_u32 s29, s29, s30
    v_mfma_f32_16x16x32_bf16 v[72:75], a[4:7], a[128:131], v[72:75]
    ds_read_b64_tr_b16 a[172:173], v15 offset:40960
    v_lshrrev_b32 v1, 4, v0
    v_mfma_f32_16x16x32_bf16 v[76:79], a[4:7], a[132:135], v[76:79]
    ds_read_b64_tr_b16 a[174:175], v15 offset:41472
    v_lshlrev_b32 v1, 9, v1
    v_mfma_f32_16x16x32_bf16 v[32:35], a[136:139], a[8:11], v[32:35]
    ds_read_b64_tr_b16 a[176:177], v14 offset:45056
    v_and_b32 v2, 15, v0
    s_waitcnt lgkmcnt(15)
    v_mfma_f32_16x16x32_bf16 v[36:39], a[140:143], a[8:11], v[36:39]
    ds_read_b64_tr_b16 a[178:179], v14 offset:45568
    v_lshl_add_u32 v4, v2, 4, v1
    v_mfma_f32_16x16x32_bf16 v[40:43], a[144:147], a[8:11], v[40:43]
    ds_read_b64_tr_b16 a[180:181], v15 offset:45056
    s_lshl_b32 s30, s28, 17
    v_mfma_f32_16x16x32_bf16 v[44:47], a[148:151], a[8:11], v[44:47]
    ds_read_b64_tr_b16 a[182:183], v15 offset:45568
    s_lshl_b32 s31, s29, 11
    v_mfma_f32_16x16x32_bf16 v[48:51], a[8:11], a[152:155], v[48:51]
    ds_read_b128 a[20:23], v12 offset:2048
    s_add_u32 s30, s30, s31
    v_mfma_f32_16x16x32_bf16 v[52:55], a[8:11], a[156:159], v[52:55]
    ds_read_b128 a[24:27], v13 offset:0
    v_and_b32 v2, 7, v0
    s_waitcnt lgkmcnt(15)
    v_mfma_f32_16x16x32_bf16 v[56:59], a[136:139], a[12:15], v[56:59]
    ds_read_b64_tr_b16 a[184:185], v14 offset:49152
    v_lshl_add_u32 v5, v2, 4, v1
    v_mfma_f32_16x16x32_bf16 v[60:63], a[140:143], a[12:15], v[60:63]
    ds_read_b64_tr_b16 a[186:187], v14 offset:49664
    v_bfe_u32 v2, v0, 3, 1
    v_mfma_f32_16x16x32_bf16 v[64:67], a[144:147], a[12:15], v[64:67]
    ds_read_b64_tr_b16 a[188:189], v15 offset:49152
    v_lshl_add_u32 v5, v2, 8, v5
    v_mfma_f32_16x16x32_bf16 v[68:71], a[148:151], a[12:15], v[68:71]
    ds_read_b64_tr_b16 a[190:191], v15 offset:49664
    s_add_u32 s30, s30, 0
    v_mfma_f32_16x16x32_bf16 v[72:75], a[12:15], a[152:155], v[72:75]
    ds_read_b64_tr_b16 a[192:193], v14 offset:53248
    s_add_u32 s31, s30, 4096
    v_mfma_f32_16x16x32_bf16 v[76:79], a[12:15], a[156:159], v[76:79]
    ds_read_b64_tr_b16 a[194:195], v14 offset:53760
    s_lshl_b32 s32, s28, 18
    s_waitcnt lgkmcnt(15)
    v_mfma_f32_16x16x32_bf16 v[32:35], a[160:163], a[16:19], v[32:35]
    ds_read_b64_tr_b16 a[196:197], v15 offset:53248
    s_lshl_b32 s33, s29, 12
    v_mfma_f32_16x16x32_bf16 v[36:39], a[164:167], a[16:19], v[36:39]
    ds_read_b64_tr_b16 a[198:199], v15 offset:53760
    s_add_u32 s32, s32, s33
    s_waitcnt lgkmcnt(15)
    v_mfma_f32_16x16x32_bf16 v[40:43], a[168:171], a[16:19], v[40:43]
    ds_read_b64_tr_b16 a[200:201], v14 offset:57344
    s_add_u32 s32, s32, 4194304
    s_waitcnt lgkmcnt(15)
    v_mfma_f32_16x16x32_bf16 v[44:47], a[172:175], a[16:19], v[44:47]
    ds_read_b64_tr_b16 a[202:203], v14 offset:57856
    s_add_u32 s33, s32, 4096
    s_waitcnt lgkmcnt(14)
    v_mfma_f32_16x16x32_bf16 v[48:51], a[16:19], a[176:179], v[48:51]
    ds_read_b64_tr_b16 a[204:205], v15 offset:57344
    s_add_u32 s34, s32, 8192
    s_waitcnt lgkmcnt(13)
    v_mfma_f32_16x16x32_bf16 v[52:55], a[16:19], a[180:183], v[52:55]
    ds_read_b64_tr_b16 a[206:207], v15 offset:57856
    s_add_u32 s35, s32, 12288
    s_waitcnt lgkmcnt(13)
    v_mfma_f32_16x16x32_bf16 v[56:59], a[160:163], a[20:23], v[56:59]
    ds_read_b128 a[28:31], v13 offset:2048
    v_mov_b32 v18, 0x3e8293ee
    v_mfma_f32_16x16x32_bf16 v[60:63], a[164:167], a[20:23], v[60:63]
    ds_read_b128 a[72:75], v12 offset:4096
    v_mov_b32 v19, 0x3e8293ee
    v_mfma_f32_16x16x32_bf16 v[64:67], a[168:171], a[20:23], v[64:67]
    ds_read_b128 a[76:79], v12 offset:6144
    v_mfma_f32_16x16x32_bf16 v[68:71], a[172:175], a[20:23], v[68:71]
    ds_read_b128 a[80:83], v13 offset:4096
    v_mfma_f32_16x16x32_bf16 v[72:75], a[20:23], a[176:179], v[72:75]
    ds_read_b128 a[84:87], v13 offset:6144
    v_mfma_f32_16x16x32_bf16 v[76:79], a[20:23], a[180:183], v[76:79]
    ds_read_b128 a[0:3], v10 offset:40960
    s_waitcnt lgkmcnt(15)
    v_mfma_f32_16x16x32_bf16 v[32:35], a[184:187], a[24:27], v[32:35]
    ds_read_b128 a[4:7], v10 offset:43008
    s_waitcnt lgkmcnt(15)
    v_mfma_f32_16x16x32_bf16 v[36:39], a[188:191], a[24:27], v[36:39]
    ds_read_b128 a[8:11], v11 offset:40960
    s_waitcnt lgkmcnt(14)
    v_mfma_f32_16x16x32_bf16 v[40:43], a[192:195], a[24:27], v[40:43]
    ds_read_b128 a[12:15], v11 offset:43008
    s_waitcnt lgkmcnt(13)
    v_mfma_f32_16x16x32_bf16 v[44:47], a[196:199], a[24:27], v[44:47]
    ds_read_b128 a[16:19], v12 offset:8192
    s_waitcnt lgkmcnt(12)
    v_mfma_f32_16x16x32_bf16 v[48:51], a[24:27], a[200:203], v[48:51]
    ds_read_b128 a[20:23], v12 offset:10240
    s_waitcnt lgkmcnt(11)
    v_mfma_f32_16x16x32_bf16 v[52:55], a[24:27], a[204:207], v[52:55]
    s_waitcnt lgkmcnt(10)
    v_mfma_f32_16x16x32_bf16 v[56:59], a[184:187], a[28:31], v[56:59]
    ds_read_b128 a[24:27], v13 offset:8192
    v_mfma_f32_16x16x32_bf16 v[60:63], a[188:191], a[28:31], v[60:63]
    v_mfma_f32_16x16x32_bf16 v[64:67], a[192:195], a[28:31], v[64:67]
    v_mfma_f32_16x16x32_bf16 v[68:71], a[196:199], a[28:31], v[68:71]
    v_mfma_f32_16x16x32_bf16 v[72:75], a[28:31], a[200:203], v[72:75]
    v_mfma_f32_16x16x32_bf16 v[76:79], a[28:31], a[204:207], v[76:79]
    v_mfma_f32_16x16x32_bf16 v[80:83], a[112:115], a[56:59], v[80:83]
    ds_read_b128 a[28:31], v13 offset:10240
    v_mfma_f32_16x16x32_bf16 v[84:87], a[116:119], a[56:59], v[84:87]
    v_mfma_f32_16x16x32_bf16 v[104:107], a[112:115], a[60:63], v[104:107]
    s_waitcnt vmcnt(0)
    s_barrier
    v_mfma_f32_16x16x32_bf16 v[108:111], a[116:119], a[60:63], v[108:111]
    ds_read_b128 a[32:35], v10 offset:0
    v_mfma_f32_16x16x32_bf16 v[80:83], a[136:139], a[64:67], v[80:83]
    ds_read_b64_tr_b16 a[208:209], v14 offset:0
    v_mfma_f32_16x16x32_bf16 v[84:87], a[140:143], a[64:67], v[84:87]
    ds_read_b64_tr_b16 a[210:211], v14 offset:512
    v_mfma_f32_16x16x32_bf16 v[104:107], a[136:139], a[68:71], v[104:107]
    ds_read_b64_tr_b16 a[212:213], v15 offset:0
    v_mfma_f32_16x16x32_bf16 v[108:111], a[140:143], a[68:71], v[108:111]
    ds_read_b64_tr_b16 a[214:215], v15 offset:512
    s_waitcnt lgkmcnt(15)
    v_mfma_f32_16x16x32_bf16 v[80:83], a[160:163], a[72:75], v[80:83]
    ds_read_b128 a[36:39], v10 offset:2048
    v_mfma_f32_16x16x32_bf16 v[84:87], a[164:167], a[72:75], v[84:87]
    ds_read_b128 a[40:43], v11 offset:0
    v_mfma_f32_16x16x32_bf16 v[104:107], a[160:163], a[76:79], v[104:107]
    ds_read_b64_tr_b16 a[232:233], v14 offset:12288
    v_mfma_f32_16x16x32_bf16 v[108:111], a[164:167], a[76:79], v[108:111]
    ds_read_b64_tr_b16 a[234:235], v14 offset:12800
    s_waitcnt lgkmcnt(15)
    v_mfma_f32_16x16x32_bf16 v[80:83], a[184:187], a[80:83], v[80:83]
    ds_read_b64_tr_b16 a[236:237], v15 offset:12288
    v_mfma_f32_16x16x32_bf16 v[84:87], a[188:191], a[80:83], v[84:87]
    ds_read_b64_tr_b16 a[238:239], v15 offset:12800
    v_mfma_f32_16x16x32_bf16 v[104:107], a[184:187], a[84:87], v[104:107]
    ds_read_b128 a[44:47], v11 offset:2048
    v_mfma_f32_16x16x32_bf16 v[108:111], a[188:191], a[84:87], v[108:111]
    ds_read_b64_tr_b16 a[216:217], v14 offset:4096
    s_waitcnt lgkmcnt(10)
    v_mfma_f32_16x16x32_bf16 v[32:35], a[208:211], a[32:35], v[32:35]
    ds_read_b64_tr_b16 a[218:219], v14 offset:4608
    s_waitcnt lgkmcnt(9)
    v_mfma_f32_16x16x32_bf16 v[36:39], a[212:215], a[32:35], v[36:39]
    ds_read_b64_tr_b16 a[220:221], v15 offset:4096
    s_waitcnt lgkmcnt(9)
    v_mfma_f32_16x16x32_bf16 v[56:59], a[208:211], a[36:39], v[56:59]
    ds_read_b64_tr_b16 a[222:223], v15 offset:4608
    v_mfma_f32_16x16x32_bf16 v[60:63], a[212:215], a[36:39], v[60:63]
    ds_read_b64_tr_b16 a[240:241], v14 offset:16384
    s_waitcnt lgkmcnt(8)
    v_mfma_f32_16x16x32_bf16 v[32:35], a[232:235], a[40:43], v[32:35]
    ds_read_b64_tr_b16 a[242:243], v14 offset:16896
    s_waitcnt lgkmcnt(7)
    v_mfma_f32_16x16x32_bf16 v[36:39], a[236:239], a[40:43], v[36:39]
    ds_read_b64_tr_b16 a[244:245], v15 offset:16384
    s_waitcnt lgkmcnt(7)
    v_mfma_f32_16x16x32_bf16 v[56:59], a[232:235], a[44:47], v[56:59]
    ds_read_b64_tr_b16 a[246:247], v15 offset:16896
    v_mfma_f32_16x16x32_bf16 v[60:63], a[236:239], a[44:47], v[60:63]
    ds_read_b64_tr_b16 a[224:225], v14 offset:8192
    s_waitcnt lgkmcnt(7)
    v_mfma_f32_16x16x32_bf16 v[40:43], a[216:219], a[32:35], v[40:43]
    ds_read_b64_tr_b16 a[226:227], v14 offset:8704
    s_waitcnt lgkmcnt(6)
    v_mfma_f32_16x16x32_bf16 v[44:47], a[220:223], a[32:35], v[44:47]
    ds_read_b64_tr_b16 a[228:229], v15 offset:8192
    v_mfma_f32_16x16x32_bf16 v[64:67], a[216:219], a[36:39], v[64:67]
    ds_read_b64_tr_b16 a[230:231], v15 offset:8704
    v_pk_mul_f32 v[32:33], v[32:33], v[18:19]
    v_mfma_f32_16x16x32_bf16 v[68:71], a[220:223], a[36:39], v[68:71]
    ds_read_b64_tr_b16 a[248:249], v14 offset:20480
    v_pk_mul_f32 v[34:35], v[34:35], v[18:19]
    s_waitcnt lgkmcnt(7)
    v_mfma_f32_16x16x32_bf16 v[40:43], a[240:243], a[40:43], v[40:43]
    ds_read_b64_tr_b16 a[250:251], v14 offset:20992
    v_pk_mul_f32 v[36:37], v[36:37], v[18:19]
    s_waitcnt lgkmcnt(6)
    v_mfma_f32_16x16x32_bf16 v[44:47], a[244:247], a[40:43], v[44:47]
    ds_read_b64_tr_b16 a[252:253], v15 offset:20480
    v_pk_mul_f32 v[38:39], v[38:39], v[18:19]
    v_mfma_f32_16x16x32_bf16 v[64:67], a[240:243], a[44:47], v[64:67]
    ds_read_b64_tr_b16 a[254:255], v15 offset:20992
    v_cvt_pk_bf16_f32 v32, v32, v33
    v_mfma_f32_16x16x32_bf16 v[68:71], a[244:247], a[44:47], v[68:71]
    ds_read_b128 a[88:91], v10 offset:4096
    v_cvt_pk_bf16_f32 v33, v34, v35
    s_waitcnt lgkmcnt(7)
    v_mfma_f32_16x16x32_bf16 v[48:51], a[32:35], a[224:227], v[48:51]
    ds_read_b128 a[92:95], v10 offset:6144
    v_cvt_pk_bf16_f32 v34, v36, v37
    s_waitcnt lgkmcnt(6)
    v_mfma_f32_16x16x32_bf16 v[52:55], a[32:35], a[228:231], v[52:55]
    ds_read_b128 a[96:99], v11 offset:4096
    v_cvt_pk_bf16_f32 v35, v38, v39
    v_mfma_f32_16x16x32_bf16 v[72:75], a[36:39], a[224:227], v[72:75]
    ds_read_b128 a[100:103], v11 offset:6144
    buffer_store_dwordx4 v[32:35], v4, s[12:15], s30 offen offset:0 sc0 sc1
    v_mfma_f32_16x16x32_bf16 v[76:79], a[36:39], a[228:231], v[76:79]
    ds_read_b128 a[32:35], v10 offset:8192
    v_pk_mul_f32 v[56:57], v[56:57], v[18:19]
    s_waitcnt lgkmcnt(7)
    v_mfma_f32_16x16x32_bf16 v[48:51], a[40:43], a[248:251], v[48:51]
    ds_read_b128 a[36:39], v10 offset:10240
    v_pk_mul_f32 v[58:59], v[58:59], v[18:19]
    s_waitcnt lgkmcnt(6)
    v_mfma_f32_16x16x32_bf16 v[52:55], a[40:43], a[252:255], v[52:55]
    v_pk_mul_f32 v[60:61], v[60:61], v[18:19]
    v_pk_mul_f32 v[62:63], v[62:63], v[18:19]
    v_mfma_f32_16x16x32_bf16 v[72:75], a[44:47], a[248:251], v[72:75]
    ds_read_b128 a[40:43], v11 offset:8192
    v_cvt_pk_bf16_f32 v56, v56, v57
    v_mfma_f32_16x16x32_bf16 v[76:79], a[44:47], a[252:255], v[76:79]
    v_cvt_pk_bf16_f32 v57, v58, v59
    v_cvt_pk_bf16_f32 v58, v60, v61
    s_waitcnt lgkmcnt(6)
    v_mfma_f32_16x16x32_bf16 v[80:83], a[208:211], a[88:91], v[80:83]
    ds_read_b128 a[44:47], v11 offset:10240
    v_cvt_pk_bf16_f32 v59, v62, v63
    v_mfma_f32_16x16x32_bf16 v[84:87], a[212:215], a[88:91], v[84:87]
    buffer_store_dwordx4 v[56:59], v4, s[12:15], s30 offen offset:256 sc0 sc1
    v_cvt_pk_bf16_f32 v40, v40, v41
    s_waitcnt lgkmcnt(6)
    v_mfma_f32_16x16x32_bf16 v[104:107], a[208:211], a[92:95], v[104:107]
    v_cvt_pk_bf16_f32 v41, v42, v43
    v_cvt_pk_bf16_f32 v42, v44, v45
    v_mfma_f32_16x16x32_bf16 v[108:111], a[212:215], a[92:95], v[108:111]
    v_cvt_pk_bf16_f32 v43, v46, v47
    buffer_store_dwordx4 v[40:43], v5, s[12:15], s32 offen offset:0 sc0 sc1
    s_waitcnt lgkmcnt(5)
    v_mfma_f32_16x16x32_bf16 v[80:83], a[232:235], a[96:99], v[80:83]
    v_cvt_pk_bf16_f32 v64, v64, v65
    v_cvt_pk_bf16_f32 v65, v66, v67
    v_mfma_f32_16x16x32_bf16 v[84:87], a[236:239], a[96:99], v[84:87]
    v_cvt_pk_bf16_f32 v66, v68, v69
    v_cvt_pk_bf16_f32 v67, v70, v71
    s_waitcnt lgkmcnt(4)
    v_mfma_f32_16x16x32_bf16 v[104:107], a[232:235], a[100:103], v[104:107]
    buffer_store_dwordx4 v[64:67], v5, s[12:15], s32 offen offset:128 sc0 sc1
    v_cvt_pk_bf16_f32 v48, v48, v49
    v_mfma_f32_16x16x32_bf16 v[108:111], a[236:239], a[100:103], v[108:111]
    v_cvt_pk_bf16_f32 v49, v50, v51
    v_cvt_pk_bf16_f32 v50, v72, v73
    v_mfma_f32_16x16x32_bf16 v[88:91], a[120:123], a[56:59], v[88:91]
    v_cvt_pk_bf16_f32 v51, v74, v75
    buffer_store_dwordx4 v[48:51], v4, s[12:15], s32 offen offset:2048 sc0 sc1
    v_mfma_f32_16x16x32_bf16 v[92:95], a[124:127], a[56:59], v[92:95]
    v_cvt_pk_bf16_f32 v52, v52, v53
    v_cvt_pk_bf16_f32 v53, v54, v55
    v_mfma_f32_16x16x32_bf16 v[112:115], a[120:123], a[60:63], v[112:115]
    v_cvt_pk_bf16_f32 v54, v76, v77
    v_cvt_pk_bf16_f32 v55, v78, v79
    v_mfma_f32_16x16x32_bf16 v[116:119], a[124:127], a[60:63], v[116:119]
    buffer_store_dwordx4 v[52:55], v4, s[12:15], s32 offen offset:2304 sc0 sc1
    v_pk_mul_f32 v[80:81], v[80:81], v[18:19]
    v_mfma_f32_16x16x32_bf16 v[88:91], a[144:147], a[64:67], v[88:91]
    v_pk_mul_f32 v[82:83], v[82:83], v[18:19]
    v_pk_mul_f32 v[84:85], v[84:85], v[18:19]
    v_mfma_f32_16x16x32_bf16 v[92:95], a[148:151], a[64:67], v[92:95]
    v_pk_mul_f32 v[86:87], v[86:87], v[18:19]
    v_cvt_pk_bf16_f32 v80, v80, v81
    v_mfma_f32_16x16x32_bf16 v[112:115], a[144:147], a[68:71], v[112:115]
    v_cvt_pk_bf16_f32 v81, v82, v83
    v_cvt_pk_bf16_f32 v82, v84, v85
    v_mfma_f32_16x16x32_bf16 v[116:119], a[148:151], a[68:71], v[116:119]
    v_cvt_pk_bf16_f32 v83, v86, v87
    buffer_store_dwordx4 v[80:83], v4, s[12:15], s30 offen offset:2048 sc0 sc1
    v_mfma_f32_16x16x32_bf16 v[88:91], a[168:171], a[72:75], v[88:91]
    v_pk_mul_f32 v[104:105], v[104:105], v[18:19]
    v_pk_mul_f32 v[106:107], v[106:107], v[18:19]
    v_mfma_f32_16x16x32_bf16 v[92:95], a[172:175], a[72:75], v[92:95]
    v_pk_mul_f32 v[108:109], v[108:109], v[18:19]
    v_pk_mul_f32 v[110:111], v[110:111], v[18:19]
    v_mfma_f32_16x16x32_bf16 v[112:115], a[168:171], a[76:79], v[112:115]
    v_cvt_pk_bf16_f32 v104, v104, v105
    v_cvt_pk_bf16_f32 v105, v106, v107
    v_mfma_f32_16x16x32_bf16 v[116:119], a[172:175], a[76:79], v[116:119]
    v_cvt_pk_bf16_f32 v106, v108, v109
    v_cvt_pk_bf16_f32 v107, v110, v111
    v_mfma_f32_16x16x32_bf16 v[88:91], a[192:195], a[80:83], v[88:91]
    buffer_store_dwordx4 v[104:107], v4, s[12:15], s30 offen offset:2304 sc0 sc1
    v_mfma_f32_16x16x32_bf16 v[92:95], a[196:199], a[80:83], v[92:95]
    v_mfma_f32_16x16x32_bf16 v[112:115], a[192:195], a[84:87], v[112:115]
    v_mfma_f32_16x16x32_bf16 v[116:119], a[196:199], a[84:87], v[116:119]
    v_mfma_f32_16x16x32_bf16 v[88:91], a[216:219], a[88:91], v[88:91]
    v_mfma_f32_16x16x32_bf16 v[92:95], a[220:223], a[88:91], v[92:95]
    v_mfma_f32_16x16x32_bf16 v[112:115], a[216:219], a[92:95], v[112:115]
    v_mfma_f32_16x16x32_bf16 v[116:119], a[220:223], a[92:95], v[116:119]
    v_mfma_f32_16x16x32_bf16 v[88:91], a[240:243], a[96:99], v[88:91]
    v_mfma_f32_16x16x32_bf16 v[92:95], a[244:247], a[96:99], v[92:95]
    v_mfma_f32_16x16x32_bf16 v[112:115], a[240:243], a[100:103], v[112:115]
    v_mfma_f32_16x16x32_bf16 v[116:119], a[244:247], a[100:103], v[116:119]
    v_mfma_f32_16x16x32_bf16 v[96:99], a[56:59], a[128:131], v[96:99]
    v_mfma_f32_16x16x32_bf16 v[100:103], a[56:59], a[132:135], v[100:103]
    v_mfma_f32_16x16x32_bf16 v[120:123], a[60:63], a[128:131], v[120:123]
    ds_read_b128 a[56:59], v10 offset:45056
    v_cvt_pk_bf16_f32 v88, v88, v89
    v_mfma_f32_16x16x32_bf16 v[124:127], a[60:63], a[132:135], v[124:127]
    v_cvt_pk_bf16_f32 v89, v90, v91
    v_cvt_pk_bf16_f32 v90, v92, v93
    v_mfma_f32_16x16x32_bf16 v[96:99], a[64:67], a[152:155], v[96:99]
    ds_read_b128 a[60:63], v10 offset:47104
    v_cvt_pk_bf16_f32 v91, v94, v95
    v_mfma_f32_16x16x32_bf16 v[100:103], a[64:67], a[156:159], v[100:103]
    buffer_store_dwordx4 v[88:91], v5, s[12:15], s33 offen offset:0 sc0 sc1
    v_cvt_pk_bf16_f32 v112, v112, v113
    v_mfma_f32_16x16x32_bf16 v[120:123], a[68:71], a[152:155], v[120:123]
    ds_read_b128 a[64:67], v11 offset:45056
    v_cvt_pk_bf16_f32 v113, v114, v115
    v_mfma_f32_16x16x32_bf16 v[124:127], a[68:71], a[156:159], v[124:127]
    v_cvt_pk_bf16_f32 v114, v116, v117
    v_cvt_pk_bf16_f32 v115, v118, v119
    v_mfma_f32_16x16x32_bf16 v[96:99], a[72:75], a[176:179], v[96:99]
    ds_read_b128 a[68:71], v11 offset:47104
    buffer_store_dwordx4 v[112:115], v5, s[12:15], s33 offen offset:128 sc0 sc1
    v_mfma_f32_16x16x32_bf16 v[100:103], a[72:75], a[180:183], v[100:103]
    v_mfma_f32_16x16x32_bf16 v[120:123], a[76:79], a[176:179], v[120:123]
    ds_read_b128 a[72:75], v12 offset:12288
    v_mfma_f32_16x16x32_bf16 v[124:127], a[76:79], a[180:183], v[124:127]
    v_mfma_f32_16x16x32_bf16 v[96:99], a[80:83], a[200:203], v[96:99]
    ds_read_b128 a[76:79], v12 offset:14336
    v_mfma_f32_16x16x32_bf16 v[100:103], a[80:83], a[204:207], v[100:103]
    v_mfma_f32_16x16x32_bf16 v[120:123], a[84:87], a[200:203], v[120:123]
    ds_read_b128 a[80:83], v13 offset:12288
    v_mfma_f32_16x16x32_bf16 v[124:127], a[84:87], a[204:207], v[124:127]
    v_mfma_f32_16x16x32_bf16 v[96:99], a[88:91], a[224:227], v[96:99]
    ds_read_b128 a[84:87], v13 offset:14336
    v_mfma_f32_16x16x32_bf16 v[100:103], a[88:91], a[228:231], v[100:103]
    v_mfma_f32_16x16x32_bf16 v[120:123], a[92:95], a[224:227], v[120:123]
    ds_read_b128 a[88:91], v10 offset:12288
    v_mfma_f32_16x16x32_bf16 v[124:127], a[92:95], a[228:231], v[124:127]
    v_mfma_f32_16x16x32_bf16 v[96:99], a[96:99], a[248:251], v[96:99]
    ds_read_b128 a[92:95], v10 offset:14336
    v_mfma_f32_16x16x32_bf16 v[100:103], a[96:99], a[252:255], v[100:103]
    v_mfma_f32_16x16x32_bf16 v[120:123], a[100:103], a[248:251], v[120:123]
    ds_read_b128 a[96:99], v11 offset:12288
    v_mfma_f32_16x16x32_bf16 v[124:127], a[100:103], a[252:255], v[124:127]
    v_mfma_f32_16x16x32_bf16 v[128:131], a[112:115], a[0:3], v[128:131]
    ds_read_b128 a[100:103], v11 offset:14336
    v_mfma_f32_16x16x32_bf16 v[132:135], a[116:119], a[0:3], v[132:135]
    v_mfma_f32_16x16x32_bf16 v[152:155], a[112:115], a[4:7], v[152:155]
    v_cvt_pk_bf16_f32 v96, v96, v97
    v_cvt_pk_bf16_f32 v97, v98, v99
    v_mfma_f32_16x16x32_bf16 v[156:159], a[116:119], a[4:7], v[156:159]
    v_cvt_pk_bf16_f32 v98, v120, v121
    v_cvt_pk_bf16_f32 v99, v122, v123
    v_mfma_f32_16x16x32_bf16 v[128:131], a[136:139], a[8:11], v[128:131]
    buffer_store_dwordx4 v[96:99], v4, s[12:15], s33 offen offset:2048 sc0 sc1
    v_cvt_pk_bf16_f32 v100, v100, v101
    v_mfma_f32_16x16x32_bf16 v[132:135], a[140:143], a[8:11], v[132:135]
    v_cvt_pk_bf16_f32 v101, v102, v103
    v_cvt_pk_bf16_f32 v102, v124, v125
    v_mfma_f32_16x16x32_bf16 v[152:155], a[136:139], a[12:15], v[152:155]
    v_cvt_pk_bf16_f32 v103, v126, v127
    buffer_store_dwordx4 v[100:103], v4, s[12:15], s33 offen offset:2304 sc0 sc1
    v_mfma_f32_16x16x32_bf16 v[156:159], a[140:143], a[12:15], v[156:159]
    v_mfma_f32_16x16x32_bf16 v[128:131], a[160:163], a[16:19], v[128:131]
    v_mfma_f32_16x16x32_bf16 v[132:135], a[164:167], a[16:19], v[132:135]
    v_mfma_f32_16x16x32_bf16 v[152:155], a[160:163], a[20:23], v[152:155]
    v_mfma_f32_16x16x32_bf16 v[156:159], a[164:167], a[20:23], v[156:159]
    v_mfma_f32_16x16x32_bf16 v[128:131], a[184:187], a[24:27], v[128:131]
    v_mfma_f32_16x16x32_bf16 v[132:135], a[188:191], a[24:27], v[132:135]
    v_mfma_f32_16x16x32_bf16 v[152:155], a[184:187], a[28:31], v[152:155]
    v_mfma_f32_16x16x32_bf16 v[156:159], a[188:191], a[28:31], v[156:159]
    s_waitcnt lgkmcnt(15)
    v_mfma_f32_16x16x32_bf16 v[128:131], a[208:211], a[32:35], v[128:131]
    v_mfma_f32_16x16x32_bf16 v[132:135], a[212:215], a[32:35], v[132:135]
    s_waitcnt lgkmcnt(14)
    v_mfma_f32_16x16x32_bf16 v[152:155], a[208:211], a[36:39], v[152:155]
    v_mfma_f32_16x16x32_bf16 v[156:159], a[212:215], a[36:39], v[156:159]
    s_waitcnt lgkmcnt(13)
    v_mfma_f32_16x16x32_bf16 v[128:131], a[232:235], a[40:43], v[128:131]
    v_mfma_f32_16x16x32_bf16 v[132:135], a[236:239], a[40:43], v[132:135]
    s_waitcnt lgkmcnt(12)
    v_mfma_f32_16x16x32_bf16 v[152:155], a[232:235], a[44:47], v[152:155]
    v_mfma_f32_16x16x32_bf16 v[156:159], a[236:239], a[44:47], v[156:159]
    v_mfma_f32_16x16x32_bf16 v[136:139], a[120:123], a[0:3], v[136:139]
    v_mfma_f32_16x16x32_bf16 v[140:143], a[124:127], a[0:3], v[140:143]
    v_mfma_f32_16x16x32_bf16 v[160:163], a[120:123], a[4:7], v[160:163]
    v_pk_mul_f32 v[128:129], v[128:129], v[18:19]
    v_pk_mul_f32 v[130:131], v[130:131], v[18:19]
    v_mfma_f32_16x16x32_bf16 v[164:167], a[124:127], a[4:7], v[164:167]
    v_pk_mul_f32 v[132:133], v[132:133], v[18:19]
    v_pk_mul_f32 v[134:135], v[134:135], v[18:19]
    v_mfma_f32_16x16x32_bf16 v[136:139], a[144:147], a[8:11], v[136:139]
    v_cvt_pk_bf16_f32 v128, v128, v129
    v_cvt_pk_bf16_f32 v129, v130, v131
    v_mfma_f32_16x16x32_bf16 v[140:143], a[148:151], a[8:11], v[140:143]
    v_cvt_pk_bf16_f32 v130, v132, v133
    v_cvt_pk_bf16_f32 v131, v134, v135
    v_mfma_f32_16x16x32_bf16 v[160:163], a[144:147], a[12:15], v[160:163]
    buffer_store_dwordx4 v[128:131], v4, s[12:15], s31 offen offset:0 sc0 sc1
    v_pk_mul_f32 v[152:153], v[152:153], v[18:19]
    v_mfma_f32_16x16x32_bf16 v[164:167], a[148:151], a[12:15], v[164:167]
    v_pk_mul_f32 v[154:155], v[154:155], v[18:19]
    v_pk_mul_f32 v[156:157], v[156:157], v[18:19]
    v_mfma_f32_16x16x32_bf16 v[136:139], a[168:171], a[16:19], v[136:139]
    v_pk_mul_f32 v[158:159], v[158:159], v[18:19]
    v_cvt_pk_bf16_f32 v152, v152, v153
    v_mfma_f32_16x16x32_bf16 v[140:143], a[172:175], a[16:19], v[140:143]
    v_cvt_pk_bf16_f32 v153, v154, v155
    v_cvt_pk_bf16_f32 v154, v156, v157
    v_mfma_f32_16x16x32_bf16 v[160:163], a[168:171], a[20:23], v[160:163]
    v_cvt_pk_bf16_f32 v155, v158, v159
    buffer_store_dwordx4 v[152:155], v4, s[12:15], s31 offen offset:256 sc0 sc1
    v_mfma_f32_16x16x32_bf16 v[164:167], a[172:175], a[20:23], v[164:167]
    v_mfma_f32_16x16x32_bf16 v[136:139], a[192:195], a[24:27], v[136:139]
    v_mfma_f32_16x16x32_bf16 v[140:143], a[196:199], a[24:27], v[140:143]
    v_mfma_f32_16x16x32_bf16 v[160:163], a[192:195], a[28:31], v[160:163]
    v_mfma_f32_16x16x32_bf16 v[164:167], a[196:199], a[28:31], v[164:167]
    v_mfma_f32_16x16x32_bf16 v[136:139], a[216:219], a[32:35], v[136:139]
    v_mfma_f32_16x16x32_bf16 v[140:143], a[220:223], a[32:35], v[140:143]
    v_mfma_f32_16x16x32_bf16 v[160:163], a[216:219], a[36:39], v[160:163]
    v_mfma_f32_16x16x32_bf16 v[164:167], a[220:223], a[36:39], v[164:167]
    v_mfma_f32_16x16x32_bf16 v[136:139], a[240:243], a[40:43], v[136:139]
    v_mfma_f32_16x16x32_bf16 v[140:143], a[244:247], a[40:43], v[140:143]
    v_mfma_f32_16x16x32_bf16 v[160:163], a[240:243], a[44:47], v[160:163]
    v_mfma_f32_16x16x32_bf16 v[164:167], a[244:247], a[44:47], v[164:167]
    v_mfma_f32_16x16x32_bf16 v[144:147], a[0:3], a[128:131], v[144:147]
    v_mfma_f32_16x16x32_bf16 v[148:151], a[0:3], a[132:135], v[148:151]
    v_mfma_f32_16x16x32_bf16 v[168:171], a[4:7], a[128:131], v[168:171]
    v_cvt_pk_bf16_f32 v136, v136, v137
    v_cvt_pk_bf16_f32 v137, v138, v139
    v_mfma_f32_16x16x32_bf16 v[172:175], a[4:7], a[132:135], v[172:175]
    v_cvt_pk_bf16_f32 v138, v140, v141
    v_cvt_pk_bf16_f32 v139, v142, v143
    v_mfma_f32_16x16x32_bf16 v[144:147], a[8:11], a[152:155], v[144:147]
    buffer_store_dwordx4 v[136:139], v5, s[12:15], s34 offen offset:0 sc0 sc1
    v_cvt_pk_bf16_f32 v160, v160, v161
    v_mfma_f32_16x16x32_bf16 v[148:151], a[8:11], a[156:159], v[148:151]
    v_cvt_pk_bf16_f32 v161, v162, v163
    v_cvt_pk_bf16_f32 v162, v164, v165
    v_mfma_f32_16x16x32_bf16 v[168:171], a[12:15], a[152:155], v[168:171]
    v_cvt_pk_bf16_f32 v163, v166, v167
    buffer_store_dwordx4 v[160:163], v5, s[12:15], s34 offen offset:128 sc0 sc1
    v_mfma_f32_16x16x32_bf16 v[172:175], a[12:15], a[156:159], v[172:175]
    v_mfma_f32_16x16x32_bf16 v[144:147], a[16:19], a[176:179], v[144:147]
    v_mfma_f32_16x16x32_bf16 v[148:151], a[16:19], a[180:183], v[148:151]
    v_mfma_f32_16x16x32_bf16 v[168:171], a[20:23], a[176:179], v[168:171]
    v_mfma_f32_16x16x32_bf16 v[172:175], a[20:23], a[180:183], v[172:175]
    v_mfma_f32_16x16x32_bf16 v[144:147], a[24:27], a[200:203], v[144:147]
    v_mfma_f32_16x16x32_bf16 v[148:151], a[24:27], a[204:207], v[148:151]
    v_mfma_f32_16x16x32_bf16 v[168:171], a[28:31], a[200:203], v[168:171]
    v_mfma_f32_16x16x32_bf16 v[172:175], a[28:31], a[204:207], v[172:175]
    v_mfma_f32_16x16x32_bf16 v[144:147], a[32:35], a[224:227], v[144:147]
    v_mfma_f32_16x16x32_bf16 v[148:151], a[32:35], a[228:231], v[148:151]
    v_mfma_f32_16x16x32_bf16 v[168:171], a[36:39], a[224:227], v[168:171]
    v_mfma_f32_16x16x32_bf16 v[172:175], a[36:39], a[228:231], v[172:175]
    v_mfma_f32_16x16x32_bf16 v[144:147], a[40:43], a[248:251], v[144:147]
    v_mfma_f32_16x16x32_bf16 v[148:151], a[40:43], a[252:255], v[148:151]
    v_mfma_f32_16x16x32_bf16 v[168:171], a[44:47], a[248:251], v[168:171]
    v_mfma_f32_16x16x32_bf16 v[172:175], a[44:47], a[252:255], v[172:175]
    s_waitcnt lgkmcnt(11)
    v_mfma_f32_16x16x32_bf16 v[176:179], a[112:115], a[56:59], v[176:179]
    v_mfma_f32_16x16x32_bf16 v[180:183], a[116:119], a[56:59], v[180:183]
    s_waitcnt lgkmcnt(10)
    v_mfma_f32_16x16x32_bf16 v[200:203], a[112:115], a[60:63], v[200:203]
    v_cvt_pk_bf16_f32 v144, v144, v145
    v_cvt_pk_bf16_f32 v145, v146, v147
    v_mfma_f32_16x16x32_bf16 v[204:207], a[116:119], a[60:63], v[204:207]
    v_cvt_pk_bf16_f32 v146, v168, v169
    v_cvt_pk_bf16_f32 v147, v170, v171
    s_waitcnt lgkmcnt(9)
    v_mfma_f32_16x16x32_bf16 v[176:179], a[136:139], a[64:67], v[176:179]
    buffer_store_dwordx4 v[144:147], v4, s[12:15], s34 offen offset:2048 sc0 sc1
    v_cvt_pk_bf16_f32 v148, v148, v149
    v_mfma_f32_16x16x32_bf16 v[180:183], a[140:143], a[64:67], v[180:183]
    v_cvt_pk_bf16_f32 v149, v150, v151
    v_cvt_pk_bf16_f32 v150, v172, v173
    s_waitcnt lgkmcnt(8)
    v_mfma_f32_16x16x32_bf16 v[200:203], a[136:139], a[68:71], v[200:203]
    v_cvt_pk_bf16_f32 v151, v174, v175
    buffer_store_dwordx4 v[148:151], v4, s[12:15], s34 offen offset:2304 sc0 sc1
    v_mfma_f32_16x16x32_bf16 v[204:207], a[140:143], a[68:71], v[204:207]
    s_waitcnt lgkmcnt(7)
    v_mfma_f32_16x16x32_bf16 v[176:179], a[160:163], a[72:75], v[176:179]
    v_mfma_f32_16x16x32_bf16 v[180:183], a[164:167], a[72:75], v[180:183]
    s_waitcnt lgkmcnt(6)
    v_mfma_f32_16x16x32_bf16 v[200:203], a[160:163], a[76:79], v[200:203]
    v_mfma_f32_16x16x32_bf16 v[204:207], a[164:167], a[76:79], v[204:207]
    s_waitcnt lgkmcnt(5)
    v_mfma_f32_16x16x32_bf16 v[176:179], a[184:187], a[80:83], v[176:179]
    v_mfma_f32_16x16x32_bf16 v[180:183], a[188:191], a[80:83], v[180:183]
    s_waitcnt lgkmcnt(4)
    v_mfma_f32_16x16x32_bf16 v[200:203], a[184:187], a[84:87], v[200:203]
    v_mfma_f32_16x16x32_bf16 v[204:207], a[188:191], a[84:87], v[204:207]
    s_waitcnt lgkmcnt(3)
    v_mfma_f32_16x16x32_bf16 v[176:179], a[208:211], a[88:91], v[176:179]
    v_mfma_f32_16x16x32_bf16 v[180:183], a[212:215], a[88:91], v[180:183]
    s_waitcnt lgkmcnt(2)
    v_mfma_f32_16x16x32_bf16 v[200:203], a[208:211], a[92:95], v[200:203]
    v_mfma_f32_16x16x32_bf16 v[204:207], a[212:215], a[92:95], v[204:207]
    s_waitcnt lgkmcnt(1)
    v_mfma_f32_16x16x32_bf16 v[176:179], a[232:235], a[96:99], v[176:179]
    v_mfma_f32_16x16x32_bf16 v[180:183], a[236:239], a[96:99], v[180:183]
    s_waitcnt lgkmcnt(0)
    v_mfma_f32_16x16x32_bf16 v[200:203], a[232:235], a[100:103], v[200:203]
    v_mfma_f32_16x16x32_bf16 v[204:207], a[236:239], a[100:103], v[204:207]
    v_mfma_f32_16x16x32_bf16 v[184:187], a[120:123], a[56:59], v[184:187]
    v_mfma_f32_16x16x32_bf16 v[188:191], a[124:127], a[56:59], v[188:191]
    v_mfma_f32_16x16x32_bf16 v[208:211], a[120:123], a[60:63], v[208:211]
    v_pk_mul_f32 v[176:177], v[176:177], v[18:19]
    v_pk_mul_f32 v[178:179], v[178:179], v[18:19]
    v_mfma_f32_16x16x32_bf16 v[212:215], a[124:127], a[60:63], v[212:215]
    v_pk_mul_f32 v[180:181], v[180:181], v[18:19]
    v_pk_mul_f32 v[182:183], v[182:183], v[18:19]
    v_mfma_f32_16x16x32_bf16 v[184:187], a[144:147], a[64:67], v[184:187]
    v_cvt_pk_bf16_f32 v176, v176, v177
    v_cvt_pk_bf16_f32 v177, v178, v179
    v_mfma_f32_16x16x32_bf16 v[188:191], a[148:151], a[64:67], v[188:191]
    v_cvt_pk_bf16_f32 v178, v180, v181
    v_cvt_pk_bf16_f32 v179, v182, v183
    v_mfma_f32_16x16x32_bf16 v[208:211], a[144:147], a[68:71], v[208:211]
    buffer_store_dwordx4 v[176:179], v4, s[12:15], s31 offen offset:2048 sc0 sc1
    v_pk_mul_f32 v[200:201], v[200:201], v[18:19]
    v_mfma_f32_16x16x32_bf16 v[212:215], a[148:151], a[68:71], v[212:215]
    v_pk_mul_f32 v[202:203], v[202:203], v[18:19]
    v_pk_mul_f32 v[204:205], v[204:205], v[18:19]
    v_mfma_f32_16x16x32_bf16 v[184:187], a[168:171], a[72:75], v[184:187]
    v_pk_mul_f32 v[206:207], v[206:207], v[18:19]
    v_cvt_pk_bf16_f32 v200, v200, v201
    v_mfma_f32_16x16x32_bf16 v[188:191], a[172:175], a[72:75], v[188:191]
    v_cvt_pk_bf16_f32 v201, v202, v203
    v_cvt_pk_bf16_f32 v202, v204, v205
    v_mfma_f32_16x16x32_bf16 v[208:211], a[168:171], a[76:79], v[208:211]
    v_cvt_pk_bf16_f32 v203, v206, v207
    buffer_store_dwordx4 v[200:203], v4, s[12:15], s31 offen offset:2304 sc0 sc1
    v_mfma_f32_16x16x32_bf16 v[212:215], a[172:175], a[76:79], v[212:215]
    v_mfma_f32_16x16x32_bf16 v[184:187], a[192:195], a[80:83], v[184:187]
    v_mfma_f32_16x16x32_bf16 v[188:191], a[196:199], a[80:83], v[188:191]
    v_mfma_f32_16x16x32_bf16 v[208:211], a[192:195], a[84:87], v[208:211]
    v_mfma_f32_16x16x32_bf16 v[212:215], a[196:199], a[84:87], v[212:215]
    v_mfma_f32_16x16x32_bf16 v[184:187], a[216:219], a[88:91], v[184:187]
    v_mfma_f32_16x16x32_bf16 v[188:191], a[220:223], a[88:91], v[188:191]
    v_mfma_f32_16x16x32_bf16 v[208:211], a[216:219], a[92:95], v[208:211]
    v_mfma_f32_16x16x32_bf16 v[212:215], a[220:223], a[92:95], v[212:215]
    v_mfma_f32_16x16x32_bf16 v[184:187], a[240:243], a[96:99], v[184:187]
    v_mfma_f32_16x16x32_bf16 v[188:191], a[244:247], a[96:99], v[188:191]
    v_mfma_f32_16x16x32_bf16 v[208:211], a[240:243], a[100:103], v[208:211]
    v_mfma_f32_16x16x32_bf16 v[212:215], a[244:247], a[100:103], v[212:215]
    v_mfma_f32_16x16x32_bf16 v[192:195], a[56:59], a[128:131], v[192:195]
    v_mfma_f32_16x16x32_bf16 v[196:199], a[56:59], a[132:135], v[196:199]
    v_mfma_f32_16x16x32_bf16 v[216:219], a[60:63], a[128:131], v[216:219]
    v_cvt_pk_bf16_f32 v184, v184, v185
    v_cvt_pk_bf16_f32 v185, v186, v187
    v_mfma_f32_16x16x32_bf16 v[220:223], a[60:63], a[132:135], v[220:223]
    v_cvt_pk_bf16_f32 v186, v188, v189
    v_cvt_pk_bf16_f32 v187, v190, v191
    v_mfma_f32_16x16x32_bf16 v[192:195], a[64:67], a[152:155], v[192:195]
    buffer_store_dwordx4 v[184:187], v5, s[12:15], s35 offen offset:0 sc0 sc1
    v_cvt_pk_bf16_f32 v208, v208, v209
    v_mfma_f32_16x16x32_bf16 v[196:199], a[64:67], a[156:159], v[196:199]
    v_cvt_pk_bf16_f32 v209, v210, v211
    v_cvt_pk_bf16_f32 v210, v212, v213
    v_mfma_f32_16x16x32_bf16 v[216:219], a[68:71], a[152:155], v[216:219]
    v_cvt_pk_bf16_f32 v211, v214, v215
    buffer_store_dwordx4 v[208:211], v5, s[12:15], s35 offen offset:128 sc0 sc1
    v_mfma_f32_16x16x32_bf16 v[220:223], a[68:71], a[156:159], v[220:223]
    v_mfma_f32_16x16x32_bf16 v[192:195], a[72:75], a[176:179], v[192:195]
    v_mfma_f32_16x16x32_bf16 v[196:199], a[72:75], a[180:183], v[196:199]
    v_mfma_f32_16x16x32_bf16 v[216:219], a[76:79], a[176:179], v[216:219]
    v_mfma_f32_16x16x32_bf16 v[220:223], a[76:79], a[180:183], v[220:223]
    v_mfma_f32_16x16x32_bf16 v[192:195], a[80:83], a[200:203], v[192:195]
    v_mfma_f32_16x16x32_bf16 v[196:199], a[80:83], a[204:207], v[196:199]
    v_mfma_f32_16x16x32_bf16 v[216:219], a[84:87], a[200:203], v[216:219]
    v_mfma_f32_16x16x32_bf16 v[220:223], a[84:87], a[204:207], v[220:223]
    v_mfma_f32_16x16x32_bf16 v[192:195], a[88:91], a[224:227], v[192:195]
    v_mfma_f32_16x16x32_bf16 v[196:199], a[88:91], a[228:231], v[196:199]
    v_mfma_f32_16x16x32_bf16 v[216:219], a[92:95], a[224:227], v[216:219]
    v_mfma_f32_16x16x32_bf16 v[220:223], a[92:95], a[228:231], v[220:223]
    v_mfma_f32_16x16x32_bf16 v[192:195], a[96:99], a[248:251], v[192:195]
    v_mfma_f32_16x16x32_bf16 v[196:199], a[96:99], a[252:255], v[196:199]
    v_mfma_f32_16x16x32_bf16 v[216:219], a[100:103], a[248:251], v[216:219]
    v_mfma_f32_16x16x32_bf16 v[220:223], a[100:103], a[252:255], v[220:223]
    s_nop 0
    s_nop 0
    s_nop 0
    s_nop 0
    s_nop 0
    s_nop 0
    s_nop 0
    s_nop 0
    s_nop 0
    s_nop 0
    s_nop 0
    s_nop 0
    v_cvt_pk_bf16_f32 v192, v192, v193
    v_cvt_pk_bf16_f32 v193, v194, v195
    v_cvt_pk_bf16_f32 v194, v216, v217
    v_cvt_pk_bf16_f32 v195, v218, v219
    buffer_store_dwordx4 v[192:195], v4, s[12:15], s35 offen offset:2048 sc0 sc1
    v_cvt_pk_bf16_f32 v196, v196, v197
    v_cvt_pk_bf16_f32 v197, v198, v199
    v_cvt_pk_bf16_f32 v198, v220, v221
    v_cvt_pk_bf16_f32 v199, v222, v223
    buffer_store_dwordx4 v[196:199], v4, s[12:15], s35 offen offset:2304 sc0 sc1
    s_endpgm
L_qkv_kernel_B:
    s_waitcnt lgkmcnt(15)
    v_mfma_f32_16x16x32_bf16 v[32:35], a[32:35], a[0:3], 1.0
    s_add_u32 s27, s27, 12288
    s_cmp_ge_u32 s27, 61440
    s_cselect_b32 s27, 0, s27
    v_mfma_f32_16x16x32_bf16 v[36:39], a[36:39], a[0:3], 1.0
    s_add_u32 s26, s26, 32768
    s_cmp_ge_u32 s26, 98304
    s_cselect_b32 s26, 0, s26
    s_waitcnt lgkmcnt(13)
    v_mfma_f32_16x16x32_bf16 v[40:43], a[0:3], a[40:43], 1.0
    s_waitcnt lgkmcnt(0)
    s_waitcnt vmcnt(13)
    s_barrier
    v_mfma_f32_16x16x32_bf16 v[44:47], a[0:3], a[44:47], 1.0
    ds_read_b128 a[56:59], v13 offset:0
    s_add_u32 m0, s23, s25
    v_mfma_f32_16x16x32_bf16 v[48:51], a[0:3], a[48:51], 0
    buffer_load_dwordx4 v6, s[8:11], s35 offen offset:0 lds
    v_mfma_f32_16x16x32_bf16 v[52:55], a[0:3], a[52:55], 0
    ds_read_b64_tr_b16 a[88:89], v16 offset:0
    s_add_u32 s25, s25, 12288
    v_mfma_f32_16x16x32_bf16 v[56:59], a[32:35], a[4:7], 1.0
    s_cmp_ge_u32 s25, 61440
    s_cselect_b32 s25, 0, s25
    v_mfma_f32_16x16x32_bf16 v[60:63], a[36:39], a[4:7], 1.0
    ds_read_b64_tr_b16 a[90:91], v16 offset:512
    buffer_load_dwordx4 v7, s[8:11], s35 offen offset:1024 lds
    v_mfma_f32_16x16x32_bf16 v[64:67], a[4:7], a[40:43], 1.0
    s_add_u32 s21, s21, 196608
    v_mfma_f32_16x16x32_bf16 v[68:71], a[4:7], a[44:47], 1.0
    ds_read_b64_tr_b16 a[92:93], v17 offset:0
    v_mfma_f32_16x16x32_bf16 v[72:75], a[4:7], a[48:51], 0
    s_cmp_ge_u32 s21, 6291456
    s_cselect_b32 s21, 0, s21
    v_mfma_f32_16x16x32_bf16 v[76:79], a[4:7], a[52:55], 0
    ds_read_b64_tr_b16 a[94:95], v17 offset:512
    s_sub_u32 s37, s37, 1
    v_mfma_f32_16x16x32_bf16 v[80:83], a[32:35], a[8:11], 1.0
    buffer_load_dwordx4 v8, s[8:11], s35 offen offset:2048 lds
    v_mfma_f32_16x16x32_bf16 v[84:87], a[36:39], a[8:11], 1.0
    ds_read_b64_tr_b16 a[96:97], v16 offset:4096
    v_mfma_f32_16x16x32_bf16 v[88:91], a[8:11], a[40:43], 1.0
    s_cmp_gt_i32 s37, 0
    s_cselect_b32 s35, s21, 0x40000000
    v_mfma_f32_16x16x32_bf16 v[92:95], a[8:11], a[44:47], 1.0
    ds_read_b64_tr_b16 a[98:99], v16 offset:4608
    s_add_u32 m0, s22, s24
    v_mfma_f32_16x16x32_bf16 v[96:99], a[8:11], a[48:51], 0
    buffer_load_dwordx4 v2, s[4:7], s34 offen offset:0 lds
    v_mfma_f32_16x16x32_bf16 v[100:103], a[8:11], a[52:55], 0
    ds_read_b64_tr_b16 a[100:101], v17 offset:4096
    v_mfma_f32_16x16x32_bf16 v[104:107], a[32:35], a[12:15], 1.0
    buffer_load_dwordx4 v3, s[4:7], s34 offen offset:1024 lds
    v_mfma_f32_16x16x32_bf16 v[108:111], a[36:39], a[12:15], 1.0
    ds_read_b64_tr_b16 a[102:103], v17 offset:4608
    v_mfma_f32_16x16x32_bf16 v[112:115], a[12:15], a[40:43], 1.0
    buffer_load_dwordx4 v4, s[4:7], s34 offen offset:2048 lds
    v_mfma_f32_16x16x32_bf16 v[116:119], a[12:15], a[44:47], 1.0
    ds_read_b64_tr_b16 a[104:105], v16 offset:8192
    v_mfma_f32_16x16x32_bf16 v[120:123], a[12:15], a[48:51], 0
    buffer_load_dwordx4 v5, s[4:7], s34 offen offset:3072 lds
    v_mfma_f32_16x16x32_bf16 v[124:127], a[12:15], a[52:55], 0
    ds_read_b64_tr_b16 a[106:107], v16 offset:8704
    s_add_u32 m0, s57, s24
    v_mfma_f32_16x16x32_bf16 v[128:131], a[32:35], a[16:19], 1.0
    buffer_load_dwordx4 v2, s[4:7], s38 offen offset:0 lds
    v_mfma_f32_16x16x32_bf16 v[132:135], a[36:39], a[16:19], 1.0
    ds_read_b64_tr_b16 a[108:109], v17 offset:8192
    s_add_u32 s24, s24, 32768
    v_mfma_f32_16x16x32_bf16 v[136:139], a[16:19], a[40:43], 1.0
    s_cmp_ge_u32 s24, 98304
    s_cselect_b32 s24, 0, s24
    v_mfma_f32_16x16x32_bf16 v[140:143], a[16:19], a[44:47], 1.0
    ds_read_b64_tr_b16 a[110:111], v17 offset:8704
    buffer_load_dwordx4 v3, s[4:7], s38 offen offset:1024 lds
    v_mfma_f32_16x16x32_bf16 v[144:147], a[16:19], a[48:51], 0
    s_add_u32 s20, s20, 128
    s_and_b32 s20, s20, 2047
    v_mfma_f32_16x16x32_bf16 v[148:151], a[16:19], a[52:55], 0
    ds_read_b128 a[60:63], v13 offset:2048
    s_sub_u32 s36, s36, 1
    v_mfma_f32_16x16x32_bf16 v[152:155], a[32:35], a[20:23], 1.0
    buffer_load_dwordx4 v4, s[4:7], s38 offen offset:2048 lds
    v_mfma_f32_16x16x32_bf16 v[156:159], a[36:39], a[20:23], 1.0
    ds_read_b128 a[64:67], v13 offset:4096
    v_mfma_f32_16x16x32_bf16 v[160:163], a[20:23], a[40:43], 1.0
    s_cmp_gt_i32 s36, 0
    s_cselect_b32 s34, s20, 0x40000000
    v_mfma_f32_16x16x32_bf16 v[164:167], a[20:23], a[44:47], 1.0
    ds_read_b128 a[68:71], v13 offset:6144
    buffer_load_dwordx4 v5, s[4:7], s38 offen offset:3072 lds
    v_mfma_f32_16x16x32_bf16 v[168:171], a[20:23], a[48:51], 0
    s_add_u32 s38, s34, 65536
    s_add_u32 m0, s23, s25
    v_mfma_f32_16x16x32_bf16 v[172:175], a[20:23], a[52:55], 0
    ds_read_b128 a[72:75], v13 offset:8192
    buffer_load_dwordx4 v6, s[8:11], s35 offen offset:0 lds
    v_mfma_f32_16x16x32_bf16 v[176:179], a[32:35], a[24:27], 1.0
    s_add_u32 s25, s25, 12288
    v_mfma_f32_16x16x32_bf16 v[180:183], a[36:39], a[24:27], 1.0
    ds_read_b128 a[76:79], v13 offset:10240
    v_mfma_f32_16x16x32_bf16 v[184:187], a[24:27], a[40:43], 1.0
    s_cmp_ge_u32 s25, 61440
    s_cselect_b32 s25, 0, s25
    v_mfma_f32_16x16x32_bf16 v[188:191], a[24:27], a[44:47], 1.0
    ds_read_b128 a[80:83], v13 offset:12288
    buffer_load_dwordx4 v7, s[8:11], s35 offen offset:1024 lds
    v_mfma_f32_16x16x32_bf16 v[192:195], a[24:27], a[48:51], 0
    s_add_u32 s21, s21, 196608
    v_mfma_f32_16x16x32_bf16 v[196:199], a[24:27], a[52:55], 0
    ds_read_b128 a[84:87], v13 offset:14336
    v_mfma_f32_16x16x32_bf16 v[200:203], a[32:35], a[28:31], 1.0
    v_add_u32 v16, s27, v14
    v_add_u32 v17, s27, v15
    v_mfma_f32_16x16x32_bf16 v[204:207], a[36:39], a[28:31], 1.0
    v_add_u32 v12, s26, v10
    v_add_u32 v13, s26, v11
    v_mfma_f32_16x16x32_bf16 v[208:211], a[28:31], a[40:43], 1.0
    s_cmp_ge_u32 s21, 6291456
    s_cselect_b32 s21, 0, s21
    v_mfma_f32_16x16x32_bf16 v[212:215], a[28:31], a[44:47], 1.0
    s_sub_u32 s37, s37, 1
    buffer_load_dwordx4 v8, s[8:11], s35 offen offset:2048 lds
    v_mfma_f32_16x16x32_bf16 v[216:219], a[28:31], a[48:51], 0
    s_cmp_gt_i32 s37, 0
    s_cselect_b32 s35, s21, 0x40000000
    v_mfma_f32_16x16x32_bf16 v[220:223], a[28:31], a[52:55], 0
    s_add_u32 m0, s23, s25
    s_nop 0
    buffer_load_dwordx4 v6, s[8:11], s35 offen offset:0 lds
    s_waitcnt lgkmcnt(15)
    v_mfma_f32_16x16x32_bf16 v[32:35], a[88:91], a[56:59], v[32:35]
    s_add_u32 s27, s27, 12288
    s_cmp_ge_u32 s27, 61440
    s_cselect_b32 s27, 0, s27
    v_mfma_f32_16x16x32_bf16 v[36:39], a[92:95], a[56:59], v[36:39]
    s_waitcnt lgkmcnt(13)
    v_mfma_f32_16x16x32_bf16 v[40:43], a[56:59], a[96:99], v[40:43]
    s_waitcnt lgkmcnt(0)
    s_waitcnt vmcnt(17)
    s_barrier
    v_mfma_f32_16x16x32_bf16 v[44:47], a[56:59], a[100:103], v[44:47]
    ds_read_b128 a[0:3], v12 offset:0
    s_add_u32 s25, s25, 12288
    v_mfma_f32_16x16x32_bf16 v[48:51], a[56:59], a[104:107], v[48:51]
    s_cmp_ge_u32 s25, 61440
    s_cselect_b32 s25, 0, s25
    v_mfma_f32_16x16x32_bf16 v[52:55], a[56:59], a[108:111], v[52:55]
    ds_read_b64_tr_b16 a[32:33], v16 offset:0
    buffer_load_dwordx4 v7, s[8:11], s35 offen offset:1024 lds
    v_mfma_f32_16x16x32_bf16 v[56:59], a[88:91], a[60:63], v[56:59]
    s_add_u32 s21, s21, 196608
    v_mfma_f32_16x16x32_bf16 v[60:63], a[92:95], a[60:63], v[60:63]
    ds_read_b64_tr_b16 a[34:35], v16 offset:512
    v_mfma_f32_16x16x32_bf16 v[64:67], a[60:63], a[96:99], v[64:67]
    s_cmp_ge_u32 s21, 6291456
    s_cselect_b32 s21, 0, s21
    v_mfma_f32_16x16x32_bf16 v[68:71], a[60:63], a[100:103], v[68:71]
    ds_read_b64_tr_b16 a[36:37], v17 offset:0
    s_sub_u32 s37, s37, 1
    v_mfma_f32_16x16x32_bf16 v[72:75], a[60:63], a[104:107], v[72:75]
    buffer_load_dwordx4 v8, s[8:11], s35 offen offset:2048 lds
    v_mfma_f32_16x16x32_bf16 v[76:79], a[60:63], a[108:111], v[76:79]
    ds_read_b64_tr_b16 a[38:39], v17 offset:512
    v_mfma_f32_16x16x32_bf16 v[80:83], a[88:91], a[64:67], v[80:83]
    s_cmp_gt_i32 s37, 0
    s_cselect_b32 s35, s21, 0x40000000
    v_mfma_f32_16x16x32_bf16 v[84:87], a[92:95], a[64:67], v[84:87]
    ds_read_b64_tr_b16 a[40:41], v16 offset:4096
    s_add_u32 m0, s23, s25
    v_mfma_f32_16x16x32_bf16 v[88:91], a[64:67], a[96:99], v[88:91]
    buffer_load_dwordx4 v6, s[8:11], s35 offen offset:0 lds
    v_mfma_f32_16x16x32_bf16 v[92:95], a[64:67], a[100:103], v[92:95]
    ds_read_b64_tr_b16 a[42:43], v16 offset:4608
    s_add_u32 s25, s25, 12288
    v_mfma_f32_16x16x32_bf16 v[96:99], a[64:67], a[104:107], v[96:99]
    s_cmp_ge_u32 s25, 61440
    s_cselect_b32 s25, 0, s25
    v_mfma_f32_16x16x32_bf16 v[100:103], a[64:67], a[108:111], v[100:103]
    ds_read_b64_tr_b16 a[44:45], v17 offset:4096
    buffer_load_dwordx4 v7, s[8:11], s35 offen offset:1024 lds
    v_mfma_f32_16x16x32_bf16 v[104:107], a[88:91], a[68:71], v[104:107]
    s_add_u32 s21, s21, 196608
    v_mfma_f32_16x16x32_bf16 v[108:111], a[92:95], a[68:71], v[108:111]
    ds_read_b64_tr_b16 a[46:47], v17 offset:4608
    v_mfma_f32_16x16x32_bf16 v[112:115], a[68:71], a[96:99], v[112:115]
    s_cmp_ge_u32 s21, 6291456
    s_cselect_b32 s21, 0, s21
    v_mfma_f32_16x16x32_bf16 v[116:119], a[68:71], a[100:103], v[116:119]
    ds_read_b64_tr_b16 a[48:49], v16 offset:8192
    s_sub_u32 s37, s37, 1
    v_mfma_f32_16x16x32_bf16 v[120:123], a[68:71], a[104:107], v[120:123]
    buffer_load_dwordx4 v8, s[8:11], s35 offen offset:2048 lds
    v_mfma_f32_16x16x32_bf16 v[124:127], a[68:71], a[108:111], v[124:127]
    ds_read_b64_tr_b16 a[50:51], v16 offset:8704
    v_mfma_f32_16x16x32_bf16 v[128:131], a[88:91], a[72:75], v[128:131]
    s_cmp_gt_i32 s37, 0
    s_cselect_b32 s35, s21, 0x40000000
    v_mfma_f32_16x16x32_bf16 v[132:135], a[92:95], a[72:75], v[132:135]
    ds_read_b64_tr_b16 a[52:53], v17 offset:8192
    s_add_u32 m0, s22, s24
    v_mfma_f32_16x16x32_bf16 v[136:139], a[72:75], a[96:99], v[136:139]
    buffer_load_dwordx4 v2, s[4:7], s34 offen offset:0 lds
    v_mfma_f32_16x16x32_bf16 v[140:143], a[72:75], a[100:103], v[140:143]
    ds_read_b64_tr_b16 a[54:55], v17 offset:8704
    v_mfma_f32_16x16x32_bf16 v[144:147], a[72:75], a[104:107], v[144:147]
    buffer_load_dwordx4 v3, s[4:7], s34 offen offset:1024 lds
    v_mfma_f32_16x16x32_bf16 v[148:151], a[72:75], a[108:111], v[148:151]
    ds_read_b128 a[4:7], v12 offset:2048
    v_mfma_f32_16x16x32_bf16 v[152:155], a[88:91], a[76:79], v[152:155]
    buffer_load_dwordx4 v4, s[4:7], s34 offen offset:2048 lds
    v_mfma_f32_16x16x32_bf16 v[156:159], a[92:95], a[76:79], v[156:159]
    ds_read_b128 a[8:11], v12 offset:4096
    v_mfma_f32_16x16x32_bf16 v[160:163], a[76:79], a[96:99], v[160:163]
    buffer_load_dwordx4 v5, s[4:7], s34 offen offset:3072 lds
    v_mfma_f32_16x16x32_bf16 v[164:167], a[76:79], a[100:103], v[164:167]
    ds_read_b128 a[12:15], v12 offset:6144
    v_mfma_f32_16x16x32_bf16 v[168:171], a[76:79], a[104:107], v[168:171]
    buffer_load_dword v28, v26, s[8:11], s65 offen
    v_mfma_f32_16x16x32_bf16 v[172:175], a[76:79], a[108:111], v[172:175]
    ds_read_b128 a[16:19], v12 offset:8192
    v_mfma_f32_16x16x32_bf16 v[176:179], a[88:91], a[80:83], v[176:179]
    v_mfma_f32_16x16x32_bf16 v[180:183], a[92:95], a[80:83], v[180:183]
    ds_read_b128 a[20:23], v12 offset:10240
    v_mfma_f32_16x16x32_bf16 v[184:187], a[80:83], a[96:99], v[184:187]
    v_mfma_f32_16x16x32_bf16 v[188:191], a[80:83], a[100:103], v[188:191]
    ds_read_b128 a[24:27], v12 offset:12288
    v_mfma_f32_16x16x32_bf16 v[192:195], a[80:83], a[104:107], v[192:195]
    v_mfma_f32_16x16x32_bf16 v[196:199], a[80:83], a[108:111], v[196:199]
    ds_read_b128 a[28:31], v12 offset:14336
    v_mfma_f32_16x16x32_bf16 v[200:203], a[88:91], a[84:87], v[200:203]
    v_add_u32 v16, s27, v14
    v_add_u32 v17, s27, v15
    v_mfma_f32_16x16x32_bf16 v[204:207], a[92:95], a[84:87], v[204:207]
    v_mfma_f32_16x16x32_bf16 v[208:211], a[84:87], a[96:99], v[208:211]
    v_mfma_f32_16x16x32_bf16 v[212:215], a[84:87], a[100:103], v[212:215]
    v_mfma_f32_16x16x32_bf16 v[216:219], a[84:87], a[104:107], v[216:219]
    v_mfma_f32_16x16x32_bf16 v[220:223], a[84:87], a[108:111], v[220:223]
    s_waitcnt lgkmcnt(15)
    v_mfma_f32_16x16x32_bf16 v[32:35], a[32:35], a[0:3], v[32:35]
    s_add_u32 s27, s27, 12288
    s_cmp_ge_u32 s27, 61440
    s_cselect_b32 s27, 0, s27
    v_mfma_f32_16x16x32_bf16 v[36:39], a[36:39], a[0:3], v[36:39]
    s_add_u32 s26, s26, 32768
    s_cmp_ge_u32 s26, 98304
    s_cselect_b32 s26, 0, s26
    s_waitcnt lgkmcnt(13)
    v_mfma_f32_16x16x32_bf16 v[40:43], a[0:3], a[40:43], v[40:43]
    s_waitcnt lgkmcnt(0)
    s_waitcnt vmcnt(22)
    s_barrier
    v_mfma_f32_16x16x32_bf16 v[44:47], a[0:3], a[44:47], v[44:47]
    ds_read_b128 a[56:59], v13 offset:0
    s_add_u32 m0, s23, s25
    v_mfma_f32_16x16x32_bf16 v[48:51], a[0:3], a[48:51], v[48:51]
    buffer_load_dwordx4 v6, s[8:11], s35 offen offset:0 lds
    v_mfma_f32_16x16x32_bf16 v[52:55], a[0:3], a[52:55], v[52:55]
    ds_read_b64_tr_b16 a[88:89], v16 offset:0
    s_add_u32 s25, s25, 12288
    v_mfma_f32_16x16x32_bf16 v[56:59], a[32:35], a[4:7], v[56:59]
    s_cmp_ge_u32 s25, 61440
    s_cselect_b32 s25, 0, s25
    v_mfma_f32_16x16x32_bf16 v[60:63], a[36:39], a[4:7], v[60:63]
    ds_read_b64_tr_b16 a[90:91], v16 offset:512
    v_mfma_f32_16x16x32_bf16 v[64:67], a[4:7], a[40:43], v[64:67]
    buffer_load_dwordx4 v7, s[8:11], s35 offen offset:1024 lds
    v_mfma_f32_16x16x32_bf16 v[68:71], a[4:7], a[44:47], v[68:71]
    ds_read_b64_tr_b16 a[92:93], v17 offset:0
    s_add_u32 s21, s21, 196608
    v_mfma_f32_16x16x32_bf16 v[72:75], a[4:7], a[48:51], v[72:75]
    s_cmp_ge_u32 s21, 6291456
    s_cselect_b32 s21, 0, s21
    v_mfma_f32_16x16x32_bf16 v[76:79], a[4:7], a[52:55], v[76:79]
    ds_read_b64_tr_b16 a[94:95], v17 offset:512
    s_sub_u32 s37, s37, 1
    v_mfma_f32_16x16x32_bf16 v[80:83], a[32:35], a[8:11], v[80:83]
    buffer_load_dwordx4 v8, s[8:11], s35 offen offset:2048 lds
    v_mfma_f32_16x16x32_bf16 v[84:87], a[36:39], a[8:11], v[84:87]
    ds_read_b64_tr_b16 a[96:97], v16 offset:4096
    v_mfma_f32_16x16x32_bf16 v[88:91], a[8:11], a[40:43], v[88:91]
    s_cmp_gt_i32 s37, 0
    s_cselect_b32 s35, s21, 0x40000000
    v_mfma_f32_16x16x32_bf16 v[92:95], a[8:11], a[44:47], v[92:95]
    ds_read_b64_tr_b16 a[98:99], v16 offset:4608
    s_add_u32 m0, s57, s24
    v_mfma_f32_16x16x32_bf16 v[96:99], a[8:11], a[48:51], v[96:99]
    buffer_load_dwordx4 v2, s[4:7], s38 offen offset:0 lds
    v_mfma_f32_16x16x32_bf16 v[100:103], a[8:11], a[52:55], v[100:103]
    ds_read_b64_tr_b16 a[100:101], v17 offset:4096
    s_add_u32 s24, s24, 32768
    v_mfma_f32_16x16x32_bf16 v[104:107], a[32:35], a[12:15], v[104:107]
    s_cmp_ge_u32 s24, 98304
    s_cselect_b32 s24, 0, s24
    v_mfma_f32_16x16x32_bf16 v[108:111], a[36:39], a[12:15], v[108:111]
    ds_read_b64_tr_b16 a[102:103], v17 offset:4608
    v_mfma_f32_16x16x32_bf16 v[112:115], a[12:15], a[40:43], v[112:115]
    buffer_load_dwordx4 v3, s[4:7], s38 offen offset:1024 lds
    v_mfma_f32_16x16x32_bf16 v[116:119], a[12:15], a[44:47], v[116:119]
    ds_read_b64_tr_b16 a[104:105], v16 offset:8192
    s_add_u32 s20, s20, 128
    v_mfma_f32_16x16x32_bf16 v[120:123], a[12:15], a[48:51], v[120:123]
    s_and_b32 s20, s20, 2047
    s_sub_u32 s36, s36, 1
    v_mfma_f32_16x16x32_bf16 v[124:127], a[12:15], a[52:55], v[124:127]
    ds_read_b64_tr_b16 a[106:107], v16 offset:8704
    v_mfma_f32_16x16x32_bf16 v[128:131], a[32:35], a[16:19], v[128:131]
    buffer_load_dwordx4 v4, s[4:7], s38 offen offset:2048 lds
    v_mfma_f32_16x16x32_bf16 v[132:135], a[36:39], a[16:19], v[132:135]
    ds_read_b64_tr_b16 a[108:109], v17 offset:8192
    v_mfma_f32_16x16x32_bf16 v[136:139], a[16:19], a[40:43], v[136:139]
    s_cmp_gt_i32 s36, 0
    s_cselect_b32 s34, s20, 0x40000000
    v_mfma_f32_16x16x32_bf16 v[140:143], a[16:19], a[44:47], v[140:143]
    ds_read_b64_tr_b16 a[110:111], v17 offset:8704
    v_mfma_f32_16x16x32_bf16 v[144:147], a[16:19], a[48:51], v[144:147]
    buffer_load_dwordx4 v5, s[4:7], s38 offen offset:3072 lds
    v_mfma_f32_16x16x32_bf16 v[148:151], a[16:19], a[52:55], v[148:151]
    ds_read_b128 a[60:63], v13 offset:2048
    s_add_u32 s38, s34, 65536
    v_mfma_f32_16x16x32_bf16 v[152:155], a[32:35], a[20:23], v[152:155]
    v_mfma_f32_16x16x32_bf16 v[156:159], a[36:39], a[20:23], v[156:159]
    ds_read_b128 a[64:67], v13 offset:4096
    v_mfma_f32_16x16x32_bf16 v[160:163], a[20:23], a[40:43], v[160:163]
    buffer_load_dword v28, v26, s[8:11], s66 offen
    v_mfma_f32_16x16x32_bf16 v[164:167], a[20:23], a[44:47], v[164:167]
    ds_read_b128 a[68:71], v13 offset:6144
    v_mfma_f32_16x16x32_bf16 v[168:171], a[20:23], a[48:51], v[168:171]
    v_mfma_f32_16x16x32_bf16 v[172:175], a[20:23], a[52:55], v[172:175]
    ds_read_b128 a[72:75], v13 offset:8192
    v_mfma_f32_16x16x32_bf16 v[176:179], a[32:35], a[24:27], v[176:179]
    buffer_load_dword v28, v27, s[4:7], s69 offen
    v_mfma_f32_16x16x32_bf16 v[180:183], a[36:39], a[24:27], v[180:183]
    ds_read_b128 a[76:79], v13 offset:10240
    v_mfma_f32_16x16x32_bf16 v[184:187], a[24:27], a[40:43], v[184:187]
    v_mfma_f32_16x16x32_bf16 v[188:191], a[24:27], a[44:47], v[188:191]
    ds_read_b128 a[80:83], v13 offset:12288
    v_mfma_f32_16x16x32_bf16 v[192:195], a[24:27], a[48:51], v[192:195]
    v_mfma_f32_16x16x32_bf16 v[196:199], a[24:27], a[52:55], v[196:199]
    ds_read_b128 a[84:87], v13 offset:14336
    v_mfma_f32_16x16x32_bf16 v[200:203], a[32:35], a[28:31], v[200:203]
    v_add_u32 v16, s27, v14
    v_add_u32 v17, s27, v15
    v_mfma_f32_16x16x32_bf16 v[204:207], a[36:39], a[28:31], v[204:207]
    v_add_u32 v12, s26, v10
    v_add_u32 v13, s26, v11
    v_mfma_f32_16x16x32_bf16 v[208:211], a[28:31], a[40:43], v[208:211]
    v_mfma_f32_16x16x32_bf16 v[212:215], a[28:31], a[44:47], v[212:215]
    v_mfma_f32_16x16x32_bf16 v[216:219], a[28:31], a[48:51], v[216:219]
    v_mfma_f32_16x16x32_bf16 v[220:223], a[28:31], a[52:55], v[220:223]
    s_waitcnt lgkmcnt(15)
    v_mfma_f32_16x16x32_bf16 v[32:35], a[88:91], a[56:59], v[32:35]
    s_add_u32 s27, s27, 12288
    s_cmp_ge_u32 s27, 61440
    s_cselect_b32 s27, 0, s27
    v_mfma_f32_16x16x32_bf16 v[36:39], a[92:95], a[56:59], v[36:39]
    s_waitcnt lgkmcnt(13)
    v_mfma_f32_16x16x32_bf16 v[40:43], a[56:59], a[96:99], v[40:43]
    s_waitcnt lgkmcnt(0)
    s_waitcnt vmcnt(20)
    s_barrier
    v_mfma_f32_16x16x32_bf16 v[44:47], a[56:59], a[100:103], v[44:47]
    ds_read_b128 a[0:3], v12 offset:0
    s_add_u32 m0, s23, s25
    v_mfma_f32_16x16x32_bf16 v[48:51], a[56:59], a[104:107], v[48:51]
    buffer_load_dwordx4 v6, s[8:11], s35 offen offset:0 lds
    v_mfma_f32_16x16x32_bf16 v[52:55], a[56:59], a[108:111], v[52:55]
    ds_read_b64_tr_b16 a[32:33], v16 offset:0
    s_add_u32 s25, s25, 12288
    v_mfma_f32_16x16x32_bf16 v[56:59], a[88:91], a[60:63], v[56:59]
    s_cmp_ge_u32 s25, 61440
    s_cselect_b32 s25, 0, s25
    v_mfma_f32_16x16x32_bf16 v[60:63], a[92:95], a[60:63], v[60:63]
    ds_read_b64_tr_b16 a[34:35], v16 offset:512
    v_mfma_f32_16x16x32_bf16 v[64:67], a[60:63], a[96:99], v[64:67]
    buffer_load_dwordx4 v7, s[8:11], s35 offen offset:1024 lds
    v_mfma_f32_16x16x32_bf16 v[68:71], a[60:63], a[100:103], v[68:71]
    ds_read_b64_tr_b16 a[36:37], v17 offset:0
    s_add_u32 s21, s21, 196608
    v_mfma_f32_16x16x32_bf16 v[72:75], a[60:63], a[104:107], v[72:75]
    s_cmp_ge_u32 s21, 6291456
    s_cselect_b32 s21, 0, s21
    v_mfma_f32_16x16x32_bf16 v[76:79], a[60:63], a[108:111], v[76:79]
    ds_read_b64_tr_b16 a[38:39], v17 offset:512
    s_sub_u32 s37, s37, 1
    v_mfma_f32_16x16x32_bf16 v[80:83], a[88:91], a[64:67], v[80:83]
    buffer_load_dwordx4 v8, s[8:11], s35 offen offset:2048 lds
    v_mfma_f32_16x16x32_bf16 v[84:87], a[92:95], a[64:67], v[84:87]
    ds_read_b64_tr_b16 a[40:41], v16 offset:4096
    v_mfma_f32_16x16x32_bf16 v[88:91], a[64:67], a[96:99], v[88:91]
    s_cmp_gt_i32 s37, 0
    s_cselect_b32 s35, s21, 0x40000000
    v_mfma_f32_16x16x32_bf16 v[92:95], a[64:67], a[100:103], v[92:95]
    ds_read_b64_tr_b16 a[42:43], v16 offset:4608
    s_add_u32 m0, s22, s24
    v_mfma_f32_16x16x32_bf16 v[96:99], a[64:67], a[104:107], v[96:99]
    buffer_load_dwordx4 v2, s[4:7], s34 offen offset:0 lds
    v_mfma_f32_16x16x32_bf16 v[100:103], a[64:67], a[108:111], v[100:103]
    ds_read_b64_tr_b16 a[44:45], v17 offset:4096
    v_mfma_f32_16x16x32_bf16 v[104:107], a[88:91], a[68:71], v[104:107]
    v_mfma_f32_16x16x32_bf16 v[108:111], a[92:95], a[68:71], v[108:111]
    ds_read_b64_tr_b16 a[46:47], v17 offset:4608
    v_mfma_f32_16x16x32_bf16 v[112:115], a[68:71], a[96:99], v[112:115]
    buffer_load_dwordx4 v3, s[4:7], s34 offen offset:1024 lds
    v_mfma_f32_16x16x32_bf16 v[116:119], a[68:71], a[100:103], v[116:119]
    ds_read_b64_tr_b16 a[48:49], v16 offset:8192
    v_mfma_f32_16x16x32_bf16 v[120:123], a[68:71], a[104:107], v[120:123]
    v_mfma_f32_16x16x32_bf16 v[124:127], a[68:71], a[108:111], v[124:127]
    ds_read_b64_tr_b16 a[50:51], v16 offset:8704
    v_mfma_f32_16x16x32_bf16 v[128:131], a[88:91], a[72:75], v[128:131]
    buffer_load_dwordx4 v4, s[4:7], s34 offen offset:2048 lds
    v_mfma_f32_16x16x32_bf16 v[132:135], a[92:95], a[72:75], v[132:135]
    ds_read_b64_tr_b16 a[52:53], v17 offset:8192
    v_mfma_f32_16x16x32_bf16 v[136:139], a[72:75], a[96:99], v[136:139]
    v_mfma_f32_16x16x32_bf16 v[140:143], a[72:75], a[100:103], v[140:143]
    ds_read_b64_tr_b16 a[54:55], v17 offset:8704
    v_mfma_f32_16x16x32_bf16 v[144:147], a[72:75], a[104:107], v[144:147]
    buffer_load_dwordx4 v5, s[4:7], s34 offen offset:3072 lds
    v_mfma_f32_16x16x32_bf16 v[148:151], a[72:75], a[108:111], v[148:151]
    ds_read_b128 a[4:7], v12 offset:2048
    v_mfma_f32_16x16x32_bf16 v[152:155], a[88:91], a[76:79], v[152:155]
    v_mfma_f32_16x16x32_bf16 v[156:159], a[92:95], a[76:79], v[156:159]
    ds_read_b128 a[8:11], v12 offset:4096
    v_mfma_f32_16x16x32_bf16 v[160:163], a[76:79], a[96:99], v[160:163]
    buffer_load_dword v28, v26, s[8:11], s67 offen
    v_mfma_f32_16x16x32_bf16 v[164:167], a[76:79], a[100:103], v[164:167]
    ds_read_b128 a[12:15], v12 offset:6144
    v_mfma_f32_16x16x32_bf16 v[168:171], a[76:79], a[104:107], v[168:171]
    v_mfma_f32_16x16x32_bf16 v[172:175], a[76:79], a[108:111], v[172:175]
    ds_read_b128 a[16:19], v12 offset:8192
    v_mfma_f32_16x16x32_bf16 v[176:179], a[88:91], a[80:83], v[176:179]
    v_mfma_f32_16x16x32_bf16 v[180:183], a[92:95], a[80:83], v[180:183]
    ds_read_b128 a[20:23], v12 offset:10240
    v_mfma_f32_16x16x32_bf16 v[184:187], a[80:83], a[96:99], v[184:187]
    v_mfma_f32_16x16x32_bf16 v[188:191], a[80:83], a[100:103], v[188:191]
    ds_read_b128 a[24:27], v12 offset:12288
    v_mfma_f32_16x16x32_bf16 v[192:195], a[80:83], a[104:107], v[192:195]
    v_mfma_f32_16x16x32_bf16 v[196:199], a[80:83], a[108:111], v[196:199]
    ds_read_b128 a[28:31], v12 offset:14336
    v_mfma_f32_16x16x32_bf16 v[200:203], a[88:91], a[84:87], v[200:203]
    v_add_u32 v16, s27, v14
    v_add_u32 v17, s27, v15
    v_mfma_f32_16x16x32_bf16 v[204:207], a[92:95], a[84:87], v[204:207]
    v_mfma_f32_16x16x32_bf16 v[208:211], a[84:87], a[96:99], v[208:211]
    v_mfma_f32_16x16x32_bf16 v[212:215], a[84:87], a[100:103], v[212:215]
    v_mfma_f32_16x16x32_bf16 v[216:219], a[84:87], a[104:107], v[216:219]
    v_mfma_f32_16x16x32_bf16 v[220:223], a[84:87], a[108:111], v[220:223]
    s_mov_b32 s39, 10
L_qkv_kernel_loopB:
    s_waitcnt lgkmcnt(15)
    v_mfma_f32_16x16x32_bf16 v[32:35], a[32:35], a[0:3], v[32:35]
    s_add_u32 s27, s27, 12288
    s_cmp_ge_u32 s27, 61440
    s_cselect_b32 s27, 0, s27
    v_mfma_f32_16x16x32_bf16 v[36:39], a[36:39], a[0:3], v[36:39]
    s_add_u32 s26, s26, 32768
    s_cmp_ge_u32 s26, 98304
    s_cselect_b32 s26, 0, s26
    s_waitcnt lgkmcnt(13)
    v_mfma_f32_16x16x32_bf16 v[40:43], a[0:3], a[40:43], v[40:43]
    s_waitcnt lgkmcnt(0)
    s_waitcnt vmcnt(25)
    s_barrier
    v_mfma_f32_16x16x32_bf16 v[44:47], a[0:3], a[44:47], v[44:47]
    ds_read_b128 a[56:59], v13 offset:0
    s_add_u32 m0, s23, s25
    v_mfma_f32_16x16x32_bf16 v[48:51], a[0:3], a[48:51], v[48:51]
    buffer_load_dwordx4 v6, s[8:11], s35 offen offset:0 lds
    v_mfma_f32_16x16x32_bf16 v[52:55], a[0:3], a[52:55], v[52:55]
    ds_read_b64_tr_b16 a[88:89], v16 offset:0
    s_add_u32 s25, s25, 12288
    v_mfma_f32_16x16x32_bf16 v[56:59], a[32:35], a[4:7], v[56:59]
    s_cmp_ge_u32 s25, 61440
    s_cselect_b32 s25, 0, s25
    v_mfma_f32_16x16x32_bf16 v[60:63], a[36:39], a[4:7], v[60:63]
    ds_read_b64_tr_b16 a[90:91], v16 offset:512
    v_mfma_f32_16x16x32_bf16 v[64:67], a[4:7], a[40:43], v[64:67]
    v_mfma_f32_16x16x32_bf16 v[68:71], a[4:7], a[44:47], v[68:71]
    ds_read_b64_tr_b16 a[92:93], v17 offset:0
    v_mfma_f32_16x16x32_bf16 v[72:75], a[4:7], a[48:51], v[72:75]
    buffer_load_dwordx4 v7, s[8:11], s35 offen offset:1024 lds
    v_mfma_f32_16x16x32_bf16 v[76:79], a[4:7], a[52:55], v[76:79]
    ds_read_b64_tr_b16 a[94:95], v17 offset:512
    s_add_u32 s21, s21, 196608
    v_mfma_f32_16x16x32_bf16 v[80:83], a[32:35], a[8:11], v[80:83]
    s_cmp_ge_u32 s21, 6291456
    s_cselect_b32 s21, 0, s21
    v_mfma_f32_16x16x32_bf16 v[84:87], a[36:39], a[8:11], v[84:87]
    ds_read_b64_tr_b16 a[96:97], v16 offset:4096
    s_sub_u32 s37, s37, 1
    v_mfma_f32_16x16x32_bf16 v[88:91], a[8:11], a[40:43], v[88:91]
    v_mfma_f32_16x16x32_bf16 v[92:95], a[8:11], a[44:47], v[92:95]
    ds_read_b64_tr_b16 a[98:99], v16 offset:4608
    v_mfma_f32_16x16x32_bf16 v[96:99], a[8:11], a[48:51], v[96:99]
    buffer_load_dwordx4 v8, s[8:11], s35 offen offset:2048 lds
    v_mfma_f32_16x16x32_bf16 v[100:103], a[8:11], a[52:55], v[100:103]
    ds_read_b64_tr_b16 a[100:101], v17 offset:4096
    v_mfma_f32_16x16x32_bf16 v[104:107], a[32:35], a[12:15], v[104:107]
    s_cmp_gt_i32 s37, 0
    s_cselect_b32 s35, s21, 0x40000000
    v_mfma_f32_16x16x32_bf16 v[108:111], a[36:39], a[12:15], v[108:111]
    ds_read_b64_tr_b16 a[102:103], v17 offset:4608
    s_add_u32 m0, s57, s24
    v_mfma_f32_16x16x32_bf16 v[112:115], a[12:15], a[40:43], v[112:115]
    v_mfma_f32_16x16x32_bf16 v[116:119], a[12:15], a[44:47], v[116:119]
    ds_read_b64_tr_b16 a[104:105], v16 offset:8192
    v_mfma_f32_16x16x32_bf16 v[120:123], a[12:15], a[48:51], v[120:123]
    buffer_load_dwordx4 v2, s[4:7], s38 offen offset:0 lds
    v_mfma_f32_16x16x32_bf16 v[124:127], a[12:15], a[52:55], v[124:127]
    ds_read_b64_tr_b16 a[106:107], v16 offset:8704
    s_add_u32 s24, s24, 32768
    v_mfma_f32_16x16x32_bf16 v[128:131], a[32:35], a[16:19], v[128:131]
    s_cmp_ge_u32 s24, 98304
    s_cselect_b32 s24, 0, s24
    v_mfma_f32_16x16x32_bf16 v[132:135], a[36:39], a[16:19], v[132:135]
    ds_read_b64_tr_b16 a[108:109], v17 offset:8192
    v_mfma_f32_16x16x32_bf16 v[136:139], a[16:19], a[40:43], v[136:139]
    v_mfma_f32_16x16x32_bf16 v[140:143], a[16:19], a[44:47], v[140:143]
    ds_read_b64_tr_b16 a[110:111], v17 offset:8704
    v_mfma_f32_16x16x32_bf16 v[144:147], a[16:19], a[48:51], v[144:147]
    buffer_load_dwordx4 v3, s[4:7], s38 offen offset:1024 lds
    v_mfma_f32_16x16x32_bf16 v[148:151], a[16:19], a[52:55], v[148:151]
    ds_read_b128 a[60:63], v13 offset:2048
    s_add_u32 s20, s20, 128
    v_mfma_f32_16x16x32_bf16 v[152:155], a[32:35], a[20:23], v[152:155]
    s_and_b32 s20, s20, 2047
    s_sub_u32 s36, s36, 1
    v_mfma_f32_16x16x32_bf16 v[156:159], a[36:39], a[20:23], v[156:159]
    ds_read_b128 a[64:67], v13 offset:4096
    v_mfma_f32_16x16x32_bf16 v[160:163], a[20:23], a[40:43], v[160:163]
    v_mfma_f32_16x16x32_bf16 v[164:167], a[20:23], a[44:47], v[164:167]
    ds_read_b128 a[68:71], v13 offset:6144
    v_mfma_f32_16x16x32_bf16 v[168:171], a[20:23], a[48:51], v[168:171]
    buffer_load_dwordx4 v4, s[4:7], s38 offen offset:2048 lds
    v_mfma_f32_16x16x32_bf16 v[172:175], a[20:23], a[52:55], v[172:175]
    ds_read_b128 a[72:75], v13 offset:8192
    v_mfma_f32_16x16x32_bf16 v[176:179], a[32:35], a[24:27], v[176:179]
    s_cmp_gt_i32 s36, 0
    s_cselect_b32 s34, s20, 0x40000000
    v_mfma_f32_16x16x32_bf16 v[180:183], a[36:39], a[24:27], v[180:183]
    ds_read_b128 a[76:79], v13 offset:10240
    v_mfma_f32_16x16x32_bf16 v[184:187], a[24:27], a[40:43], v[184:187]
    v_mfma_f32_16x16x32_bf16 v[188:191], a[24:27], a[44:47], v[188:191]
    ds_read_b128 a[80:83], v13 offset:12288
    v_mfma_f32_16x16x32_bf16 v[192:195], a[24:27], a[48:51], v[192:195]
    buffer_load_dwordx4 v5, s[4:7], s38 offen offset:3072 lds
    v_mfma_f32_16x16x32_bf16 v[196:199], a[24:27], a[52:55], v[196:199]
    ds_read_b128 a[84:87], v13 offset:14336
    s_add_u32 s38, s34, 65536
    v_mfma_f32_16x16x32_bf16 v[200:203], a[32:35], a[28:31], v[200:203]
    v_add_u32 v16, s27, v14
    v_add_u32 v17, s27, v15
    v_mfma_f32_16x16x32_bf16 v[204:207], a[36:39], a[28:31], v[204:207]
    v_add_u32 v12, s26, v10
    v_add_u32 v13, s26, v11
    v_mfma_f32_16x16x32_bf16 v[208:211], a[28:31], a[40:43], v[208:211]
    v_mfma_f32_16x16x32_bf16 v[212:215], a[28:31], a[44:47], v[212:215]
    v_mfma_f32_16x16x32_bf16 v[216:219], a[28:31], a[48:51], v[216:219]
    v_mfma_f32_16x16x32_bf16 v[220:223], a[28:31], a[52:55], v[220:223]
    s_waitcnt lgkmcnt(15)
    v_mfma_f32_16x16x32_bf16 v[32:35], a[88:91], a[56:59], v[32:35]
    s_add_u32 s27, s27, 12288
    s_cmp_ge_u32 s27, 61440
    s_cselect_b32 s27, 0, s27
    v_mfma_f32_16x16x32_bf16 v[36:39], a[92:95], a[56:59], v[36:39]
    s_waitcnt lgkmcnt(13)
    v_mfma_f32_16x16x32_bf16 v[40:43], a[56:59], a[96:99], v[40:43]
    s_waitcnt lgkmcnt(0)
    s_waitcnt vmcnt(14)
    s_barrier
    v_mfma_f32_16x16x32_bf16 v[44:47], a[56:59], a[100:103], v[44:47]
    ds_read_b128 a[0:3], v12 offset:0
    s_add_u32 m0, s23, s25
    v_mfma_f32_16x16x32_bf16 v[48:51], a[56:59], a[104:107], v[48:51]
    buffer_load_dwordx4 v6, s[8:11], s35 offen offset:0 lds
    v_mfma_f32_16x16x32_bf16 v[52:55], a[56:59], a[108:111], v[52:55]
    ds_read_b64_tr_b16 a[32:33], v16 offset:0
    s_add_u32 s25, s25, 12288
    v_mfma_f32_16x16x32_bf16 v[56:59], a[88:91], a[60:63], v[56:59]
    s_cmp_ge_u32 s25, 61440
    s_cselect_b32 s25, 0, s25
    v_mfma_f32_16x16x32_bf16 v[60:63], a[92:95], a[60:63], v[60:63]
    ds_read_b64_tr_b16 a[34:35], v16 offset:512
    v_mfma_f32_16x16x32_bf16 v[64:67], a[60:63], a[96:99], v[64:67]
    v_mfma_f32_16x16x32_bf16 v[68:71], a[60:63], a[100:103], v[68:71]
    ds_read_b64_tr_b16 a[36:37], v17 offset:0
    v_mfma_f32_16x16x32_bf16 v[72:75], a[60:63], a[104:107], v[72:75]
    buffer_load_dwordx4 v7, s[8:11], s35 offen offset:1024 lds
    v_mfma_f32_16x16x32_bf16 v[76:79], a[60:63], a[108:111], v[76:79]
    ds_read_b64_tr_b16 a[38:39], v17 offset:512
    s_add_u32 s21, s21, 196608
    v_mfma_f32_16x16x32_bf16 v[80:83], a[88:91], a[64:67], v[80:83]
    s_cmp_ge_u32 s21, 6291456
    s_cselect_b32 s21, 0, s21
    v_mfma_f32_16x16x32_bf16 v[84:87], a[92:95], a[64:67], v[84:87]
    ds_read_b64_tr_b16 a[40:41], v16 offset:4096
    s_sub_u32 s37, s37, 1
    v_mfma_f32_16x16x32_bf16 v[88:91], a[64:67], a[96:99], v[88:91]
    v_mfma_f32_16x16x32_bf16 v[92:95], a[64:67], a[100:103], v[92:95]
    ds_read_b64_tr_b16 a[42:43], v16 offset:4608
    v_mfma_f32_16x16x32_bf16 v[96:99], a[64:67], a[104:107], v[96:99]
    buffer_load_dwordx4 v8, s[8:11], s35 offen offset:2048 lds
    v_mfma_f32_16x16x32_bf16 v[100:103], a[64:67], a[108:111], v[100:103]
    ds_read_b64_tr_b16 a[44:45], v17 offset:4096
    v_mfma_f32_16x16x32_bf16 v[104:107], a[88:91], a[68:71], v[104:107]
    s_cmp_gt_i32 s37, 0
    s_cselect_b32 s35, s21, 0x40000000
    v_mfma_f32_16x16x32_bf16 v[108:111], a[92:95], a[68:71], v[108:111]
    ds_read_b64_tr_b16 a[46:47], v17 offset:4608
    s_add_u32 m0, s22, s24
    v_mfma_f32_16x16x32_bf16 v[112:115], a[68:71], a[96:99], v[112:115]
    v_mfma_f32_16x16x32_bf16 v[116:119], a[68:71], a[100:103], v[116:119]
    ds_read_b64_tr_b16 a[48:49], v16 offset:8192
    v_mfma_f32_16x16x32_bf16 v[120:123], a[68:71], a[104:107], v[120:123]
    buffer_load_dwordx4 v2, s[4:7], s34 offen offset:0 lds
    v_mfma_f32_16x16x32_bf16 v[124:127], a[68:71], a[108:111], v[124:127]
    ds_read_b64_tr_b16 a[50:51], v16 offset:8704
    v_mfma_f32_16x16x32_bf16 v[128:131], a[88:91], a[72:75], v[128:131]
    v_mfma_f32_16x16x32_bf16 v[132:135], a[92:95], a[72:75], v[132:135]
    ds_read_b64_tr_b16 a[52:53], v17 offset:8192
    v_mfma_f32_16x16x32_bf16 v[136:139], a[72:75], a[96:99], v[136:139]
    v_mfma_f32_16x16x32_bf16 v[140:143], a[72:75], a[100:103], v[140:143]
    ds_read_b64_tr_b16 a[54:55], v17 offset:8704
    v_mfma_f32_16x16x32_bf16 v[144:147], a[72:75], a[104:107], v[144:147]
    buffer_load_dwordx4 v3, s[4:7], s34 offen offset:1024 lds
    v_mfma_f32_16x16x32_bf16 v[148:151], a[72:75], a[108:111], v[148:151]
    ds_read_b128 a[4:7], v12 offset:2048
    v_mfma_f32_16x16x32_bf16 v[152:155], a[88:91], a[76:79], v[152:155]
    v_mfma_f32_16x16x32_bf16 v[156:159], a[92:95], a[76:79], v[156:159]
    ds_read_b128 a[8:11], v12 offset:4096
    v_mfma_f32_16x16x32_bf16 v[160:163], a[76:79], a[96:99], v[160:163]
    v_mfma_f32_16x16x32_bf16 v[164:167], a[76:79], a[100:103], v[164:167]
    ds_read_b128 a[12:15], v12 offset:6144
    v_mfma_f32_16x16x32_bf16 v[168:171], a[76:79], a[104:107], v[168:171]
    buffer_load_dwordx4 v4, s[4:7], s34 offen offset:2048 lds
    v_mfma_f32_16x16x32_bf16 v[172:175], a[76:79], a[108:111], v[172:175]
    ds_read_b128 a[16:19], v12 offset:8192
    v_mfma_f32_16x16x32_bf16 v[176:179], a[88:91], a[80:83], v[176:179]
    v_mfma_f32_16x16x32_bf16 v[180:183], a[92:95], a[80:83], v[180:183]
    ds_read_b128 a[20:23], v12 offset:10240
    v_mfma_f32_16x16x32_bf16 v[184:187], a[80:83], a[96:99], v[184:187]
    v_mfma_f32_16x16x32_bf16 v[188:191], a[80:83], a[100:103], v[188:191]
    ds_read_b128 a[24:27], v12 offset:12288
    v_mfma_f32_16x16x32_bf16 v[192:195], a[80:83], a[104:107], v[192:195]
    buffer_load_dwordx4 v5, s[4:7], s34 offen offset:3072 lds
    v_mfma_f32_16x16x32_bf16 v[196:199], a[80:83], a[108:111], v[196:199]
    ds_read_b128 a[28:31], v12 offset:14336
    v_mfma_f32_16x16x32_bf16 v[200:203], a[88:91], a[84:87], v[200:203]
    v_add_u32 v16, s27, v14
    v_add_u32 v17, s27, v15
    v_mfma_f32_16x16x32_bf16 v[204:207], a[92:95], a[84:87], v[204:207]
    v_mfma_f32_16x16x32_bf16 v[208:211], a[84:87], a[96:99], v[208:211]
    v_mfma_f32_16x16x32_bf16 v[212:215], a[84:87], a[100:103], v[212:215]
    v_mfma_f32_16x16x32_bf16 v[216:219], a[84:87], a[104:107], v[216:219]
    v_mfma_f32_16x16x32_bf16 v[220:223], a[84:87], a[108:111], v[220:223]
    s_sub_u32 s39, s39, 1
    s_cmp_lg_u32 s39, 0
    s_cbranch_scc1 L_qkv_kernel_loopB
    v_add_u32 v12, 0x10000, v10
    v_add_u32 v13, 0x10000, v11
    s_waitcnt lgkmcnt(15)
    v_mfma_f32_16x16x32_bf16 v[32:35], a[32:35], a[0:3], v[32:35]
    v_mfma_f32_16x16x32_bf16 v[36:39], a[36:39], a[0:3], v[36:39]
    s_waitcnt lgkmcnt(13)
    v_mfma_f32_16x16x32_bf16 v[40:43], a[0:3], a[40:43], v[40:43]
    s_waitcnt lgkmcnt(0)
    s_waitcnt vmcnt(18)
    s_barrier
    v_mfma_f32_16x16x32_bf16 v[44:47], a[0:3], a[44:47], v[44:47]
    ds_read_b64_tr_b16 a[112:113], v14 offset:12288
    s_add_u32 m0, s23, s25
    v_mfma_f32_16x16x32_bf16 v[48:51], a[0:3], a[48:51], v[48:51]
    ds_read_b64_tr_b16 a[114:115], v14 offset:12800
    buffer_load_dwordx4 v6, s[8:11], s35 offen offset:0 lds
    s_add_u32 s25, s25, 12288
    v_mfma_f32_16x16x32_bf16 v[52:55], a[0:3], a[52:55], v[52:55]
    ds_read_b64_tr_b16 a[116:117], v15 offset:12288
    s_cmp_ge_u32 s25, 61440
    s_cselect_b32 s25, 0, s25
    v_mfma_f32_16x16x32_bf16 v[56:59], a[32:35], a[4:7], v[56:59]
    ds_read_b64_tr_b16 a[118:119], v15 offset:12800
    v_mfma_f32_16x16x32_bf16 v[60:63], a[36:39], a[4:7], v[60:63]
    ds_read_b64_tr_b16 a[120:121], v14 offset:16384
    v_mfma_f32_16x16x32_bf16 v[64:67], a[4:7], a[40:43], v[64:67]
    ds_read_b64_tr_b16 a[122:123], v14 offset:16896
    v_mfma_f32_16x16x32_bf16 v[68:71], a[4:7], a[44:47], v[68:71]
    ds_read_b64_tr_b16 a[124:125], v15 offset:16384
    v_mfma_f32_16x16x32_bf16 v[72:75], a[4:7], a[48:51], v[72:75]
    ds_read_b64_tr_b16 a[126:127], v15 offset:16896
    buffer_load_dwordx4 v7, s[8:11], s35 offen offset:1024 lds
    s_add_u32 s21, s21, 196608
    v_mfma_f32_16x16x32_bf16 v[76:79], a[4:7], a[52:55], v[76:79]
    ds_read_b64_tr_b16 a[128:129], v14 offset:20480
    s_cmp_ge_u32 s21, 6291456
    s_cselect_b32 s21, 0, s21
    v_mfma_f32_16x16x32_bf16 v[80:83], a[32:35], a[8:11], v[80:83]
    ds_read_b64_tr_b16 a[130:131], v14 offset:20992
    s_sub_u32 s37, s37, 1
    v_mfma_f32_16x16x32_bf16 v[84:87], a[36:39], a[8:11], v[84:87]
    ds_read_b64_tr_b16 a[132:133], v15 offset:20480
    v_mfma_f32_16x16x32_bf16 v[88:91], a[8:11], a[40:43], v[88:91]
    ds_read_b64_tr_b16 a[134:135], v15 offset:20992
    v_mfma_f32_16x16x32_bf16 v[92:95], a[8:11], a[44:47], v[92:95]
    ds_read_b128 a[56:59], v11 offset:0
    v_mfma_f32_16x16x32_bf16 v[96:99], a[8:11], a[48:51], v[96:99]
    ds_read_b64_tr_b16 a[88:89], v14 offset:0
    buffer_load_dwordx4 v8, s[8:11], s35 offen offset:2048 lds
    v_mfma_f32_16x16x32_bf16 v[100:103], a[8:11], a[52:55], v[100:103]
    ds_read_b64_tr_b16 a[90:91], v14 offset:512
    s_cmp_gt_i32 s37, 0
    s_cselect_b32 s35, s21, 0x40000000
    v_mfma_f32_16x16x32_bf16 v[104:107], a[32:35], a[12:15], v[104:107]
    ds_read_b64_tr_b16 a[92:93], v15 offset:0
    s_add_u32 m0, s57, s24
    v_mfma_f32_16x16x32_bf16 v[108:111], a[36:39], a[12:15], v[108:111]
    ds_read_b64_tr_b16 a[94:95], v15 offset:512
    v_mfma_f32_16x16x32_bf16 v[112:115], a[12:15], a[40:43], v[112:115]
    ds_read_b64_tr_b16 a[96:97], v14 offset:4096
    v_mfma_f32_16x16x32_bf16 v[116:119], a[12:15], a[44:47], v[116:119]
    ds_read_b64_tr_b16 a[98:99], v14 offset:4608
    v_mfma_f32_16x16x32_bf16 v[120:123], a[12:15], a[48:51], v[120:123]
    ds_read_b64_tr_b16 a[100:101], v15 offset:4096
    buffer_load_dwordx4 v2, s[4:7], s38 offen offset:0 lds
    s_add_u32 s24, s24, 32768
    v_mfma_f32_16x16x32_bf16 v[124:127], a[12:15], a[52:55], v[124:127]
    ds_read_b64_tr_b16 a[102:103], v15 offset:4608
    s_cmp_ge_u32 s24, 98304
    s_cselect_b32 s24, 0, s24
    v_mfma_f32_16x16x32_bf16 v[128:131], a[32:35], a[16:19], v[128:131]
    ds_read_b64_tr_b16 a[104:105], v14 offset:8192
    v_mfma_f32_16x16x32_bf16 v[132:135], a[36:39], a[16:19], v[132:135]
    ds_read_b64_tr_b16 a[106:107], v14 offset:8704
    v_mfma_f32_16x16x32_bf16 v[136:139], a[16:19], a[40:43], v[136:139]
    ds_read_b64_tr_b16 a[108:109], v15 offset:8192
    v_mfma_f32_16x16x32_bf16 v[140:143], a[16:19], a[44:47], v[140:143]
    ds_read_b64_tr_b16 a[110:111], v15 offset:8704
    v_mfma_f32_16x16x32_bf16 v[144:147], a[16:19], a[48:51], v[144:147]
    ds_read_b128 a[60:63], v11 offset:2048
    buffer_load_dwordx4 v3, s[4:7], s38 offen offset:1024 lds
    s_add_u32 s20, s20, 128
    v_mfma_f32_16x16x32_bf16 v[148:151], a[16:19], a[52:55], v[148:151]
    ds_read_b128 a[64:67], v11 offset:4096
    s_and_b32 s20, s20, 2047
    s_sub_u32 s36, s36, 1
    v_mfma_f32_16x16x32_bf16 v[152:155], a[32:35], a[20:23], v[152:155]
    ds_read_b128 a[68:71], v11 offset:6144
    v_mfma_f32_16x16x32_bf16 v[156:159], a[36:39], a[20:23], v[156:159]
    ds_read_b128 a[72:75], v11 offset:8192
    v_mfma_f32_16x16x32_bf16 v[160:163], a[20:23], a[40:43], v[160:163]
    ds_read_b128 a[76:79], v11 offset:10240
    v_mfma_f32_16x16x32_bf16 v[164:167], a[20:23], a[44:47], v[164:167]
    ds_read_b128 a[80:83], v11 offset:12288
    v_mfma_f32_16x16x32_bf16 v[168:171], a[20:23], a[48:51], v[168:171]
    ds_read_b128 a[84:87], v11 offset:14336
    buffer_load_dwordx4 v4, s[4:7], s38 offen offset:2048 lds
    v_mfma_f32_16x16x32_bf16 v[172:175], a[20:23], a[52:55], v[172:175]
    s_cmp_gt_i32 s36, 0
    s_cselect_b32 s34, s20, 0x40000000
    v_mfma_f32_16x16x32_bf16 v[176:179], a[32:35], a[24:27], v[176:179]
    v_mfma_f32_16x16x32_bf16 v[180:183], a[36:39], a[24:27], v[180:183]
    v_mfma_f32_16x16x32_bf16 v[184:187], a[24:27], a[40:43], v[184:187]
    v_mfma_f32_16x16x32_bf16 v[188:191], a[24:27], a[44:47], v[188:191]
    v_mfma_f32_16x16x32_bf16 v[192:195], a[24:27], a[48:51], v[192:195]
    buffer_load_dwordx4 v5, s[4:7], s38 offen offset:3072 lds
    s_add_u32 s38, s34, 65536
    v_mfma_f32_16x16x32_bf16 v[196:199], a[24:27], a[52:55], v[196:199]
    v_mfma_f32_16x16x32_bf16 v[200:203], a[32:35], a[28:31], v[200:203]
    v_mfma_f32_16x16x32_bf16 v[204:207], a[36:39], a[28:31], v[204:207]
    v_mfma_f32_16x16x32_bf16 v[208:211], a[28:31], a[40:43], v[208:211]
    v_mfma_f32_16x16x32_bf16 v[212:215], a[28:31], a[44:47], v[212:215]
    v_mfma_f32_16x16x32_bf16 v[216:219], a[28:31], a[48:51], v[216:219]
    v_mfma_f32_16x16x32_bf16 v[220:223], a[28:31], a[52:55], v[220:223]
    s_waitcnt lgkmcnt(15)
    v_mfma_f32_16x16x32_bf16 v[32:35], a[88:91], a[56:59], v[32:35]
    v_mfma_f32_16x16x32_bf16 v[36:39], a[92:95], a[56:59], v[36:39]
    s_waitcnt lgkmcnt(13)
    v_mfma_f32_16x16x32_bf16 v[40:43], a[56:59], a[96:99], v[40:43]
    s_waitcnt lgkmcnt(0)
    s_waitcnt vmcnt(14)
    s_barrier
    v_mfma_f32_16x16x32_bf16 v[44:47], a[56:59], a[100:103], v[44:47]
    ds_read_b128 a[0:3], v10 offset:32768
    s_add_u32 m0, s22, s24
    v_mfma_f32_16x16x32_bf16 v[48:51], a[56:59], a[104:107], v[48:51]
    ds_read_b128 a[4:7], v10 offset:34816
    buffer_load_dwordx4 v2, s[4:7], s34 offen offset:0 lds
    v_mfma_f32_16x16x32_bf16 v[52:55], a[56:59], a[108:111], v[52:55]
    ds_read_b128 a[8:11], v11 offset:32768
    v_mfma_f32_16x16x32_bf16 v[56:59], a[88:91], a[60:63], v[56:59]
    ds_read_b64_tr_b16 a[136:137], v14 offset:24576
    v_mfma_f32_16x16x32_bf16 v[60:63], a[92:95], a[60:63], v[60:63]
    ds_read_b64_tr_b16 a[138:139], v14 offset:25088
    buffer_load_dwordx4 v3, s[4:7], s34 offen offset:1024 lds
    v_mfma_f32_16x16x32_bf16 v[64:67], a[60:63], a[96:99], v[64:67]
    ds_read_b64_tr_b16 a[140:141], v15 offset:24576
    v_mfma_f32_16x16x32_bf16 v[68:71], a[60:63], a[100:103], v[68:71]
    ds_read_b64_tr_b16 a[142:143], v15 offset:25088
    v_mfma_f32_16x16x32_bf16 v[72:75], a[60:63], a[104:107], v[72:75]
    ds_read_b64_tr_b16 a[144:145], v14 offset:28672
    buffer_load_dwordx4 v4, s[4:7], s34 offen offset:2048 lds
    v_mfma_f32_16x16x32_bf16 v[76:79], a[60:63], a[108:111], v[76:79]
    ds_read_b64_tr_b16 a[146:147], v14 offset:29184
    v_mfma_f32_16x16x32_bf16 v[80:83], a[88:91], a[64:67], v[80:83]
    ds_read_b64_tr_b16 a[148:149], v15 offset:28672
    v_mfma_f32_16x16x32_bf16 v[84:87], a[92:95], a[64:67], v[84:87]
    ds_read_b64_tr_b16 a[150:151], v15 offset:29184
    buffer_load_dwordx4 v5, s[4:7], s34 offen offset:3072 lds
    s_add_u32 m0, s23, s25
    v_mfma_f32_16x16x32_bf16 v[88:91], a[64:67], a[96:99], v[88:91]
    ds_read_b64_tr_b16 a[152:153], v14 offset:32768
    v_mfma_f32_16x16x32_bf16 v[92:95], a[64:67], a[100:103], v[92:95]
    ds_read_b64_tr_b16 a[154:155], v14 offset:33280
    v_mfma_f32_16x16x32_bf16 v[96:99], a[64:67], a[104:107], v[96:99]
    ds_read_b64_tr_b16 a[156:157], v15 offset:32768
    buffer_load_dwordx4 v6, s[8:11], s35 offen offset:0 lds
    s_add_u32 s25, s25, 12288
    v_mfma_f32_16x16x32_bf16 v[100:103], a[64:67], a[108:111], v[100:103]
    ds_read_b64_tr_b16 a[158:159], v15 offset:33280
    s_cmp_ge_u32 s25, 61440
    s_cselect_b32 s25, 0, s25
    v_mfma_f32_16x16x32_bf16 v[104:107], a[88:91], a[68:71], v[104:107]
    ds_read_b128 a[12:15], v11 offset:34816
    v_mfma_f32_16x16x32_bf16 v[108:111], a[92:95], a[68:71], v[108:111]
    ds_read_b128 a[56:59], v10 offset:36864
    buffer_load_dwordx4 v7, s[8:11], s35 offen offset:1024 lds
    s_add_u32 s21, s21, 196608
    v_mfma_f32_16x16x32_bf16 v[112:115], a[68:71], a[96:99], v[112:115]
    ds_read_b128 a[60:63], v10 offset:38912
    s_cmp_ge_u32 s21, 6291456
    s_cselect_b32 s21, 0, s21
    v_mfma_f32_16x16x32_bf16 v[116:119], a[68:71], a[100:103], v[116:119]
    ds_read_b128 a[64:67], v11 offset:36864
    s_sub_u32 s37, s37, 1
    v_mfma_f32_16x16x32_bf16 v[120:123], a[68:71], a[104:107], v[120:123]
    buffer_load_dwordx4 v8, s[8:11], s35 offen offset:2048 lds
    s_cmp_gt_i32 s37, 0
    s_cselect_b32 s35, s21, 0x40000000
    v_mfma_f32_16x16x32_bf16 v[124:127], a[68:71], a[108:111], v[124:127]
    s_add_u32 m0, s57, s24
    v_mfma_f32_16x16x32_bf16 v[128:131], a[88:91], a[72:75], v[128:131]
    ds_read_b128 a[68:71], v11 offset:38912
    v_mfma_f32_16x16x32_bf16 v[132:135], a[92:95], a[72:75], v[132:135]
    buffer_load_dwordx4 v2, s[4:7], s38 offen offset:0 lds
    s_add_u32 s24, s24, 32768
    v_mfma_f32_16x16x32_bf16 v[136:139], a[72:75], a[96:99], v[136:139]
    s_cmp_ge_u32 s24, 98304
    s_cselect_b32 s24, 0, s24
    v_mfma_f32_16x16x32_bf16 v[140:143], a[72:75], a[100:103], v[140:143]
    v_mfma_f32_16x16x32_bf16 v[144:147], a[72:75], a[104:107], v[144:147]
    buffer_load_dwordx4 v3, s[4:7], s38 offen offset:1024 lds
    s_add_u32 s20, s20, 128
    s_and_b32 s20, s20, 2047
    v_mfma_f32_16x16x32_bf16 v[148:151], a[72:75], a[108:111], v[148:151]
    s_sub_u32 s36, s36, 1
    v_mfma_f32_16x16x32_bf16 v[152:155], a[88:91], a[76:79], v[152:155]
    v_mfma_f32_16x16x32_bf16 v[156:159], a[92:95], a[76:79], v[156:159]
    buffer_load_dwordx4 v4, s[4:7], s38 offen offset:2048 lds
    s_cmp_gt_i32 s36, 0
    s_cselect_b32 s34, s20, 0x40000000
    v_mfma_f32_16x16x32_bf16 v[160:163], a[76:79], a[96:99], v[160:163]
    v_mfma_f32_16x16x32_bf16 v[164:167], a[76:79], a[100:103], v[164:167]
    v_mfma_f32_16x16x32_bf16 v[168:171], a[76:79], a[104:107], v[168:171]
    buffer_load_dwordx4 v5, s[4:7], s38 offen offset:3072 lds
    s_add_u32 m0, s23, s25
    v_mfma_f32_16x16x32_bf16 v[172:175], a[76:79], a[108:111], v[172:175]
    v_mfma_f32_16x16x32_bf16 v[176:179], a[88:91], a[80:83], v[176:179]
    v_mfma_f32_16x16x32_bf16 v[180:183], a[92:95], a[80:83], v[180:183]
    buffer_load_dwordx4 v6, s[8:11], s35 offen offset:0 lds
    s_add_u32 s25, s25, 12288
    v_mfma_f32_16x16x32_bf16 v[184:187], a[80:83], a[96:99], v[184:187]
    s_cmp_ge_u32 s25, 61440
    s_cselect_b32 s25, 0, s25
    v_mfma_f32_16x16x32_bf16 v[188:191], a[80:83], a[100:103], v[188:191]
    v_mfma_f32_16x16x32_bf16 v[192:195], a[80:83], a[104:107], v[192:195]
    buffer_load_dwordx4 v7, s[8:11], s35 offen offset:1024 lds
    s_add_u32 s21, s21, 196608
    v_mfma_f32_16x16x32_bf16 v[196:199], a[80:83], a[108:111], v[196:199]
    s_cmp_ge_u32 s21, 6291456
    s_cselect_b32 s21, 0, s21
    s_sub_u32 s37, s37, 1
    v_mfma_f32_16x16x32_bf16 v[200:203], a[88:91], a[84:87], v[200:203]
    v_mfma_f32_16x16x32_bf16 v[204:207], a[92:95], a[84:87], v[204:207]
    buffer_load_dwordx4 v8, s[8:11], s35 offen offset:2048 lds
    v_mfma_f32_16x16x32_bf16 v[208:211], a[84:87], a[96:99], v[208:211]
    v_mfma_f32_16x16x32_bf16 v[212:215], a[84:87], a[100:103], v[212:215]
    v_mfma_f32_16x16x32_bf16 v[216:219], a[84:87], a[104:107], v[216:219]
    v_mfma_f32_16x16x32_bf16 v[220:223], a[84:87], a[108:111], v[220:223]
    s_waitcnt lgkmcnt(15)
    v_mfma_f32_16x16x32_bf16 v[32:35], a[112:115], a[0:3], v[32:35]
    v_mfma_f32_16x16x32_bf16 v[36:39], a[116:119], a[0:3], v[36:39]
    v_mfma_f32_16x16x32_bf16 v[40:43], a[0:3], a[120:123], v[40:43]
    s_waitcnt vmcnt(14)
    s_barrier
    v_mfma_f32_16x16x32_bf16 v[44:47], a[0:3], a[124:127], v[44:47]
    ds_read_b128 a[16:19], v12 offset:0
    s_and_b32 s28, s16, 1
    s_lshl_b32 s29, s18, 1
    v_mfma_f32_16x16x32_bf16 v[48:51], a[0:3], a[128:131], v[48:51]
    ds_read_b64_tr_b16 a[160:161], v14 offset:36864
    s_add_u32 s28, s28, s29
    s_lshr_b32 s29, s16, 1
    v_mfma_f32_16x16x32_bf16 v[52:55], a[0:3], a[132:135], v[52:55]
    ds_read_b64_tr_b16 a[162:163], v14 offset:37376
    s_lshl_b32 s29, s29, 2
    s_lshl_b32 s30, s17, 3
    v_mfma_f32_16x16x32_bf16 v[56:59], a[112:115], a[4:7], v[56:59]
    ds_read_b64_tr_b16 a[164:165], v15 offset:36864
    s_add_u32 s29, s29, s30
    v_lshrrev_b32 v1, 4, v0
    v_mfma_f32_16x16x32_bf16 v[60:63], a[116:119], a[4:7], v[60:63]
    ds_read_b64_tr_b16 a[166:167], v15 offset:37376
    v_lshlrev_b32 v1, 9, v1
    v_and_b32 v2, 15, v0
    v_mfma_f32_16x16x32_bf16 v[64:67], a[4:7], a[120:123], v[64:67]
    ds_read_b64_tr_b16 a[168:169], v14 offset:40960
    v_lshl_add_u32 v4, v2, 4, v1
    s_lshl_b32 s30, s28, 17
    v_mfma_f32_16x16x32_bf16 v[68:71], a[4:7], a[124:127], v[68:71]
    ds_read_b64_tr_b16 a[170:171], v14 offset:41472
    s_lshl_b32 s31, s29, 11
    s_add_u32 s30, s30, s31
    v_mfma_f32_16x16x32_bf16 v[72:75], a[4:7], a[128:131], v[72:75]
    ds_read_b64_tr_b16 a[172:173], v15 offset:40960
    s_add_u32 s30, s30, 12582912
    s_add_u32 s31, s30, 4096
    v_mfma_f32_16x16x32_bf16 v[76:79], a[4:7], a[132:135], v[76:79]
    ds_read_b64_tr_b16 a[174:175], v15 offset:41472
    s_lshr_b32 s33, s29, 2
    s_lshl_b32 s32, s28, 4
    v_mfma_f32_16x16x32_bf16 v[32:35], a[136:139], a[8:11], v[32:35]
    ds_read_b64_tr_b16 a[176:177], v14 offset:45056
    s_add_u32 s33, s33, s32
    s_lshl_b32 s32, s33, 12
    s_waitcnt lgkmcnt(15)
    v_mfma_f32_16x16x32_bf16 v[36:39], a[140:143], a[8:11], v[36:39]
    ds_read_b64_tr_b16 a[178:179], v14 offset:45568
    s_add_u32 s32, s32, 25165824
    s_lshl_b32 s33, s33, 7
    v_mfma_f32_16x16x32_bf16 v[40:43], a[8:11], a[144:147], v[40:43]
    ds_read_b64_tr_b16 a[180:181], v15 offset:45056
    s_add_u32 s33, s33, 27262976
    v_mov_b32 v18, 0x3fb8aa3b
    v_mfma_f32_16x16x32_bf16 v[44:47], a[8:11], a[148:151], v[44:47]
    ds_read_b64_tr_b16 a[182:183], v15 offset:45568
    v_mov_b32 v19, 0x3fb8aa3b
    v_mov_b32 v20, 0xbfb8aa3b
    v_mfma_f32_16x16x32_bf16 v[48:51], a[8:11], a[152:155], v[48:51]
    ds_read_b128 a[20:23], v12 offset:2048
    v_mov_b32 v21, 0xbfb8aa3b
    v_mov_b32 v22, 0x358637bd
    v_mfma_f32_16x16x32_bf16 v[52:55], a[8:11], a[156:159], v[52:55]
    ds_read_b128 a[24:27], v13 offset:0
    v_mov_b32 v23, 0x358637bd
    v_mov_b32 v248, 0x3f803f80
    s_waitcnt lgkmcnt(15)
    v_mfma_f32_16x16x32_bf16 v[56:59], a[136:139], a[12:15], v[56:59]
    ds_read_b64_tr_b16 a[184:185], v14 offset:49152
    v_mov_b32 v249, 0x3f803f80
    v_mov_b32 v250, 0x3f803f80
    v_mfma_f32_16x16x32_bf16 v[60:63], a[140:143], a[12:15], v[60:63]
    ds_read_b64_tr_b16 a[186:187], v14 offset:49664
    v_mov_b32 v251, 0x3f803f80
    v_lshlrev_b32 v6, 4, v0
    v_mfma_f32_16x16x32_bf16 v[64:67], a[12:15], a[144:147], v[64:67]
    ds_read_b64_tr_b16 a[188:189], v15 offset:49152
    v_lshlrev_b32 v7, 2, v0
    v_mfma_f32_16x16x32_bf16 v[68:71], a[12:15], a[148:151], v[68:71]
    ds_read_b64_tr_b16 a[190:191], v15 offset:49664
    v_mfma_f32_16x16x32_bf16 v[72:75], a[12:15], a[152:155], v[72:75]
    ds_read_b64_tr_b16 a[192:193], v14 offset:53248
    v_mfma_f32_16x16x32_bf16 v[76:79], a[12:15], a[156:159], v[76:79]
    ds_read_b64_tr_b16 a[194:195], v14 offset:53760
    s_waitcnt lgkmcnt(15)
    v_mfma_f32_16x16x32_bf16 v[32:35], a[160:163], a[16:19], v[32:35]
    ds_read_b64_tr_b16 a[196:197], v15 offset:53248
    v_mfma_f32_16x16x32_bf16 v[36:39], a[164:167], a[16:19], v[36:39]
    ds_read_b64_tr_b16 a[198:199], v15 offset:53760
    s_waitcnt lgkmcnt(15)
    v_mfma_f32_16x16x32_bf16 v[40:43], a[16:19], a[168:171], v[40:43]
    ds_read_b64_tr_b16 a[200:201], v14 offset:57344
    s_waitcnt lgkmcnt(15)
    v_mfma_f32_16x16x32_bf16 v[44:47], a[16:19], a[172:175], v[44:47]
    ds_read_b64_tr_b16 a[202:203], v14 offset:57856
    s_waitcnt lgkmcnt(14)
    v_mfma_f32_16x16x32_bf16 v[48:51], a[16:19], a[176:179], v[48:51]
    ds_read_b64_tr_b16 a[204:205], v15 offset:57344
    s_waitcnt lgkmcnt(13)
    v_mfma_f32_16x16x32_bf16 v[52:55], a[16:19], a[180:183], v[52:55]
    ds_read_b64_tr_b16 a[206:207], v15 offset:57856
    s_waitcnt lgkmcnt(13)
    v_mfma_f32_16x16x32_bf16 v[56:59], a[160:163], a[20:23], v[56:59]
    ds_read_b128 a[28:31], v13 offset:2048
    v_mfma_f32_16x16x32_bf16 v[60:63], a[164:167], a[20:23], v[60:63]
    ds_read_b128 a[72:75], v12 offset:4096
    v_mfma_f32_16x16x32_bf16 v[64:67], a[20:23], a[168:171], v[64:67]
    ds_read_b128 a[76:79], v12 offset:6144
    v_mfma_f32_16x16x32_bf16 v[68:71], a[20:23], a[172:175], v[68:71]
    ds_read_b128 a[80:83], v13 offset:4096
    v_mfma_f32_16x16x32_bf16 v[72:75], a[20:23], a[176:179], v[72:75]
    ds_read_b128 a[84:87], v13 offset:6144
    v_mfma_f32_16x16x32_bf16 v[76:79], a[20:23], a[180:183], v[76:79]
    ds_read_b128 a[0:3], v10 offset:40960
    s_waitcnt lgkmcnt(15)
    v_mfma_f32_16x16x32_bf16 v[32:35], a[184:187], a[24:27], v[32:35]
    ds_read_b128 a[4:7], v10 offset:43008
    s_waitcnt lgkmcnt(15)
    v_mfma_f32_16x16x32_bf16 v[36:39], a[188:191], a[24:27], v[36:39]
    ds_read_b128 a[8:11], v11 offset:40960
    s_waitcnt lgkmcnt(14)
    v_mfma_f32_16x16x32_bf16 v[40:43], a[24:27], a[192:195], v[40:43]
    ds_read_b128 a[12:15], v11 offset:43008
    s_waitcnt lgkmcnt(13)
    v_mfma_f32_16x16x32_bf16 v[44:47], a[24:27], a[196:199], v[44:47]
    ds_read_b128 a[16:19], v12 offset:8192
    s_waitcnt lgkmcnt(12)
    v_mfma_f32_16x16x32_bf16 v[48:51], a[24:27], a[200:203], v[48:51]
    ds_read_b128 a[20:23], v12 offset:10240
    s_waitcnt lgkmcnt(11)
    v_mfma_f32_16x16x32_bf16 v[52:55], a[24:27], a[204:207], v[52:55]
    s_waitcnt lgkmcnt(10)
    v_mfma_f32_16x16x32_bf16 v[56:59], a[184:187], a[28:31], v[56:59]
    ds_read_b128 a[24:27], v13 offset:8192
    v_mfma_f32_16x16x32_bf16 v[60:63], a[188:191], a[28:31], v[60:63]
    v_mfma_f32_16x16x32_bf16 v[64:67], a[28:31], a[192:195], v[64:67]
    v_mfma_f32_16x16x32_bf16 v[68:71], a[28:31], a[196:199], v[68:71]
    v_mfma_f32_16x16x32_bf16 v[72:75], a[28:31], a[200:203], v[72:75]
    v_mfma_f32_16x16x32_bf16 v[76:79], a[28:31], a[204:207], v[76:79]
    v_mfma_f32_16x16x32_bf16 v[88:91], a[56:59], a[120:123], v[88:91]
    ds_read_b128 a[28:31], v13 offset:10240
    v_mfma_f32_16x16x32_bf16 v[92:95], a[56:59], a[124:127], v[92:95]
    v_mfma_f32_16x16x32_bf16 v[112:115], a[60:63], a[120:123], v[112:115]
    s_waitcnt vmcnt(0)
    s_barrier
    v_mfma_f32_16x16x32_bf16 v[116:119], a[60:63], a[124:127], v[116:119]
    ds_read_b128 a[32:35], v10 offset:0
    v_mfma_f32_16x16x32_bf16 v[88:91], a[64:67], a[144:147], v[88:91]
    ds_read_b64_tr_b16 a[216:217], v14 offset:4096
    v_mfma_f32_16x16x32_bf16 v[92:95], a[64:67], a[148:151], v[92:95]
    ds_read_b64_tr_b16 a[218:219], v14 offset:4608
    v_mfma_f32_16x16x32_bf16 v[112:115], a[68:71], a[144:147], v[112:115]
    ds_read_b64_tr_b16 a[220:221], v15 offset:4096
    v_mfma_f32_16x16x32_bf16 v[116:119], a[68:71], a[148:151], v[116:119]
    ds_read_b64_tr_b16 a[222:223], v15 offset:4608
    s_waitcnt lgkmcnt(15)
    v_mfma_f32_16x16x32_bf16 v[88:91], a[72:75], a[168:171], v[88:91]
    ds_read_b128 a[36:39], v10 offset:2048
    v_mfma_f32_16x16x32_bf16 v[92:95], a[72:75], a[172:175], v[92:95]
    ds_read_b128 a[40:43], v11 offset:0
    v_mfma_f32_16x16x32_bf16 v[112:115], a[76:79], a[168:171], v[112:115]
    ds_read_b64_tr_b16 a[240:241], v14 offset:16384
    v_mfma_f32_16x16x32_bf16 v[116:119], a[76:79], a[172:175], v[116:119]
    ds_read_b64_tr_b16 a[242:243], v14 offset:16896
    s_waitcnt lgkmcnt(15)
    v_mfma_f32_16x16x32_bf16 v[88:91], a[80:83], a[192:195], v[88:91]
    ds_read_b64_tr_b16 a[244:245], v15 offset:16384
    v_mfma_f32_16x16x32_bf16 v[92:95], a[80:83], a[196:199], v[92:95]
    ds_read_b64_tr_b16 a[246:247], v15 offset:16896
    v_mfma_f32_16x16x32_bf16 v[112:115], a[84:87], a[192:195], v[112:115]
    ds_read_b128 a[44:47], v11 offset:2048
    v_mfma_f32_16x16x32_bf16 v[116:119], a[84:87], a[196:199], v[116:119]
    ds_read_b64_tr_b16 a[224:225], v14 offset:8192
    s_waitcnt lgkmcnt(10)
    v_mfma_f32_16x16x32_bf16 v[40:43], a[32:35], a[216:219], v[40:43]
    ds_read_b64_tr_b16 a[226:227], v14 offset:8704
    s_waitcnt lgkmcnt(9)
    v_mfma_f32_16x16x32_bf16 v[44:47], a[32:35], a[220:223], v[44:47]
    ds_read_b64_tr_b16 a[228:229], v15 offset:8192
    s_waitcnt lgkmcnt(9)
    v_mfma_f32_16x16x32_bf16 v[64:67], a[36:39], a[216:219], v[64:67]
    ds_read_b64_tr_b16 a[230:231], v15 offset:8704
    v_mfma_f32_16x16x32_bf16 v[68:71], a[36:39], a[220:223], v[68:71]
    ds_read_b64_tr_b16 a[248:249], v14 offset:20480
    s_waitcnt lgkmcnt(8)
    v_mfma_f32_16x16x32_bf16 v[40:43], a[40:43], a[240:243], v[40:43]
    ds_read_b64_tr_b16 a[250:251], v14 offset:20992
    s_waitcnt lgkmcnt(7)
    v_mfma_f32_16x16x32_bf16 v[44:47], a[40:43], a[244:247], v[44:47]
    ds_read_b64_tr_b16 a[252:253], v15 offset:20480
    s_waitcnt lgkmcnt(7)
    v_mfma_f32_16x16x32_bf16 v[64:67], a[44:47], a[240:243], v[64:67]
    ds_read_b64_tr_b16 a[254:255], v15 offset:20992
    v_mfma_f32_16x16x32_bf16 v[68:71], a[44:47], a[244:247], v[68:71]
    ds_read_b64_tr_b16 a[208:209], v14 offset:0
    s_waitcnt lgkmcnt(7)
    v_mfma_f32_16x16x32_bf16 v[48:51], a[32:35], a[224:227], v[48:51]
    ds_read_b64_tr_b16 a[210:211], v14 offset:512
    s_waitcnt lgkmcnt(6)
    v_mfma_f32_16x16x32_bf16 v[52:55], a[32:35], a[228:231], v[52:55]
    ds_read_b64_tr_b16 a[212:213], v15 offset:0
    v_mfma_f32_16x16x32_bf16 v[72:75], a[36:39], a[224:227], v[72:75]
    ds_read_b64_tr_b16 a[214:215], v15 offset:512
    v_pk_fma_f32 v[24:25], v[40:41], v[18:19], v[20:21]
    v_pk_fma_f32 v[26:27], v[42:43], v[18:19], v[20:21]
    v_mfma_f32_16x16x32_bf16 v[76:79], a[36:39], a[228:231], v[76:79]
    ds_read_b64_tr_b16 a[232:233], v14 offset:12288
    v_exp_f32 v24, v24 clamp
    s_waitcnt lgkmcnt(7)
    v_mfma_f32_16x16x32_bf16 v[48:51], a[40:43], a[248:251], v[48:51]
    ds_read_b64_tr_b16 a[234:235], v14 offset:12800
    v_exp_f32 v25, v25 clamp
    s_waitcnt lgkmcnt(6)
    v_mfma_f32_16x16x32_bf16 v[52:55], a[40:43], a[252:255], v[52:55]
    ds_read_b64_tr_b16 a[236:237], v15 offset:12288
    v_exp_f32 v26, v26 clamp
    v_mfma_f32_16x16x32_bf16 v[72:75], a[44:47], a[248:251], v[72:75]
    ds_read_b64_tr_b16 a[238:239], v15 offset:12800
    v_exp_f32 v27, v27 clamp
    v_mfma_f32_16x16x32_bf16 v[76:79], a[44:47], a[252:255], v[76:79]
    ds_read_b128 a[88:91], v10 offset:4096
    v_max_f32 v40, v40, v24
    v_max_f32 v41, v41, v25
    s_waitcnt lgkmcnt(7)
    v_mfma_f32_16x16x32_bf16 v[32:35], a[208:211], a[32:35], v[32:35]
    ds_read_b128 a[92:95], v10 offset:6144
    v_max_f32 v42, v42, v26
    v_max_f32 v43, v43, v27
    s_waitcnt lgkmcnt(6)
    v_mfma_f32_16x16x32_bf16 v[36:39], a[212:215], a[32:35], v[36:39]
    ds_read_b128 a[96:99], v11 offset:4096
    v_pk_add_f32 v[40:41], v[40:41], v[22:23]
    v_pk_add_f32 v[42:43], v[42:43], v[22:23]
    v_mfma_f32_16x16x32_bf16 v[56:59], a[208:211], a[36:39], v[56:59]
    ds_read_b128 a[100:103], v11 offset:6144
    v_pk_fma_f32 v[28:29], v[64:65], v[18:19], v[20:21]
    v_pk_fma_f32 v[30:31], v[66:67], v[18:19], v[20:21]
    v_mfma_f32_16x16x32_bf16 v[60:63], a[212:215], a[36:39], v[60:63]
    ds_read_b128 a[32:35], v10 offset:8192
    v_exp_f32 v28, v28 clamp
    s_waitcnt lgkmcnt(7)
    v_mfma_f32_16x16x32_bf16 v[32:35], a[232:235], a[40:43], v[32:35]
    ds_read_b128 a[36:39], v10 offset:10240
    v_exp_f32 v29, v29 clamp
    s_waitcnt lgkmcnt(6)
    v_mfma_f32_16x16x32_bf16 v[36:39], a[236:239], a[40:43], v[36:39]
    v_exp_f32 v30, v30 clamp
    v_max_f32 v64, v64, v28
    v_mfma_f32_16x16x32_bf16 v[56:59], a[232:235], a[44:47], v[56:59]
    ds_read_b128 a[40:43], v11 offset:8192
    v_exp_f32 v31, v31 clamp
    v_mfma_f32_16x16x32_bf16 v[60:63], a[236:239], a[44:47], v[60:63]
    v_max_f32 v65, v65, v29
    v_max_f32 v66, v66, v30
    v_max_f32 v67, v67, v31
    s_waitcnt lgkmcnt(6)
    v_mfma_f32_16x16x32_bf16 v[88:91], a[88:91], a[216:219], v[88:91]
    ds_read_b128 a[44:47], v11 offset:10240
    v_pk_add_f32 v[64:65], v[64:65], v[22:23]
    v_pk_add_f32 v[66:67], v[66:67], v[22:23]
    v_mfma_f32_16x16x32_bf16 v[92:95], a[88:91], a[220:223], v[92:95]
    v_cvt_pk_bf16_f32 v40, v40, v41
    v_cvt_pk_bf16_f32 v41, v42, v43
    v_cvt_pk_bf16_f32 v42, v64, v65
    s_waitcnt lgkmcnt(6)
    v_mfma_f32_16x16x32_bf16 v[112:115], a[92:95], a[216:219], v[112:115]
    v_cvt_pk_bf16_f32 v43, v66, v67
    v_pk_fma_f32 v[252:253], v[44:45], v[18:19], v[20:21]
    v_pk_fma_f32 v[254:255], v[46:47], v[18:19], v[20:21]
    v_mfma_f32_16x16x32_bf16 v[116:119], a[92:95], a[220:223], v[116:119]
    v_exp_f32 v252, v252 clamp
    v_pk_fma_f32 v[24:25], v[68:69], v[18:19], v[20:21]
    s_waitcnt lgkmcnt(5)
    v_mfma_f32_16x16x32_bf16 v[88:91], a[96:99], a[240:243], v[88:91]
    v_exp_f32 v253, v253 clamp
    v_max_f32 v44, v44, v252
    v_mfma_f32_16x16x32_bf16 v[92:95], a[96:99], a[244:247], v[92:95]
    v_exp_f32 v254, v254 clamp
    v_max_f32 v45, v45, v253
    s_waitcnt lgkmcnt(4)
    v_mfma_f32_16x16x32_bf16 v[112:115], a[100:103], a[240:243], v[112:115]
    v_exp_f32 v255, v255 clamp
    v_max_f32 v46, v46, v254
    v_mfma_f32_16x16x32_bf16 v[116:119], a[100:103], a[244:247], v[116:119]
    v_max_f32 v47, v47, v255
    v_pk_add_f32 v[44:45], v[44:45], v[22:23]
    v_pk_add_f32 v[46:47], v[46:47], v[22:23]
    v_mfma_f32_16x16x32_bf16 v[96:99], a[56:59], a[128:131], v[96:99]
    v_pk_fma_f32 v[26:27], v[70:71], v[18:19], v[20:21]
    v_exp_f32 v24, v24 clamp
    v_mfma_f32_16x16x32_bf16 v[100:103], a[56:59], a[132:135], v[100:103]
    v_exp_f32 v25, v25 clamp
    v_max_f32 v68, v68, v24
    v_mfma_f32_16x16x32_bf16 v[120:123], a[60:63], a[128:131], v[120:123]
    v_exp_f32 v26, v26 clamp
    v_max_f32 v69, v69, v25
    v_mfma_f32_16x16x32_bf16 v[124:127], a[60:63], a[132:135], v[124:127]
    v_exp_f32 v27, v27 clamp
    v_max_f32 v70, v70, v26
    v_mfma_f32_16x16x32_bf16 v[96:99], a[64:67], a[152:155], v[96:99]
    v_max_f32 v71, v71, v27
    v_pk_add_f32 v[68:69], v[68:69], v[22:23]
    v_pk_add_f32 v[70:71], v[70:71], v[22:23]
    v_mfma_f32_16x16x32_bf16 v[100:103], a[64:67], a[156:159], v[100:103]
    v_cvt_pk_bf16_f32 v44, v44, v45
    v_cvt_pk_bf16_f32 v45, v46, v47
    v_cvt_pk_bf16_f32 v46, v68, v69
    v_mfma_f32_16x16x32_bf16 v[120:123], a[68:71], a[152:155], v[120:123]
    v_cvt_pk_bf16_f32 v47, v70, v71
    v_mfma_f32_16x16x32_bf16 v[240:243], v[248:251], v[40:43], 0
    v_cvt_pk_bf16_f32 v48, v48, v49
    v_mfma_f32_16x16x32_bf16 v[124:127], a[68:71], a[156:159], v[124:127]
    v_mfma_f32_16x16x32_bf16 v[244:247], v[248:251], v[44:47], 0
    v_cvt_pk_bf16_f32 v49, v50, v51
    v_cvt_pk_bf16_f32 v50, v72, v73
    v_mfma_f32_16x16x32_bf16 v[96:99], a[72:75], a[176:179], v[96:99]
    v_cvt_pk_bf16_f32 v51, v74, v75
    v_cvt_pk_bf16_f32 v52, v52, v53
    v_cvt_pk_bf16_f32 v53, v54, v55
    v_mfma_f32_16x16x32_bf16 v[100:103], a[72:75], a[180:183], v[100:103]
    v_cvt_pk_bf16_f32 v54, v76, v77
    v_cvt_pk_bf16_f32 v55, v78, v79
    v_mfma_f32_16x16x32_bf16 v[224:227], v[40:43], v[48:51], 0
    v_mfma_f32_16x16x32_bf16 v[120:123], a[76:79], a[176:179], v[120:123]
    v_mfma_f32_16x16x32_bf16 v[228:231], v[44:47], v[48:51], 0
    v_mfma_f32_16x16x32_bf16 v[232:235], v[40:43], v[52:55], 0
    v_mfma_f32_16x16x32_bf16 v[236:239], v[44:47], v[52:55], 0
    v_mfma_f32_16x16x32_bf16 v[124:127], a[76:79], a[180:183], v[124:127]
    v_pk_fma_f32 v[28:29], v[32:33], v[18:19], v[20:21]
    v_pk_fma_f32 v[30:31], v[34:35], v[18:19], v[20:21]
    v_pk_fma_f32 v[252:253], v[36:37], v[18:19], v[20:21]
    v_mfma_f32_16x16x32_bf16 v[96:99], a[80:83], a[200:203], v[96:99]
    v_exp_f32 v28, v28 clamp
    v_pk_fma_f32 v[254:255], v[38:39], v[18:19], v[20:21]
    v_mfma_f32_16x16x32_bf16 v[100:103], a[80:83], a[204:207], v[100:103]
    v_exp_f32 v29, v29 clamp
    v_max_f32 v32, v32, v28
    v_mfma_f32_16x16x32_bf16 v[120:123], a[84:87], a[200:203], v[120:123]
    v_exp_f32 v30, v30 clamp
    v_max_f32 v33, v33, v29
    v_mfma_f32_16x16x32_bf16 v[124:127], a[84:87], a[204:207], v[124:127]
    v_exp_f32 v31, v31 clamp
    v_max_f32 v34, v34, v30
    v_mfma_f32_16x16x32_bf16 v[96:99], a[88:91], a[224:227], v[96:99]
    v_max_f32 v35, v35, v31
    v_pk_add_f32 v[32:33], v[32:33], v[22:23]
    v_pk_add_f32 v[34:35], v[34:35], v[22:23]
    v_mfma_f32_16x16x32_bf16 v[100:103], a[88:91], a[228:231], v[100:103]
    v_exp_f32 v252, v252 clamp
    v_cvt_pk_bf16_f32 v32, v32, v33
    v_mfma_f32_16x16x32_bf16 v[120:123], a[92:95], a[224:227], v[120:123]
    v_exp_f32 v253, v253 clamp
    v_max_f32 v36, v36, v252
    v_mfma_f32_16x16x32_bf16 v[124:127], a[92:95], a[228:231], v[124:127]
    v_exp_f32 v254, v254 clamp
    v_max_f32 v37, v37, v253
    v_mfma_f32_16x16x32_bf16 v[96:99], a[96:99], a[248:251], v[96:99]
    v_exp_f32 v255, v255 clamp
    v_max_f32 v38, v38, v254
    v_mfma_f32_16x16x32_bf16 v[100:103], a[96:99], a[252:255], v[100:103]
    v_max_f32 v39, v39, v255
    v_pk_add_f32 v[36:37], v[36:37], v[22:23]
    v_pk_add_f32 v[38:39], v[38:39], v[22:23]
    v_mfma_f32_16x16x32_bf16 v[120:123], a[100:103], a[248:251], v[120:123]
    v_cvt_pk_bf16_f32 v33, v34, v35
    v_cvt_pk_bf16_f32 v34, v36, v37
    v_cvt_pk_bf16_f32 v35, v38, v39
    v_mfma_f32_16x16x32_bf16 v[124:127], a[100:103], a[252:255], v[124:127]
    buffer_store_dwordx4 v[32:35], v4, s[12:15], s30 offen offset:0 sc0 sc1
    v_pk_fma_f32 v[24:25], v[56:57], v[18:19], v[20:21]
    v_pk_fma_f32 v[26:27], v[58:59], v[18:19], v[20:21]
    v_mfma_f32_16x16x32_bf16 v[80:83], a[112:115], a[56:59], v[80:83]
    v_exp_f32 v24, v24 clamp
    v_pk_fma_f32 v[28:29], v[60:61], v[18:19], v[20:21]
    v_mfma_f32_16x16x32_bf16 v[84:87], a[116:119], a[56:59], v[84:87]
    v_exp_f32 v25, v25 clamp
    v_max_f32 v56, v56, v24
    v_mfma_f32_16x16x32_bf16 v[104:107], a[112:115], a[60:63], v[104:107]
    ds_read_b128 a[56:59], v10 offset:45056
    v_exp_f32 v26, v26 clamp
    v_mfma_f32_16x16x32_bf16 v[108:111], a[116:119], a[60:63], v[108:111]
    v_exp_f32 v27, v27 clamp
    v_max_f32 v57, v57, v25
    v_mfma_f32_16x16x32_bf16 v[80:83], a[136:139], a[64:67], v[80:83]
    ds_read_b128 a[60:63], v10 offset:47104
    v_max_f32 v58, v58, v26
    v_max_f32 v59, v59, v27
    v_mfma_f32_16x16x32_bf16 v[84:87], a[140:143], a[64:67], v[84:87]
    v_pk_add_f32 v[56:57], v[56:57], v[22:23]
    v_pk_add_f32 v[58:59], v[58:59], v[22:23]
    v_pk_fma_f32 v[30:31], v[62:63], v[18:19], v[20:21]
    v_mfma_f32_16x16x32_bf16 v[104:107], a[136:139], a[68:71], v[104:107]
    ds_read_b128 a[64:67], v11 offset:45056
    v_exp_f32 v28, v28 clamp
    v_mfma_f32_16x16x32_bf16 v[108:111], a[140:143], a[68:71], v[108:111]
    v_exp_f32 v29, v29 clamp
    v_max_f32 v60, v60, v28
    v_mfma_f32_16x16x32_bf16 v[80:83], a[160:163], a[72:75], v[80:83]
    ds_read_b128 a[68:71], v11 offset:47104
    v_exp_f32 v30, v30 clamp
    v_mfma_f32_16x16x32_bf16 v[84:87], a[164:167], a[72:75], v[84:87]
    v_exp_f32 v31, v31 clamp
    v_max_f32 v61, v61, v29
    v_mfma_f32_16x16x32_bf16 v[104:107], a[160:163], a[76:79], v[104:107]
    ds_read_b128 a[72:75], v12 offset:12288
    v_max_f32 v62, v62, v30
    v_max_f32 v63, v63, v31
    v_mfma_f32_16x16x32_bf16 v[108:111], a[164:167], a[76:79], v[108:111]
    v_pk_add_f32 v[60:61], v[60:61], v[22:23]
    v_pk_add_f32 v[62:63], v[62:63], v[22:23]
    v_cvt_pk_bf16_f32 v56, v56, v57
    v_mfma_f32_16x16x32_bf16 v[80:83], a[184:187], a[80:83], v[80:83]
    ds_read_b128 a[76:79], v12 offset:14336
    v_cvt_pk_bf16_f32 v57, v58, v59
    v_cvt_pk_bf16_f32 v58, v60, v61
    v_mfma_f32_16x16x32_bf16 v[84:87], a[188:191], a[80:83], v[84:87]
    v_cvt_pk_bf16_f32 v59, v62, v63
    buffer_store_dwordx4 v[56:59], v4, s[12:15], s30 offen offset:256 sc0 sc1
    v_pk_fma_f32 v[252:253], v[88:89], v[18:19], v[20:21]
    v_mfma_f32_16x16x32_bf16 v[104:107], a[184:187], a[84:87], v[104:107]
    ds_read_b128 a[80:83], v13 offset:12288
    v_pk_fma_f32 v[254:255], v[90:91], v[18:19], v[20:21]
    v_pk_fma_f32 v[24:25], v[112:113], v[18:19], v[20:21]
    v_mfma_f32_16x16x32_bf16 v[108:111], a[188:191], a[84:87], v[108:111]
    v_exp_f32 v252, v252 clamp
    v_pk_fma_f32 v[26:27], v[114:115], v[18:19], v[20:21]
    v_mfma_f32_16x16x32_bf16 v[80:83], a[208:211], a[88:91], v[80:83]
    ds_read_b128 a[84:87], v13 offset:14336
    v_exp_f32 v253, v253 clamp
    v_mfma_f32_16x16x32_bf16 v[84:87], a[212:215], a[88:91], v[84:87]
    v_exp_f32 v254, v254 clamp
    v_max_f32 v88, v88, v252
    v_mfma_f32_16x16x32_bf16 v[104:107], a[208:211], a[92:95], v[104:107]
    ds_read_b128 a[88:91], v10 offset:12288
    v_exp_f32 v255, v255 clamp
    v_mfma_f32_16x16x32_bf16 v[108:111], a[212:215], a[92:95], v[108:111]
    v_max_f32 v89, v89, v253
    v_max_f32 v90, v90, v254
    v_max_f32 v91, v91, v255
    v_mfma_f32_16x16x32_bf16 v[80:83], a[232:235], a[96:99], v[80:83]
    ds_read_b128 a[92:95], v10 offset:14336
    v_pk_add_f32 v[88:89], v[88:89], v[22:23]
    v_pk_add_f32 v[90:91], v[90:91], v[22:23]
    v_mfma_f32_16x16x32_bf16 v[84:87], a[236:239], a[96:99], v[84:87]
    v_exp_f32 v24, v24 clamp
    v_cvt_pk_bf16_f32 v88, v88, v89
    v_mfma_f32_16x16x32_bf16 v[104:107], a[232:235], a[100:103], v[104:107]
    ds_read_b128 a[96:99], v11 offset:12288
    v_exp_f32 v25, v25 clamp
    v_mfma_f32_16x16x32_bf16 v[108:111], a[236:239], a[100:103], v[108:111]
    v_exp_f32 v26, v26 clamp
    v_max_f32 v112, v112, v24
    v_mfma_f32_16x16x32_bf16 v[136:139], a[0:3], a[120:123], v[136:139]
    ds_read_b128 a[100:103], v11 offset:14336
    v_exp_f32 v27, v27 clamp
    v_mfma_f32_16x16x32_bf16 v[140:143], a[0:3], a[124:127], v[140:143]
    v_max_f32 v113, v113, v25
    v_max_f32 v114, v114, v26
    v_max_f32 v115, v115, v27
    v_mfma_f32_16x16x32_bf16 v[160:163], a[4:7], a[120:123], v[160:163]
    v_pk_add_f32 v[112:113], v[112:113], v[22:23]
    v_pk_add_f32 v[114:115], v[114:115], v[22:23]
    v_cvt_pk_bf16_f32 v89, v90, v91
    v_mfma_f32_16x16x32_bf16 v[164:167], a[4:7], a[124:127], v[164:167]
    v_cvt_pk_bf16_f32 v90, v112, v113
    v_cvt_pk_bf16_f32 v91, v114, v115
    v_pk_fma_f32 v[28:29], v[92:93], v[18:19], v[20:21]
    v_mfma_f32_16x16x32_bf16 v[136:139], a[8:11], a[144:147], v[136:139]
    v_pk_fma_f32 v[30:31], v[94:95], v[18:19], v[20:21]
    v_exp_f32 v28, v28 clamp
    v_mfma_f32_16x16x32_bf16 v[140:143], a[8:11], a[148:151], v[140:143]
    v_exp_f32 v29, v29 clamp
    v_max_f32 v92, v92, v28
    v_mfma_f32_16x16x32_bf16 v[160:163], a[12:15], a[144:147], v[160:163]
    v_exp_f32 v30, v30 clamp
    v_max_f32 v93, v93, v29
    v_mfma_f32_16x16x32_bf16 v[164:167], a[12:15], a[148:151], v[164:167]
    v_exp_f32 v31, v31 clamp
    v_max_f32 v94, v94, v30
    v_mfma_f32_16x16x32_bf16 v[136:139], a[16:19], a[168:171], v[136:139]
    v_max_f32 v95, v95, v31
    v_pk_add_f32 v[92:93], v[92:93], v[22:23]
    v_pk_add_f32 v[94:95], v[94:95], v[22:23]
    v_mfma_f32_16x16x32_bf16 v[140:143], a[16:19], a[172:175], v[140:143]
    v_pk_fma_f32 v[252:253], v[116:117], v[18:19], v[20:21]
    v_pk_fma_f32 v[254:255], v[118:119], v[18:19], v[20:21]
    v_cvt_pk_bf16_f32 v92, v92, v93
    v_mfma_f32_16x16x32_bf16 v[160:163], a[20:23], a[168:171], v[160:163]
    v_exp_f32 v252, v252 clamp
    v_cvt_pk_bf16_f32 v93, v94, v95
    v_mfma_f32_16x16x32_bf16 v[164:167], a[20:23], a[172:175], v[164:167]
    v_exp_f32 v253, v253 clamp
    v_max_f32 v116, v116, v252
    v_mfma_f32_16x16x32_bf16 v[136:139], a[24:27], a[192:195], v[136:139]
    v_exp_f32 v254, v254 clamp
    v_max_f32 v117, v117, v253
    v_mfma_f32_16x16x32_bf16 v[140:143], a[24:27], a[196:199], v[140:143]
    v_exp_f32 v255, v255 clamp
    v_max_f32 v118, v118, v254
    v_mfma_f32_16x16x32_bf16 v[160:163], a[28:31], a[192:195], v[160:163]
    v_max_f32 v119, v119, v255
    v_pk_add_f32 v[116:117], v[116:117], v[22:23]
    v_pk_add_f32 v[118:119], v[118:119], v[22:23]
    v_mfma_f32_16x16x32_bf16 v[164:167], a[28:31], a[196:199], v[164:167]
    v_cvt_pk_bf16_f32 v94, v116, v117
    v_cvt_pk_bf16_f32 v95, v118, v119
    v_mfma_f32_16x16x32_bf16 v[240:243], v[248:251], v[88:91], v[240:243]
    s_waitcnt lgkmcnt(15)
    v_mfma_f32_16x16x32_bf16 v[136:139], a[32:35], a[216:219], v[136:139]
    v_mfma_f32_16x16x32_bf16 v[244:247], v[248:251], v[92:95], v[244:247]
    v_cvt_pk_bf16_f32 v96, v96, v97
    v_cvt_pk_bf16_f32 v97, v98, v99
    v_mfma_f32_16x16x32_bf16 v[140:143], a[32:35], a[220:223], v[140:143]
    v_cvt_pk_bf16_f32 v98, v120, v121
    v_cvt_pk_bf16_f32 v99, v122, v123
    v_cvt_pk_bf16_f32 v100, v100, v101
    s_waitcnt lgkmcnt(14)
    v_mfma_f32_16x16x32_bf16 v[160:163], a[36:39], a[216:219], v[160:163]
    v_cvt_pk_bf16_f32 v101, v102, v103
    v_cvt_pk_bf16_f32 v102, v124, v125
    v_cvt_pk_bf16_f32 v103, v126, v127
    v_mfma_f32_16x16x32_bf16 v[164:167], a[36:39], a[220:223], v[164:167]
    v_mfma_f32_16x16x32_bf16 v[224:227], v[88:91], v[96:99], v[224:227]
    v_mfma_f32_16x16x32_bf16 v[228:231], v[92:95], v[96:99], v[228:231]
    v_mfma_f32_16x16x32_bf16 v[232:235], v[88:91], v[100:103], v[232:235]
    s_waitcnt lgkmcnt(13)
    v_mfma_f32_16x16x32_bf16 v[136:139], a[40:43], a[240:243], v[136:139]
    v_mfma_f32_16x16x32_bf16 v[236:239], v[92:95], v[100:103], v[236:239]
    v_pk_fma_f32 v[24:25], v[80:81], v[18:19], v[20:21]
    v_pk_fma_f32 v[26:27], v[82:83], v[18:19], v[20:21]
    v_mfma_f32_16x16x32_bf16 v[140:143], a[40:43], a[244:247], v[140:143]
    v_exp_f32 v24, v24 clamp
    v_pk_fma_f32 v[28:29], v[84:85], v[18:19], v[20:21]
    s_waitcnt lgkmcnt(12)
    v_mfma_f32_16x16x32_bf16 v[160:163], a[44:47], a[240:243], v[160:163]
    v_exp_f32 v25, v25 clamp
    v_max_f32 v80, v80, v24
    v_mfma_f32_16x16x32_bf16 v[164:167], a[44:47], a[244:247], v[164:167]
    v_exp_f32 v26, v26 clamp
    v_max_f32 v81, v81, v25
    v_mfma_f32_16x16x32_bf16 v[144:147], a[0:3], a[128:131], v[144:147]
    v_exp_f32 v27, v27 clamp
    v_max_f32 v82, v82, v26
    v_mfma_f32_16x16x32_bf16 v[148:151], a[0:3], a[132:135], v[148:151]
    v_max_f32 v83, v83, v27
    v_pk_add_f32 v[80:81], v[80:81], v[22:23]
    v_pk_add_f32 v[82:83], v[82:83], v[22:23]
    v_mfma_f32_16x16x32_bf16 v[168:171], a[4:7], a[128:131], v[168:171]
    v_pk_fma_f32 v[30:31], v[86:87], v[18:19], v[20:21]
    v_exp_f32 v28, v28 clamp
    v_mfma_f32_16x16x32_bf16 v[172:175], a[4:7], a[132:135], v[172:175]
    v_exp_f32 v29, v29 clamp
    v_max_f32 v84, v84, v28
    v_mfma_f32_16x16x32_bf16 v[144:147], a[8:11], a[152:155], v[144:147]
    v_exp_f32 v30, v30 clamp
    v_max_f32 v85, v85, v29
    v_mfma_f32_16x16x32_bf16 v[148:151], a[8:11], a[156:159], v[148:151]
    v_exp_f32 v31, v31 clamp
    v_max_f32 v86, v86, v30
    v_mfma_f32_16x16x32_bf16 v[168:171], a[12:15], a[152:155], v[168:171]
    v_max_f32 v87, v87, v31
    v_pk_add_f32 v[84:85], v[84:85], v[22:23]
    v_pk_add_f32 v[86:87], v[86:87], v[22:23]
    v_mfma_f32_16x16x32_bf16 v[172:175], a[12:15], a[156:159], v[172:175]
    v_cvt_pk_bf16_f32 v80, v80, v81
    v_cvt_pk_bf16_f32 v81, v82, v83
    v_cvt_pk_bf16_f32 v82, v84, v85
    v_mfma_f32_16x16x32_bf16 v[144:147], a[16:19], a[176:179], v[144:147]
    v_cvt_pk_bf16_f32 v83, v86, v87
    buffer_store_dwordx4 v[80:83], v4, s[12:15], s30 offen offset:2048 sc0 sc1
    v_pk_fma_f32 v[252:253], v[104:105], v[18:19], v[20:21]
    v_mfma_f32_16x16x32_bf16 v[148:151], a[16:19], a[180:183], v[148:151]
    v_pk_fma_f32 v[254:255], v[106:107], v[18:19], v[20:21]
    v_exp_f32 v252, v252 clamp
    v_mfma_f32_16x16x32_bf16 v[168:171], a[20:23], a[176:179], v[168:171]
    v_exp_f32 v253, v253 clamp
    v_max_f32 v104, v104, v252
    v_mfma_f32_16x16x32_bf16 v[172:175], a[20:23], a[180:183], v[172:175]
    v_exp_f32 v254, v254 clamp
    v_max_f32 v105, v105, v253
    v_mfma_f32_16x16x32_bf16 v[144:147], a[24:27], a[200:203], v[144:147]
    v_exp_f32 v255, v255 clamp
    v_max_f32 v106, v106, v254
    v_mfma_f32_16x16x32_bf16 v[148:151], a[24:27], a[204:207], v[148:151]
    v_max_f32 v107, v107, v255
    v_pk_add_f32 v[104:105], v[104:105], v[22:23]
    v_pk_add_f32 v[106:107], v[106:107], v[22:23]
    v_mfma_f32_16x16x32_bf16 v[168:171], a[28:31], a[200:203], v[168:171]
    v_pk_fma_f32 v[24:25], v[108:109], v[18:19], v[20:21]
    v_pk_fma_f32 v[26:27], v[110:111], v[18:19], v[20:21]
    v_cvt_pk_bf16_f32 v104, v104, v105
    v_mfma_f32_16x16x32_bf16 v[172:175], a[28:31], a[204:207], v[172:175]
    v_exp_f32 v24, v24 clamp
    v_cvt_pk_bf16_f32 v105, v106, v107
    v_mfma_f32_16x16x32_bf16 v[144:147], a[32:35], a[224:227], v[144:147]
    v_exp_f32 v25, v25 clamp
    v_max_f32 v108, v108, v24
    v_mfma_f32_16x16x32_bf16 v[148:151], a[32:35], a[228:231], v[148:151]
    v_exp_f32 v26, v26 clamp
    v_max_f32 v109, v109, v25
    v_mfma_f32_16x16x32_bf16 v[168:171], a[36:39], a[224:227], v[168:171]
    v_exp_f32 v27, v27 clamp
    v_max_f32 v110, v110, v26
    v_mfma_f32_16x16x32_bf16 v[172:175], a[36:39], a[228:231], v[172:175]
    v_max_f32 v111, v111, v27
    v_pk_add_f32 v[108:109], v[108:109], v[22:23]
    v_pk_add_f32 v[110:111], v[110:111], v[22:23]
    v_mfma_f32_16x16x32_bf16 v[144:147], a[40:43], a[248:251], v[144:147]
    v_cvt_pk_bf16_f32 v106, v108, v109
    v_cvt_pk_bf16_f32 v107, v110, v111
    buffer_store_dwordx4 v[104:107], v4, s[12:15], s30 offen offset:2304 sc0 sc1
    v_mfma_f32_16x16x32_bf16 v[148:151], a[40:43], a[252:255], v[148:151]
    v_pk_fma_f32 v[28:29], v[136:137], v[18:19], v[20:21]
    v_pk_fma_f32 v[30:31], v[138:139], v[18:19], v[20:21]
    v_pk_fma_f32 v[252:253], v[160:161], v[18:19], v[20:21]
    v_mfma_f32_16x16x32_bf16 v[168:171], a[44:47], a[248:251], v[168:171]
    v_exp_f32 v28, v28 clamp
    v_pk_fma_f32 v[254:255], v[162:163], v[18:19], v[20:21]
    v_mfma_f32_16x16x32_bf16 v[172:175], a[44:47], a[252:255], v[172:175]
    v_exp_f32 v29, v29 clamp
    v_max_f32 v136, v136, v28
    v_mfma_f32_16x16x32_bf16 v[128:131], a[112:115], a[0:3], v[128:131]
    v_exp_f32 v30, v30 clamp
    v_max_f32 v137, v137, v29
    v_mfma_f32_16x16x32_bf16 v[132:135], a[116:119], a[0:3], v[132:135]
    v_exp_f32 v31, v31 clamp
    v_max_f32 v138, v138, v30
    v_mfma_f32_16x16x32_bf16 v[152:155], a[112:115], a[4:7], v[152:155]
    v_max_f32 v139, v139, v31
    v_pk_add_f32 v[136:137], v[136:137], v[22:23]
    v_pk_add_f32 v[138:139], v[138:139], v[22:23]
    v_mfma_f32_16x16x32_bf16 v[156:159], a[116:119], a[4:7], v[156:159]
    v_exp_f32 v252, v252 clamp
    v_cvt_pk_bf16_f32 v136, v136, v137
    v_mfma_f32_16x16x32_bf16 v[128:131], a[136:139], a[8:11], v[128:131]
    v_exp_f32 v253, v253 clamp
    v_max_f32 v160, v160, v252
    v_mfma_f32_16x16x32_bf16 v[132:135], a[140:143], a[8:11], v[132:135]
    v_exp_f32 v254, v254 clamp
    v_max_f32 v161, v161, v253
    v_mfma_f32_16x16x32_bf16 v[152:155], a[136:139], a[12:15], v[152:155]
    v_exp_f32 v255, v255 clamp
    v_max_f32 v162, v162, v254
    v_mfma_f32_16x16x32_bf16 v[156:159], a[140:143], a[12:15], v[156:159]
    v_max_f32 v163, v163, v255
    v_pk_add_f32 v[160:161], v[160:161], v[22:23]
    v_pk_add_f32 v[162:163], v[162:163], v[22:23]
    v_mfma_f32_16x16x32_bf16 v[128:131], a[160:163], a[16:19], v[128:131]
    v_cvt_pk_bf16_f32 v137, v138, v139
    v_cvt_pk_bf16_f32 v138, v160, v161
    v_cvt_pk_bf16_f32 v139, v162, v163
    v_mfma_f32_16x16x32_bf16 v[132:135], a[164:167], a[16:19], v[132:135]
    v_pk_fma_f32 v[24:25], v[140:141], v[18:19], v[20:21]
    v_pk_fma_f32 v[26:27], v[142:143], v[18:19], v[20:21]
    v_pk_fma_f32 v[28:29], v[164:165], v[18:19], v[20:21]
    v_mfma_f32_16x16x32_bf16 v[152:155], a[160:163], a[20:23], v[152:155]
    v_exp_f32 v24, v24 clamp
    v_pk_fma_f32 v[30:31], v[166:167], v[18:19], v[20:21]
    v_mfma_f32_16x16x32_bf16 v[156:159], a[164:167], a[20:23], v[156:159]
    v_exp_f32 v25, v25 clamp
    v_max_f32 v140, v140, v24
    v_mfma_f32_16x16x32_bf16 v[128:131], a[184:187], a[24:27], v[128:131]
    v_exp_f32 v26, v26 clamp
    v_max_f32 v141, v141, v25
    v_mfma_f32_16x16x32_bf16 v[132:135], a[188:191], a[24:27], v[132:135]
    v_exp_f32 v27, v27 clamp
    v_max_f32 v142, v142, v26
    v_mfma_f32_16x16x32_bf16 v[152:155], a[184:187], a[28:31], v[152:155]
    v_max_f32 v143, v143, v27
    v_pk_add_f32 v[140:141], v[140:141], v[22:23]
    v_pk_add_f32 v[142:143], v[142:143], v[22:23]
    v_mfma_f32_16x16x32_bf16 v[156:159], a[188:191], a[28:31], v[156:159]
    v_exp_f32 v28, v28 clamp
    v_cvt_pk_bf16_f32 v140, v140, v141
    v_mfma_f32_16x16x32_bf16 v[128:131], a[208:211], a[32:35], v[128:131]
    v_exp_f32 v29, v29 clamp
    v_max_f32 v164, v164, v28
    v_mfma_f32_16x16x32_bf16 v[132:135], a[212:215], a[32:35], v[132:135]
    v_exp_f32 v30, v30 clamp
    v_max_f32 v165, v165, v29
    v_mfma_f32_16x16x32_bf16 v[152:155], a[208:211], a[36:39], v[152:155]
    v_exp_f32 v31, v31 clamp
    v_max_f32 v166, v166, v30
    v_mfma_f32_16x16x32_bf16 v[156:159], a[212:215], a[36:39], v[156:159]
    v_max_f32 v167, v167, v31
    v_pk_add_f32 v[164:165], v[164:165], v[22:23]
    v_pk_add_f32 v[166:167], v[166:167], v[22:23]
    v_mfma_f32_16x16x32_bf16 v[128:131], a[232:235], a[40:43], v[128:131]
    v_cvt_pk_bf16_f32 v141, v142, v143
    v_cvt_pk_bf16_f32 v142, v164, v165
    v_cvt_pk_bf16_f32 v143, v166, v167
    v_mfma_f32_16x16x32_bf16 v[132:135], a[236:239], a[40:43], v[132:135]
    v_mfma_f32_16x16x32_bf16 v[240:243], v[248:251], v[136:139], v[240:243]
    v_mfma_f32_16x16x32_bf16 v[244:247], v[248:251], v[140:143], v[244:247]
    v_cvt_pk_bf16_f32 v144, v144, v145
    v_mfma_f32_16x16x32_bf16 v[152:155], a[232:235], a[44:47], v[152:155]
    v_cvt_pk_bf16_f32 v145, v146, v147
    v_cvt_pk_bf16_f32 v146, v168, v169
    v_cvt_pk_bf16_f32 v147, v170, v171
    v_mfma_f32_16x16x32_bf16 v[156:159], a[236:239], a[44:47], v[156:159]
    v_cvt_pk_bf16_f32 v148, v148, v149
    v_cvt_pk_bf16_f32 v149, v150, v151
    v_cvt_pk_bf16_f32 v150, v172, v173
    s_waitcnt lgkmcnt(11)
    v_mfma_f32_16x16x32_bf16 v[184:187], a[56:59], a[120:123], v[184:187]
    v_cvt_pk_bf16_f32 v151, v174, v175
    v_mfma_f32_16x16x32_bf16 v[224:227], v[136:139], v[144:147], v[224:227]
    v_mfma_f32_16x16x32_bf16 v[228:231], v[140:143], v[144:147], v[228:231]
    v_mfma_f32_16x16x32_bf16 v[188:191], a[56:59], a[124:127], v[188:191]
    v_mfma_f32_16x16x32_bf16 v[232:235], v[136:139], v[148:151], v[232:235]
    v_mfma_f32_16x16x32_bf16 v[236:239], v[140:143], v[148:151], v[236:239]
    s_waitcnt lgkmcnt(10)
    v_mfma_f32_16x16x32_bf16 v[208:211], a[60:63], a[120:123], v[208:211]
    v_pk_fma_f32 v[252:253], v[128:129], v[18:19], v[20:21]
    v_pk_fma_f32 v[254:255], v[130:131], v[18:19], v[20:21]
    v_pk_fma_f32 v[24:25], v[132:133], v[18:19], v[20:21]
    v_mfma_f32_16x16x32_bf16 v[212:215], a[60:63], a[124:127], v[212:215]
    v_exp_f32 v252, v252 clamp
    v_pk_fma_f32 v[26:27], v[134:135], v[18:19], v[20:21]
    s_waitcnt lgkmcnt(9)
    v_mfma_f32_16x16x32_bf16 v[184:187], a[64:67], a[144:147], v[184:187]
    v_exp_f32 v253, v253 clamp
    v_max_f32 v128, v128, v252
    v_mfma_f32_16x16x32_bf16 v[188:191], a[64:67], a[148:151], v[188:191]
    v_exp_f32 v254, v254 clamp
    v_max_f32 v129, v129, v253
    s_waitcnt lgkmcnt(8)
    v_mfma_f32_16x16x32_bf16 v[208:211], a[68:71], a[144:147], v[208:211]
    v_exp_f32 v255, v255 clamp
    v_max_f32 v130, v130, v254
    v_mfma_f32_16x16x32_bf16 v[212:215], a[68:71], a[148:151], v[212:215]
    v_max_f32 v131, v131, v255
    v_pk_add_f32 v[128:129], v[128:129], v[22:23]
    v_pk_add_f32 v[130:131], v[130:131], v[22:23]
    s_waitcnt lgkmcnt(7)
    v_mfma_f32_16x16x32_bf16 v[184:187], a[72:75], a[168:171], v[184:187]
    v_exp_f32 v24, v24 clamp
    v_cvt_pk_bf16_f32 v128, v128, v129
    v_mfma_f32_16x16x32_bf16 v[188:191], a[72:75], a[172:175], v[188:191]
    v_exp_f32 v25, v25 clamp
    v_max_f32 v132, v132, v24
    s_waitcnt lgkmcnt(6)
    v_mfma_f32_16x16x32_bf16 v[208:211], a[76:79], a[168:171], v[208:211]
    v_exp_f32 v26, v26 clamp
    v_max_f32 v133, v133, v25
    v_mfma_f32_16x16x32_bf16 v[212:215], a[76:79], a[172:175], v[212:215]
    v_exp_f32 v27, v27 clamp
    v_max_f32 v134, v134, v26
    s_waitcnt lgkmcnt(5)
    v_mfma_f32_16x16x32_bf16 v[184:187], a[80:83], a[192:195], v[184:187]
    v_max_f32 v135, v135, v27
    v_pk_add_f32 v[132:133], v[132:133], v[22:23]
    v_pk_add_f32 v[134:135], v[134:135], v[22:23]
    v_mfma_f32_16x16x32_bf16 v[188:191], a[80:83], a[196:199], v[188:191]
    v_cvt_pk_bf16_f32 v129, v130, v131
    v_cvt_pk_bf16_f32 v130, v132, v133
    v_cvt_pk_bf16_f32 v131, v134, v135
    s_waitcnt lgkmcnt(4)
    v_mfma_f32_16x16x32_bf16 v[208:211], a[84:87], a[192:195], v[208:211]
    buffer_store_dwordx4 v[128:131], v4, s[12:15], s31 offen offset:0 sc0 sc1
    v_pk_fma_f32 v[28:29], v[152:153], v[18:19], v[20:21]
    v_pk_fma_f32 v[30:31], v[154:155], v[18:19], v[20:21]
    v_mfma_f32_16x16x32_bf16 v[212:215], a[84:87], a[196:199], v[212:215]
    v_exp_f32 v28, v28 clamp
    v_pk_fma_f32 v[252:253], v[156:157], v[18:19], v[20:21]
    s_waitcnt lgkmcnt(3)
    v_mfma_f32_16x16x32_bf16 v[184:187], a[88:91], a[216:219], v[184:187]
    v_exp_f32 v29, v29 clamp
    v_max_f32 v152, v152, v28
    v_mfma_f32_16x16x32_bf16 v[188:191], a[88:91], a[220:223], v[188:191]
    v_exp_f32 v30, v30 clamp
    v_max_f32 v153, v153, v29
    s_waitcnt lgkmcnt(2)
    v_mfma_f32_16x16x32_bf16 v[208:211], a[92:95], a[216:219], v[208:211]
    v_exp_f32 v31, v31 clamp
    v_max_f32 v154, v154, v30
    v_mfma_f32_16x16x32_bf16 v[212:215], a[92:95], a[220:223], v[212:215]
    v_max_f32 v155, v155, v31
    v_pk_add_f32 v[152:153], v[152:153], v[22:23]
    v_pk_add_f32 v[154:155], v[154:155], v[22:23]
    s_waitcnt lgkmcnt(1)
    v_mfma_f32_16x16x32_bf16 v[184:187], a[96:99], a[240:243], v[184:187]
    v_pk_fma_f32 v[254:255], v[158:159], v[18:19], v[20:21]
    v_exp_f32 v252, v252 clamp
    v_mfma_f32_16x16x32_bf16 v[188:191], a[96:99], a[244:247], v[188:191]
    v_exp_f32 v253, v253 clamp
    v_max_f32 v156, v156, v252
    s_waitcnt lgkmcnt(0)
    v_mfma_f32_16x16x32_bf16 v[208:211], a[100:103], a[240:243], v[208:211]
    v_exp_f32 v254, v254 clamp
    v_max_f32 v157, v157, v253
    v_mfma_f32_16x16x32_bf16 v[212:215], a[100:103], a[244:247], v[212:215]
    v_exp_f32 v255, v255 clamp
    v_max_f32 v158, v158, v254
    v_mfma_f32_16x16x32_bf16 v[192:195], a[56:59], a[128:131], v[192:195]
    v_max_f32 v159, v159, v255
    v_pk_add_f32 v[156:157], v[156:157], v[22:23]
    v_pk_add_f32 v[158:159], v[158:159], v[22:23]
    v_mfma_f32_16x16x32_bf16 v[196:199], a[56:59], a[132:135], v[196:199]
    v_cvt_pk_bf16_f32 v152, v152, v153
    v_cvt_pk_bf16_f32 v153, v154, v155
    v_cvt_pk_bf16_f32 v154, v156, v157
    v_mfma_f32_16x16x32_bf16 v[216:219], a[60:63], a[128:131], v[216:219]
    v_cvt_pk_bf16_f32 v155, v158, v159
    buffer_store_dwordx4 v[152:155], v4, s[12:15], s31 offen offset:256 sc0 sc1
    v_pk_fma_f32 v[24:25], v[184:185], v[18:19], v[20:21]
    v_mfma_f32_16x16x32_bf16 v[220:223], a[60:63], a[132:135], v[220:223]
    v_pk_fma_f32 v[26:27], v[186:187], v[18:19], v[20:21]
    v_exp_f32 v24, v24 clamp
    v_mfma_f32_16x16x32_bf16 v[192:195], a[64:67], a[152:155], v[192:195]
    v_exp_f32 v25, v25 clamp
    v_max_f32 v184, v184, v24
    v_mfma_f32_16x16x32_bf16 v[196:199], a[64:67], a[156:159], v[196:199]
    v_exp_f32 v26, v26 clamp
    v_max_f32 v185, v185, v25
    v_mfma_f32_16x16x32_bf16 v[216:219], a[68:71], a[152:155], v[216:219]
    v_exp_f32 v27, v27 clamp
    v_max_f32 v186, v186, v26
    v_mfma_f32_16x16x32_bf16 v[220:223], a[68:71], a[156:159], v[220:223]
    v_max_f32 v187, v187, v27
    v_pk_add_f32 v[184:185], v[184:185], v[22:23]
    v_pk_add_f32 v[186:187], v[186:187], v[22:23]
    v_mfma_f32_16x16x32_bf16 v[192:195], a[72:75], a[176:179], v[192:195]
    v_pk_fma_f32 v[28:29], v[208:209], v[18:19], v[20:21]
    v_pk_fma_f32 v[30:31], v[210:211], v[18:19], v[20:21]
    v_cvt_pk_bf16_f32 v184, v184, v185
    v_mfma_f32_16x16x32_bf16 v[196:199], a[72:75], a[180:183], v[196:199]
    v_exp_f32 v28, v28 clamp
    v_cvt_pk_bf16_f32 v185, v186, v187
    v_mfma_f32_16x16x32_bf16 v[216:219], a[76:79], a[176:179], v[216:219]
    v_exp_f32 v29, v29 clamp
    v_max_f32 v208, v208, v28
    v_mfma_f32_16x16x32_bf16 v[220:223], a[76:79], a[180:183], v[220:223]
    v_exp_f32 v30, v30 clamp
    v_max_f32 v209, v209, v29
    v_mfma_f32_16x16x32_bf16 v[192:195], a[80:83], a[200:203], v[192:195]
    v_exp_f32 v31, v31 clamp
    v_max_f32 v210, v210, v30
    v_mfma_f32_16x16x32_bf16 v[196:199], a[80:83], a[204:207], v[196:199]
    v_max_f32 v211, v211, v31
    v_pk_add_f32 v[208:209], v[208:209], v[22:23]
    v_pk_add_f32 v[210:211], v[210:211], v[22:23]
    v_mfma_f32_16x16x32_bf16 v[216:219], a[84:87], a[200:203], v[216:219]
    v_cvt_pk_bf16_f32 v186, v208, v209
    v_cvt_pk_bf16_f32 v187, v210, v211
    v_pk_fma_f32 v[252:253], v[188:189], v[18:19], v[20:21]
    v_mfma_f32_16x16x32_bf16 v[220:223], a[84:87], a[204:207], v[220:223]
    v_pk_fma_f32 v[254:255], v[190:191], v[18:19], v[20:21]
    v_exp_f32 v252, v252 clamp
    v_mfma_f32_16x16x32_bf16 v[192:195], a[88:91], a[224:227], v[192:195]
    v_exp_f32 v253, v253 clamp
    v_max_f32 v188, v188, v252
    v_mfma_f32_16x16x32_bf16 v[196:199], a[88:91], a[228:231], v[196:199]
    v_exp_f32 v254, v254 clamp
    v_max_f32 v189, v189, v253
    v_mfma_f32_16x16x32_bf16 v[216:219], a[92:95], a[224:227], v[216:219]
    v_exp_f32 v255, v255 clamp
    v_max_f32 v190, v190, v254
    v_mfma_f32_16x16x32_bf16 v[220:223], a[92:95], a[228:231], v[220:223]
    v_max_f32 v191, v191, v255
    v_pk_add_f32 v[188:189], v[188:189], v[22:23]
    v_pk_add_f32 v[190:191], v[190:191], v[22:23]
    v_mfma_f32_16x16x32_bf16 v[192:195], a[96:99], a[248:251], v[192:195]
    v_pk_fma_f32 v[24:25], v[212:213], v[18:19], v[20:21]
    v_pk_fma_f32 v[26:27], v[214:215], v[18:19], v[20:21]
    v_cvt_pk_bf16_f32 v188, v188, v189
    v_mfma_f32_16x16x32_bf16 v[196:199], a[96:99], a[252:255], v[196:199]
    v_exp_f32 v24, v24 clamp
    v_cvt_pk_bf16_f32 v189, v190, v191
    v_mfma_f32_16x16x32_bf16 v[216:219], a[100:103], a[248:251], v[216:219]
    v_exp_f32 v25, v25 clamp
    v_max_f32 v212, v212, v24
    v_mfma_f32_16x16x32_bf16 v[220:223], a[100:103], a[252:255], v[220:223]
    v_exp_f32 v26, v26 clamp
    v_max_f32 v213, v213, v25
    v_mfma_f32_16x16x32_bf16 v[176:179], a[112:115], a[56:59], v[176:179]
    v_exp_f32 v27, v27 clamp
    v_max_f32 v214, v214, v26
    v_mfma_f32_16x16x32_bf16 v[180:183], a[116:119], a[56:59], v[180:183]
    v_max_f32 v215, v215, v27
    v_pk_add_f32 v[212:213], v[212:213], v[22:23]
    v_pk_add_f32 v[214:215], v[214:215], v[22:23]
    v_mfma_f32_16x16x32_bf16 v[200:203], a[112:115], a[60:63], v[200:203]
    v_cvt_pk_bf16_f32 v190, v212, v213
    v_cvt_pk_bf16_f32 v191, v214, v215
    v_mfma_f32_16x16x32_bf16 v[240:243], v[248:251], v[184:187], v[240:243]
    v_mfma_f32_16x16x32_bf16 v[204:207], a[116:119], a[60:63], v[204:207]
    v_mfma_f32_16x16x32_bf16 v[244:247], v[248:251], v[188:191], v[244:247]
    v_cvt_pk_bf16_f32 v192, v192, v193
    v_cvt_pk_bf16_f32 v193, v194, v195
    v_mfma_f32_16x16x32_bf16 v[176:179], a[136:139], a[64:67], v[176:179]
    v_cvt_pk_bf16_f32 v194, v216, v217
    v_cvt_pk_bf16_f32 v195, v218, v219
    v_cvt_pk_bf16_f32 v196, v196, v197
    v_mfma_f32_16x16x32_bf16 v[180:183], a[140:143], a[64:67], v[180:183]
    v_cvt_pk_bf16_f32 v197, v198, v199
    v_cvt_pk_bf16_f32 v198, v220, v221
    v_cvt_pk_bf16_f32 v199, v222, v223
    v_mfma_f32_16x16x32_bf16 v[200:203], a[136:139], a[68:71], v[200:203]
    v_mfma_f32_16x16x32_bf16 v[224:227], v[184:187], v[192:195], v[224:227]
    v_mfma_f32_16x16x32_bf16 v[228:231], v[188:191], v[192:195], v[228:231]
    v_mfma_f32_16x16x32_bf16 v[232:235], v[184:187], v[196:199], v[232:235]
    v_mfma_f32_16x16x32_bf16 v[204:207], a[140:143], a[68:71], v[204:207]
    v_mfma_f32_16x16x32_bf16 v[236:239], v[188:191], v[196:199], v[236:239]
    v_mfma_f32_16x16x32_bf16 v[176:179], a[160:163], a[72:75], v[176:179]
    s_nop 7
    s_nop 3
    v_mfma_f32_16x16x32_bf16 v[180:183], a[164:167], a[72:75], v[180:183]
    buffer_store_dwordx4 v[224:227], v6, s[12:15], s32 offen offset:0 sc0 sc1
    buffer_store_dwordx4 v[228:231], v6, s[12:15], s32 offen offset:1024 sc0 sc1
    buffer_store_dwordx4 v[232:235], v6, s[12:15], s32 offen offset:2048 sc0 sc1
    v_mfma_f32_16x16x32_bf16 v[200:203], a[160:163], a[76:79], v[200:203]
    buffer_store_dwordx4 v[236:239], v6, s[12:15], s32 offen offset:3072 sc0 sc1
    v_mfma_f32_16x16x32_bf16 v[204:207], a[164:167], a[76:79], v[204:207]
    s_mov_b64 exec, 0xffff
    buffer_store_dword v240, v7, s[12:15], s33 offen sc0 sc1
    buffer_store_dword v244, v7, s[12:15], s33 offen offset:64 sc0 sc1
    s_mov_b64 exec, -1
    v_mfma_f32_16x16x32_bf16 v[176:179], a[184:187], a[80:83], v[176:179]
    v_mfma_f32_16x16x32_bf16 v[180:183], a[188:191], a[80:83], v[180:183]
    v_mfma_f32_16x16x32_bf16 v[200:203], a[184:187], a[84:87], v[200:203]
    v_mfma_f32_16x16x32_bf16 v[204:207], a[188:191], a[84:87], v[204:207]
    v_mfma_f32_16x16x32_bf16 v[176:179], a[208:211], a[88:91], v[176:179]
    v_mfma_f32_16x16x32_bf16 v[180:183], a[212:215], a[88:91], v[180:183]
    v_mfma_f32_16x16x32_bf16 v[200:203], a[208:211], a[92:95], v[200:203]
    v_mfma_f32_16x16x32_bf16 v[204:207], a[212:215], a[92:95], v[204:207]
    v_mfma_f32_16x16x32_bf16 v[176:179], a[232:235], a[96:99], v[176:179]
    v_mfma_f32_16x16x32_bf16 v[180:183], a[236:239], a[96:99], v[180:183]
    v_mfma_f32_16x16x32_bf16 v[200:203], a[232:235], a[100:103], v[200:203]
    v_mfma_f32_16x16x32_bf16 v[204:207], a[236:239], a[100:103], v[204:207]
    s_nop 0
    s_nop 0
    s_nop 0
    s_nop 0
    s_nop 0
    s_nop 0
    s_nop 0
    s_nop 0
    s_nop 0
    s_nop 0
    s_nop 0
    s_nop 0
    v_pk_fma_f32 v[28:29], v[176:177], v[18:19], v[20:21]
    v_pk_fma_f32 v[30:31], v[178:179], v[18:19], v[20:21]
    v_exp_f32 v28, v28 clamp
    v_exp_f32 v29, v29 clamp
    v_exp_f32 v30, v30 clamp
    v_exp_f32 v31, v31 clamp
    v_max_f32 v176, v176, v28
    v_max_f32 v177, v177, v29
    v_max_f32 v178, v178, v30
    v_max_f32 v179, v179, v31
    v_pk_add_f32 v[176:177], v[176:177], v[22:23]
    v_pk_add_f32 v[178:179], v[178:179], v[22:23]
    v_pk_fma_f32 v[252:253], v[180:181], v[18:19], v[20:21]
    v_pk_fma_f32 v[254:255], v[182:183], v[18:19], v[20:21]
    v_exp_f32 v252, v252 clamp
    v_exp_f32 v253, v253 clamp
    v_exp_f32 v254, v254 clamp
    v_exp_f32 v255, v255 clamp
    v_max_f32 v180, v180, v252
    v_max_f32 v181, v181, v253
    v_max_f32 v182, v182, v254
    v_max_f32 v183, v183, v255
    v_pk_add_f32 v[180:181], v[180:181], v[22:23]
    v_pk_add_f32 v[182:183], v[182:183], v[22:23]
    v_cvt_pk_bf16_f32 v176, v176, v177
    v_cvt_pk_bf16_f32 v177, v178, v179
    v_cvt_pk_bf16_f32 v178, v180, v181
    v_cvt_pk_bf16_f32 v179, v182, v183
    buffer_store_dwordx4 v[176:179], v4, s[12:15], s31 offen offset:2048 sc0 sc1
    v_pk_fma_f32 v[24:25], v[200:201], v[18:19], v[20:21]
    v_pk_fma_f32 v[26:27], v[202:203], v[18:19], v[20:21]
    v_exp_f32 v24, v24 clamp
    v_exp_f32 v25, v25 clamp
    v_exp_f32 v26, v26 clamp
    v_exp_f32 v27, v27 clamp
    v_max_f32 v200, v200, v24
    v_max_f32 v201, v201, v25
    v_max_f32 v202, v202, v26
    v_max_f32 v203, v203, v27
    v_pk_add_f32 v[200:201], v[200:201], v[22:23]
    v_pk_add_f32 v[202:203], v[202:203], v[22:23]
    v_pk_fma_f32 v[28:29], v[204:205], v[18:19], v[20:21]
    v_pk_fma_f32 v[30:31], v[206:207], v[18:19], v[20:21]
    v_exp_f32 v28, v28 clamp
    v_exp_f32 v29, v29 clamp
    v_exp_f32 v30, v30 clamp
    v_exp_f32 v31, v31 clamp
    v_max_f32 v204, v204, v28
    v_max_f32 v205, v205, v29
    v_max_f32 v206, v206, v30
    v_max_f32 v207, v207, v31
    v_pk_add_f32 v[204:205], v[204:205], v[22:23]
    v_pk_add_f32 v[206:207], v[206:207], v[22:23]
    v_cvt_pk_bf16_f32 v200, v200, v201
    v_cvt_pk_bf16_f32 v201, v202, v203
    v_cvt_pk_bf16_f32 v202, v204, v205
    v_cvt_pk_bf16_f32 v203, v206, v207
    buffer_store_dwordx4 v[200:203], v4, s[12:15], s31 offen offset:2304 sc0 sc1
L_qkv_kernel_fin:
L_qkv_kernel_end:
    s_endpgm
.globl attn_kernel
.p2align 8
.type attn_kernel,@function
attn_kernel:

    s_cmp_ge_u32 s2, 256
    s_cbranch_scc1 L_attn_kernel_end

    s_load_dwordx2 s[12:13], s[0:1], 64
    s_load_dwordx2 s[36:37], s[0:1], 16
    s_load_dwordx2 s[38:39], s[0:1], 40
    v_lshrrev_b32 v1, 6, v0
    v_and_b32 v0, 63, v0
    s_and_b32 s17, s2, 7
    v_readfirstlane_b32 s16, v1
    s_lshl_b32 s17, s17, 2
    s_lshr_b32 s28, s2, 6
    s_add_u32 s17, s17, s28
    s_bfe_u32 s18, s2, 0x30003
    v_lshlrev_b32 v2, 4, v0
    s_mov_b32 s14, 29360128
    s_mov_b32 s15, 0x20000
    s_lshl_b32 s19, s17, 18
    s_add_u32 s19, s19, 4194304
    s_lshl_b32 s28, s16, 12
    s_add_u32 s20, s19, s28
    s_mov_b32 s21, s28
    s_lshl_b32 s29, s18, 3
    s_add_u32 s29, s29, s16
    s_lshl_b32 s22, s17, 17
    s_lshl_b32 s30, s29, 11
    s_add_u32 s22, s22, s30
    s_lshl_b32 s23, s29, 16
    s_lshl_b32 s30, s17, 11
    s_add_u32 s23, s23, s30
    s_mov_b32 m0, s21
    s_add_u32 s26, s22, 12582912
    s_add_u32 s22, s22, 0
    s_mov_b32 s27, 0

    s_waitcnt lgkmcnt(0)
    buffer_load_dwordx4 v2, s[12:15], s20 offen offset:0 lds
    buffer_load_dwordx4 v2, s[12:15], s20 offen offset:1024 lds
    buffer_load_dwordx4 v2, s[12:15], s20 offen offset:2048 lds
    buffer_load_dwordx4 v2, s[12:15], s20 offen offset:3072 lds
    buffer_load_dwordx4 v[12:15], v2, s[12:15], s22 offen offset:0
    buffer_load_dwordx4 v[16:19], v2, s[12:15], s22 offen offset:1024
    s_add_u32 s27, s27, 1
    s_add_u32 s20, s20, 32768
    s_cmp_ge_u32 s27, 8
    s_cselect_b32 s20, 0x40000000, s20
    s_add_u32 s21, s21, 32768
    s_and_b32 s21, s21, 131071
    s_mov_b32 m0, s21
    s_nop 0
    v_bfe_u32 v1, v0, 4, 1
    v_lshlrev_b32 v5, 11, v1
    v_lshrrev_b32 v1, 5, v0
    v_lshl_add_u32 v5, v1, 15, v5
    v_and_b32 v1, 15, v0
    v_lshl_add_u32 v5, v1, 4, v5
    v_lshlrev_b32 v6, 7, v1
    s_bfe_u32 s28, s16, 0x10001
    s_and_b32 s29, s16, 1
    s_lshr_b32 s30, s16, 2
    s_lshl_b32 s24, s17, 16
    s_add_u32 s24, s24, 25165824
    s_lshl_b32 s31, s29, 10
    s_add_u32 s24, s24, s31
    s_lshl_b32 s31, s28, 9
    s_add_u32 s24, s24, s31
    s_lshl_b32 s31, s30, 8
    s_add_u32 s24, s24, s31
    s_lshl_b32 s25, s17, 11
    s_add_u32 s25, s25, 27262976
    s_lshl_b32 s31, s29, 6
    s_add_u32 s25, s25, s31
    s_lshl_b32 s31, s28, 5
    s_add_u32 s25, s25, s31
    s_lshl_b32 s31, s30, 4
    s_add_u32 s25, s25, s31
    v_mov_b32 v3, v2
    v_add_u32 v4, 32768, v2
    s_mov_b32 s33, 32768
    v_lshrrev_b32 v1, 4, v0
    v_lshrrev_b32 v7, 2, v0
    v_xor_b32 v1, v1, v7
    v_and_b32 v1, 1, v1
    v_cmp_eq_u32 vcc, 0, v1
    v_mov_b32 v1, 0x3f803f80
    v_cndmask_b32 v28, 0, v1, vcc
    v_cndmask_b32 v29, 0, v1, vcc
    v_cndmask_b32 v30, 0, v1, vcc
    v_cndmask_b32 v31, 0, v1, vcc
    s_and_b32 s28, s16, 3
    s_lshl_b32 s28, s28, 10
    s_lshl_b32 s31, s30, 9
    s_add_u32 s28, s28, s31
    s_add_u32 s28, s28, 131072
    v_and_b32 v1, 31, v0
    v_lshlrev_b32 v1, 4, v1
    v_add_u32 v7, s28, v1
    v_add_u32 v8, 131072, v2
    v_lshlrev_b32 v9, 5, v0
    s_bitcmp1_b32 s2, 7
    s_cselect_b32 s8, s38, s36
    s_cselect_b32 s9, s39, s37
    s_mov_b32 s10, 2097152
    s_mov_b32 s11, 0x20000
    s_and_b32 s28, s2, 127
    s_lshl_b32 s28, s28, 3
    s_add_u32 s28, s28, s16
    s_lshl_b32 s32, s28, 11
    s_lshl_b32 s28, s16, 2
    s_add_u32 s28, s28, 135168
    v_mov_b32 v184, s28
    v_and_b32 v1, 7, v0
    v_lshlrev_b32 v1, 2, v1
    v_add_u32 v185, 135168, v1
    v_mov_b32 v187, 0
    ds_write_b32 v184, v187

    v_mov_b32 v72, 0
    v_mov_b32 v73, 0
    v_mov_b32 v74, 0
    v_mov_b32 v75, 0
    v_mov_b32 v76, 0
    v_mov_b32 v77, 0
    v_mov_b32 v78, 0
    v_mov_b32 v79, 0
    v_mov_b32 v80, 0
    v_mov_b32 v81, 0
    v_mov_b32 v82, 0
    v_mov_b32 v83, 0
    v_mov_b32 v84, 0
    v_mov_b32 v85, 0
    v_mov_b32 v86, 0
    v_mov_b32 v87, 0
    v_mov_b32 v88, 0
    v_mov_b32 v68, 0
    v_mov_b32 v124, 0
    v_mov_b32 v89, 0
    v_mov_b32 v69, 0
    v_mov_b32 v125, 0
    v_mov_b32 v90, 0
    v_mov_b32 v70, 0
    v_mov_b32 v126, 0
    v_mov_b32 v91, 0
    v_mov_b32 v71, 0
    v_mov_b32 v127, 0
    s_waitcnt vmcnt(0) lgkmcnt(0)
    buffer_load_dwordx4 v2, s[12:15], s20 offen offset:0 lds
    buffer_load_dwordx4 v2, s[12:15], s20 offen offset:1024 lds
    buffer_load_dwordx4 v2, s[12:15], s20 offen offset:2048 lds
    buffer_load_dwordx4 v2, s[12:15], s20 offen offset:3072 lds
    s_add_u32 s27, s27, 1
    s_add_u32 s20, s20, 32768
    s_cmp_ge_u32 s27, 8
    s_cselect_b32 s20, 0x40000000, s20
    s_add_u32 s21, s21, 32768
    s_and_b32 s21, s21, 131071
    s_mov_b32 m0, s21
    s_barrier
    ds_read_b128 v[96:99], v3 offset:0
    ds_read_b128 v[100:103], v3 offset:1024
    ds_read_b128 v[104:107], v3 offset:4096
    ds_read_b128 v[108:111], v3 offset:5120
    ds_read_b128 v[112:115], v3 offset:2048
    ds_read_b128 v[116:119], v3 offset:3072
    s_waitcnt lgkmcnt(4)
    v_mfma_f32_32x32x16_bf16 v[32:47], v[96:99], v[12:15], 0
    v_mfma_f32_32x32x16_bf16 v[32:47], v[100:103], v[16:19], v[32:47]
    buffer_load_dwordx4 v2, s[12:15], s20 offen offset:0 lds
    buffer_load_dwordx4 v2, s[12:15], s20 offen offset:1024 lds
    buffer_load_dwordx4 v2, s[12:15], s20 offen offset:2048 lds
    buffer_load_dwordx4 v2, s[12:15], s20 offen offset:3072 lds
    s_add_u32 s27, s27, 1
    s_add_u32 s20, s20, 32768
    s_cmp_ge_u32 s27, 8
    s_cselect_b32 s20, 0x40000000, s20
    s_add_u32 s21, s21, 32768
    s_and_b32 s21, s21, 131071
    s_mov_b32 m0, s21
    s_waitcnt lgkmcnt(0)
    s_setprio 1
    v_mfma_f32_32x32x16_bf16 v[48:63], v[104:107], v[12:15], 0
    v_exp_f32 v32, v32
    ds_read_b128 v[96:99], v3 offset:8192
    v_exp_f32 v33, v33
    ds_read_b128 v[100:103], v3 offset:9216
    v_exp_f32 v34, v34
    ds_read_b128 v[120:123], v3 offset:6144
    v_exp_f32 v35, v35
    v_mfma_f32_32x32x16_bf16 v[72:87], v[124:127], v[68:71], v[72:87]
    v_exp_f32 v36, v36
    ds_read_b128 v[124:127], v3 offset:7168
    v_exp_f32 v37, v37
    buffer_load_dwordx4 v[128:131], v5, s[12:15], s24 offen
    s_add_u32 s24, s24, 4096
    v_exp_f32 v38, v38
    buffer_load_dwordx4 v[132:135], v5, s[12:15], s24 offen
    s_add_u32 s24, s24, 4096
    v_exp_f32 v39, v39
    v_mfma_f32_16x16x32_bf16 v[88:91], v[28:31], v[68:71], v[88:91]
    v_cvt_pk_bf16_f32 v64, v32, v33
    v_cvt_pk_bf16_f32 v65, v34, v35
    v_cvt_pk_bf16_f32 v66, v36, v37
    v_cvt_pk_bf16_f32 v67, v38, v39
    v_mfma_f32_32x32x16_bf16 v[48:63], v[108:111], v[16:19], v[48:63]
    v_exp_f32 v40, v40
    buffer_load_dwordx4 v[136:139], v5, s[12:15], s24 offen
    s_add_u32 s24, s24, 4096
    v_exp_f32 v41, v41
    buffer_load_dwordx4 v[140:143], v5, s[12:15], s24 offen
    s_add_u32 s24, s24, 4096
    v_exp_f32 v42, v42
    buffer_load_dwordx4 v[144:147], v5, s[12:15], s24 offen
    s_add_u32 s24, s24, 4096
    v_exp_f32 v43, v43
    v_mfma_f32_32x32x16_bf16 v[72:87], v[112:115], v[64:67], v[72:87]
    v_exp_f32 v44, v44
    buffer_load_dwordx4 v[148:151], v5, s[12:15], s24 offen
    s_add_u32 s24, s24, 4096
    v_exp_f32 v45, v45
    buffer_load_dwordx4 v[152:155], v5, s[12:15], s24 offen
    s_add_u32 s24, s24, 4096
    v_exp_f32 v46, v46
    v_exp_f32 v47, v47
    s_waitcnt lgkmcnt(0)
    s_setprio 0
    v_mfma_f32_16x16x32_bf16 v[88:91], v[28:31], v[64:67], v[88:91]
    v_cvt_pk_bf16_f32 v68, v40, v41
    v_cvt_pk_bf16_f32 v69, v42, v43
    v_cvt_pk_bf16_f32 v70, v44, v45
    v_cvt_pk_bf16_f32 v71, v46, v47
    s_setprio 1
    v_mfma_f32_32x32x16_bf16 v[32:47], v[96:99], v[12:15], 0
    v_exp_f32 v48, v48
    ds_read_b128 v[104:107], v3 offset:12288
    v_exp_f32 v49, v49
    ds_read_b128 v[108:111], v3 offset:13312
    v_exp_f32 v50, v50
    ds_read_b128 v[112:115], v3 offset:10240
    v_exp_f32 v51, v51
    v_mfma_f32_32x32x16_bf16 v[72:87], v[116:119], v[68:71], v[72:87]
    v_exp_f32 v52, v52
    ds_read_b128 v[116:119], v3 offset:11264
    v_exp_f32 v53, v53
    buffer_load_dwordx4 v[156:159], v5, s[12:15], s24 offen
    v_exp_f32 v54, v54
    buffer_load_dwordx4 v[92:95], v6, s[12:15], s25 offen
    v_exp_f32 v55, v55
    v_mfma_f32_16x16x32_bf16 v[88:91], v[28:31], v[68:71], v[88:91]
    v_cvt_pk_bf16_f32 v64, v48, v49
    v_cvt_pk_bf16_f32 v65, v50, v51
    v_cvt_pk_bf16_f32 v66, v52, v53
    v_cvt_pk_bf16_f32 v67, v54, v55
    v_mfma_f32_32x32x16_bf16 v[32:47], v[100:103], v[16:19], v[32:47]
    v_exp_f32 v56, v56
    buffer_load_dwordx4 v[20:23], v2, s[12:15], s26 offen offset:0
    v_exp_f32 v57, v57
    buffer_load_dwordx4 v[24:27], v2, s[12:15], s26 offen offset:1024
    v_exp_f32 v58, v58
    v_exp_f32 v59, v59
    v_mfma_f32_32x32x16_bf16 v[72:87], v[120:123], v[64:67], v[72:87]
    v_exp_f32 v60, v60
    v_exp_f32 v61, v61
    v_exp_f32 v62, v62
    v_exp_f32 v63, v63
    s_waitcnt lgkmcnt(0)
    s_setprio 0
    v_mfma_f32_16x16x32_bf16 v[88:91], v[28:31], v[64:67], v[88:91]
    v_cvt_pk_bf16_f32 v68, v56, v57
    v_cvt_pk_bf16_f32 v69, v58, v59
    v_cvt_pk_bf16_f32 v70, v60, v61
    v_cvt_pk_bf16_f32 v71, v62, v63
    s_setprio 1
    v_mfma_f32_32x32x16_bf16 v[48:63], v[104:107], v[12:15], 0
    v_exp_f32 v32, v32
    ds_read_b128 v[96:99], v3 offset:16384
    v_exp_f32 v33, v33
    ds_read_b128 v[100:103], v3 offset:17408
    v_exp_f32 v34, v34
    ds_read_b128 v[120:123], v3 offset:14336
    v_exp_f32 v35, v35
    v_mfma_f32_32x32x16_bf16 v[72:87], v[124:127], v[68:71], v[72:87]
    v_exp_f32 v36, v36
    ds_read_b128 v[124:127], v3 offset:15360
    v_exp_f32 v37, v37
    v_exp_f32 v38, v38
    v_exp_f32 v39, v39
    v_mfma_f32_16x16x32_bf16 v[88:91], v[28:31], v[68:71], v[88:91]
    v_cvt_pk_bf16_f32 v64, v32, v33
    v_cvt_pk_bf16_f32 v65, v34, v35
    v_cvt_pk_bf16_f32 v66, v36, v37
    v_cvt_pk_bf16_f32 v67, v38, v39
    v_mfma_f32_32x32x16_bf16 v[48:63], v[108:111], v[16:19], v[48:63]
    v_exp_f32 v40, v40
    v_exp_f32 v41, v41
    v_exp_f32 v42, v42
    v_exp_f32 v43, v43
    v_mfma_f32_32x32x16_bf16 v[72:87], v[112:115], v[64:67], v[72:87]
    v_exp_f32 v44, v44
    v_exp_f32 v45, v45
    v_exp_f32 v46, v46
    v_exp_f32 v47, v47
    s_waitcnt lgkmcnt(0)
    s_setprio 0
    v_mfma_f32_16x16x32_bf16 v[88:91], v[28:31], v[64:67], v[88:91]
    v_cvt_pk_bf16_f32 v68, v40, v41
    v_cvt_pk_bf16_f32 v69, v42, v43
    v_cvt_pk_bf16_f32 v70, v44, v45
    v_cvt_pk_bf16_f32 v71, v46, v47
    s_setprio 1
    v_mfma_f32_32x32x16_bf16 v[32:47], v[96:99], v[12:15], 0
    v_exp_f32 v48, v48
    ds_read_b128 v[104:107], v3 offset:20480
    v_exp_f32 v49, v49
    ds_read_b128 v[108:111], v3 offset:21504
    v_exp_f32 v50, v50
    ds_read_b128 v[112:115], v3 offset:18432
    v_exp_f32 v51, v51
    v_mfma_f32_32x32x16_bf16 v[72:87], v[116:119], v[68:71], v[72:87]
    v_exp_f32 v52, v52
    ds_read_b128 v[116:119], v3 offset:19456
    v_exp_f32 v53, v53
    v_exp_f32 v54, v54
    v_exp_f32 v55, v55
    v_mfma_f32_16x16x32_bf16 v[88:91], v[28:31], v[68:71], v[88:91]
    v_cvt_pk_bf16_f32 v64, v48, v49
    v_cvt_pk_bf16_f32 v65, v50, v51
    v_cvt_pk_bf16_f32 v66, v52, v53
    v_cvt_pk_bf16_f32 v67, v54, v55
    v_mfma_f32_32x32x16_bf16 v[32:47], v[100:103], v[16:19], v[32:47]
    v_exp_f32 v56, v56
    v_exp_f32 v57, v57
    v_exp_f32 v58, v58
    v_exp_f32 v59, v59
    v_mfma_f32_32x32x16_bf16 v[72:87], v[120:123], v[64:67], v[72:87]
    v_exp_f32 v60, v60
    v_exp_f32 v61, v61
    v_exp_f32 v62, v62
    v_exp_f32 v63, v63
    s_waitcnt lgkmcnt(0)
    s_setprio 0
    v_mfma_f32_16x16x32_bf16 v[88:91], v[28:31], v[64:67], v[88:91]
    v_cvt_pk_bf16_f32 v68, v56, v57
    v_cvt_pk_bf16_f32 v69, v58, v59
    v_cvt_pk_bf16_f32 v70, v60, v61
    v_cvt_pk_bf16_f32 v71, v62, v63
    s_waitcnt vmcnt(15)
    v_add_u32 v187, 1, v187
    ds_write_b32 v184, v187
    s_setprio 1
    v_mfma_f32_32x32x16_bf16 v[48:63], v[104:107], v[12:15], 0
    v_exp_f32 v32, v32
    ds_read_b128 v[96:99], v3 offset:24576
    v_exp_f32 v33, v33
    ds_read_b128 v[100:103], v3 offset:25600
    v_exp_f32 v34, v34
    ds_read_b128 v[120:123], v3 offset:22528
    v_exp_f32 v35, v35
    v_mfma_f32_32x32x16_bf16 v[72:87], v[124:127], v[68:71], v[72:87]
    v_exp_f32 v36, v36
    ds_read_b128 v[124:127], v3 offset:23552
    v_exp_f32 v37, v37
    v_exp_f32 v38, v38
    v_exp_f32 v39, v39
    v_mfma_f32_16x16x32_bf16 v[88:91], v[28:31], v[68:71], v[88:91]
    v_cvt_pk_bf16_f32 v64, v32, v33
    v_cvt_pk_bf16_f32 v65, v34, v35
    v_cvt_pk_bf16_f32 v66, v36, v37
    v_cvt_pk_bf16_f32 v67, v38, v39
    v_mfma_f32_32x32x16_bf16 v[48:63], v[108:111], v[16:19], v[48:63]
    v_exp_f32 v40, v40
    v_exp_f32 v41, v41
    v_exp_f32 v42, v42
    v_exp_f32 v43, v43
    v_mfma_f32_32x32x16_bf16 v[72:87], v[112:115], v[64:67], v[72:87]
    v_exp_f32 v44, v44
    v_exp_f32 v45, v45
    v_exp_f32 v46, v46
    v_exp_f32 v47, v47
    s_waitcnt lgkmcnt(0)
    s_setprio 0
    v_mfma_f32_16x16x32_bf16 v[88:91], v[28:31], v[64:67], v[88:91]
    v_cvt_pk_bf16_f32 v68, v40, v41
    v_cvt_pk_bf16_f32 v69, v42, v43
    v_cvt_pk_bf16_f32 v70, v44, v45
    v_cvt_pk_bf16_f32 v71, v46, v47
    s_setprio 1
    v_mfma_f32_32x32x16_bf16 v[32:47], v[96:99], v[12:15], 0
    v_exp_f32 v48, v48
    ds_read_b128 v[104:107], v3 offset:28672
    v_exp_f32 v49, v49
    ds_read_b128 v[108:111], v3 offset:29696
    v_exp_f32 v50, v50
    ds_read_b128 v[112:115], v3 offset:26624
    v_exp_f32 v51, v51
    v_mfma_f32_32x32x16_bf16 v[72:87], v[116:119], v[68:71], v[72:87]
    v_exp_f32 v52, v52
    ds_read_b128 v[116:119], v3 offset:27648
    v_exp_f32 v53, v53
    v_exp_f32 v54, v54
    v_exp_f32 v55, v55
    v_mfma_f32_16x16x32_bf16 v[88:91], v[28:31], v[68:71], v[88:91]
    v_cvt_pk_bf16_f32 v64, v48, v49
    v_cvt_pk_bf16_f32 v65, v50, v51
    v_cvt_pk_bf16_f32 v66, v52, v53
    v_cvt_pk_bf16_f32 v67, v54, v55
    v_mfma_f32_32x32x16_bf16 v[32:47], v[100:103], v[16:19], v[32:47]
    v_exp_f32 v56, v56
    v_exp_f32 v57, v57
    v_exp_f32 v58, v58
    v_exp_f32 v59, v59
    v_mfma_f32_32x32x16_bf16 v[72:87], v[120:123], v[64:67], v[72:87]
    v_exp_f32 v60, v60
    v_exp_f32 v61, v61
    ds_read_b32 v186, v185
    v_exp_f32 v62, v62
    v_exp_f32 v63, v63
    s_waitcnt lgkmcnt(0)
    s_setprio 0
    v_mfma_f32_16x16x32_bf16 v[88:91], v[28:31], v[64:67], v[88:91]
    v_cvt_pk_bf16_f32 v68, v56, v57
    v_cvt_pk_bf16_f32 v69, v58, v59
    v_cvt_pk_bf16_f32 v70, v60, v61
    v_cvt_pk_bf16_f32 v71, v62, v63
    v_cmp_ge_u32 vcc, v186, v187
    s_cmp_eq_u64 vcc, -1
    s_cbranch_scc0 L_attn_kernel_0_spin

L_attn_kernel_0_go:
    s_setprio 1
    v_mfma_f32_32x32x16_bf16 v[48:63], v[104:107], v[12:15], 0
    v_exp_f32 v32, v32
    ds_read_b128 v[96:99], v4 offset:0
    v_exp_f32 v33, v33
    ds_read_b128 v[100:103], v4 offset:1024
    v_exp_f32 v34, v34
    ds_read_b128 v[120:123], v3 offset:30720
    v_exp_f32 v35, v35
    v_mfma_f32_32x32x16_bf16 v[72:87], v[124:127], v[68:71], v[72:87]
    v_exp_f32 v36, v36
    ds_read_b128 v[124:127], v3 offset:31744
    v_exp_f32 v37, v37
    buffer_load_dwordx4 v2, s[12:15], s20 offen offset:0 lds
    v_exp_f32 v38, v38
    buffer_load_dwordx4 v2, s[12:15], s20 offen offset:1024 lds
    v_exp_f32 v39, v39
    v_mfma_f32_16x16x32_bf16 v[88:91], v[28:31], v[68:71], v[88:91]
    v_cvt_pk_bf16_f32 v64, v32, v33
    v_cvt_pk_bf16_f32 v65, v34, v35
    v_cvt_pk_bf16_f32 v66, v36, v37
    v_cvt_pk_bf16_f32 v67, v38, v39
    v_mfma_f32_32x32x16_bf16 v[48:63], v[108:111], v[16:19], v[48:63]
    v_exp_f32 v40, v40
    buffer_load_dwordx4 v2, s[12:15], s20 offen offset:2048 lds
    v_exp_f32 v41, v41
    buffer_load_dwordx4 v2, s[12:15], s20 offen offset:3072 lds
    v_exp_f32 v42, v42
    s_add_u32 s27, s27, 1
    s_add_u32 s20, s20, 32768
    s_cmp_ge_u32 s27, 8
    s_cselect_b32 s20, 0x40000000, s20
    s_add_u32 s21, s21, 32768
    s_and_b32 s21, s21, 131071
    s_mov_b32 m0, s21
    v_exp_f32 v43, v43
    v_mfma_f32_32x32x16_bf16 v[72:87], v[112:115], v[64:67], v[72:87]
    v_exp_f32 v44, v44
    buffer_load_dword v10, v9, s[8:11], s32 offen
    v_exp_f32 v45, v45
    s_add_u32 s35, s23, 16777216
    buffer_load_dword v10, off, s[12:15], s35
    v_exp_f32 v46, v46
    v_exp_f32 v47, v47
    s_waitcnt lgkmcnt(0)
    s_setprio 0
    v_mfma_f32_16x16x32_bf16 v[88:91], v[28:31], v[64:67], v[88:91]
    v_cvt_pk_bf16_f32 v68, v40, v41
    v_cvt_pk_bf16_f32 v69, v42, v43
    v_cvt_pk_bf16_f32 v70, v44, v45
    v_cvt_pk_bf16_f32 v71, v46, v47
    s_setprio 1
    v_mfma_f32_32x32x16_bf16 v[32:47], v[96:99], v[12:15], 0
    v_exp_f32 v48, v48
    ds_read_b128 v[104:107], v4 offset:4096
    v_exp_f32 v49, v49
    ds_read_b128 v[108:111], v4 offset:5120
    v_exp_f32 v50, v50
    ds_read_b128 v[112:115], v4 offset:2048
    v_exp_f32 v51, v51
    v_mfma_f32_32x32x16_bf16 v[72:87], v[116:119], v[68:71], v[72:87]
    v_exp_f32 v52, v52
    ds_read_b128 v[116:119], v4 offset:3072
    v_exp_f32 v53, v53
    v_exp_f32 v54, v54
    v_exp_f32 v55, v55
    v_mfma_f32_16x16x32_bf16 v[88:91], v[28:31], v[68:71], v[88:91]
    v_cvt_pk_bf16_f32 v64, v48, v49
    v_cvt_pk_bf16_f32 v65, v50, v51
    v_cvt_pk_bf16_f32 v66, v52, v53
    v_cvt_pk_bf16_f32 v67, v54, v55
    v_mfma_f32_32x32x16_bf16 v[32:47], v[100:103], v[16:19], v[32:47]
    v_exp_f32 v56, v56
    v_exp_f32 v57, v57
    v_exp_f32 v58, v58
    v_exp_f32 v59, v59
    v_mfma_f32_32x32x16_bf16 v[72:87], v[120:123], v[64:67], v[72:87]
    v_exp_f32 v60, v60
    v_exp_f32 v61, v61
    v_exp_f32 v62, v62
    v_exp_f32 v63, v63
    s_waitcnt lgkmcnt(0)
    s_setprio 0
    v_mfma_f32_16x16x32_bf16 v[88:91], v[28:31], v[64:67], v[88:91]
    v_cvt_pk_bf16_f32 v68, v56, v57
    v_cvt_pk_bf16_f32 v69, v58, v59
    v_cvt_pk_bf16_f32 v70, v60, v61
    v_cvt_pk_bf16_f32 v71, v62, v63
    s_add_u32 s33, s33, 32768
    s_and_b32 s33, s33, 131071
    v_mov_b32 v3, v4
    v_add_u32 v4, s33, v2

    s_setprio 1
    v_mfma_f32_32x32x16_bf16 v[48:63], v[104:107], v[12:15], 0
    v_exp_f32 v32, v32
    ds_read_b128 v[96:99], v3 offset:8192
    v_exp_f32 v33, v33
    ds_read_b128 v[100:103], v3 offset:9216
    v_exp_f32 v34, v34
    ds_read_b128 v[120:123], v3 offset:6144
    v_exp_f32 v35, v35
    v_mfma_f32_32x32x16_bf16 v[72:87], v[124:127], v[68:71], v[72:87]
    v_exp_f32 v36, v36
    ds_read_b128 v[124:127], v3 offset:7168
    v_exp_f32 v37, v37
    v_exp_f32 v38, v38
    v_exp_f32 v39, v39
    v_mfma_f32_16x16x32_bf16 v[88:91], v[28:31], v[68:71], v[88:91]
    v_cvt_pk_bf16_f32 v64, v32, v33
    v_cvt_pk_bf16_f32 v65, v34, v35
    v_cvt_pk_bf16_f32 v66, v36, v37
    v_cvt_pk_bf16_f32 v67, v38, v39
    v_mfma_f32_32x32x16_bf16 v[48:63], v[108:111], v[16:19], v[48:63]
    v_exp_f32 v40, v40
    v_exp_f32 v41, v41
    v_exp_f32 v42, v42
    v_exp_f32 v43, v43
    v_mfma_f32_32x32x16_bf16 v[72:87], v[112:115], v[64:67], v[72:87]
    v_exp_f32 v44, v44
    v_exp_f32 v45, v45
    v_exp_f32 v46, v46
    v_exp_f32 v47, v47
    s_waitcnt lgkmcnt(0)
    s_setprio 0
    v_mfma_f32_16x16x32_bf16 v[88:91], v[28:31], v[64:67], v[88:91]
    v_cvt_pk_bf16_f32 v68, v40, v41
    v_cvt_pk_bf16_f32 v69, v42, v43
    v_cvt_pk_bf16_f32 v70, v44, v45
    v_cvt_pk_bf16_f32 v71, v46, v47
    s_setprio 1
    v_mfma_f32_32x32x16_bf16 v[32:47], v[96:99], v[12:15], 0
    v_exp_f32 v48, v48
    ds_read_b128 v[104:107], v3 offset:12288
    v_exp_f32 v49, v49
    ds_read_b128 v[108:111], v3 offset:13312
    v_exp_f32 v50, v50
    ds_read_b128 v[112:115], v3 offset:10240
    v_exp_f32 v51, v51
    v_mfma_f32_32x32x16_bf16 v[72:87], v[116:119], v[68:71], v[72:87]
    v_exp_f32 v52, v52
    ds_read_b128 v[116:119], v3 offset:11264
    v_exp_f32 v53, v53
    v_exp_f32 v54, v54
    v_exp_f32 v55, v55
    v_mfma_f32_16x16x32_bf16 v[88:91], v[28:31], v[68:71], v[88:91]
    v_cvt_pk_bf16_f32 v64, v48, v49
    v_cvt_pk_bf16_f32 v65, v50, v51
    v_cvt_pk_bf16_f32 v66, v52, v53
    v_cvt_pk_bf16_f32 v67, v54, v55
    v_mfma_f32_32x32x16_bf16 v[32:47], v[100:103], v[16:19], v[32:47]
    v_exp_f32 v56, v56
    v_exp_f32 v57, v57
    v_exp_f32 v58, v58
    v_exp_f32 v59, v59
    v_mfma_f32_32x32x16_bf16 v[72:87], v[120:123], v[64:67], v[72:87]
    v_exp_f32 v60, v60
    v_exp_f32 v61, v61
    v_exp_f32 v62, v62
    v_exp_f32 v63, v63
    s_waitcnt lgkmcnt(0)
    s_setprio 0
    v_mfma_f32_16x16x32_bf16 v[88:91], v[28:31], v[64:67], v[88:91]
    v_cvt_pk_bf16_f32 v68, v56, v57
    v_cvt_pk_bf16_f32 v69, v58, v59
    v_cvt_pk_bf16_f32 v70, v60, v61
    v_cvt_pk_bf16_f32 v71, v62, v63
    s_waitcnt vmcnt(6)
    v_add_f32 v128, v128, v132
    v_add_f32 v129, v129, v133
    v_add_f32 v130, v130, v134
    v_add_f32 v131, v131, v135
    v_add_f32 v136, v136, v140
    v_add_f32 v137, v137, v141
    v_add_f32 v138, v138, v142
    v_add_f32 v139, v139, v143
    v_add_f32 v144, v144, v148
    v_add_f32 v145, v145, v149
    v_add_f32 v146, v146, v150
    v_add_f32 v147, v147, v151
    v_add_f32 v152, v152, v156
    v_add_f32 v153, v153, v157
    v_add_f32 v154, v154, v158
    v_add_f32 v155, v155, v159
    v_add_f32 v128, v128, v136
    v_add_f32 v129, v129, v137
    v_add_f32 v130, v130, v138
    v_add_f32 v131, v131, v139
    v_add_f32 v144, v144, v152
    v_add_f32 v145, v145, v153
    v_add_f32 v146, v146, v154
    v_add_f32 v147, v147, v155
    v_add_f32 v128, v128, v144
    v_add_f32 v129, v129, v145
    v_add_f32 v130, v130, v146
    v_add_f32 v131, v131, v147
    v_mov_b32 v132, v128
    v_mov_b32 v133, v129
    v_mov_b32 v134, v130
    v_mov_b32 v135, v131
    v_add_f32_dpp v92, v92, v92 row_ror:1 row_mask:0xf bank_mask:0xf
    v_add_f32_dpp v93, v93, v93 row_ror:1 row_mask:0xf bank_mask:0xf
    v_add_f32_dpp v94, v94, v94 row_ror:1 row_mask:0xf bank_mask:0xf
    v_add_f32_dpp v95, v95, v95 row_ror:1 row_mask:0xf bank_mask:0xf
    v_permlane32_swap_b32 v128, v132
    v_permlane32_swap_b32 v129, v133
    v_permlane32_swap_b32 v130, v134
    v_permlane32_swap_b32 v131, v135
    v_add_f32_dpp v92, v92, v92 row_ror:2 row_mask:0xf bank_mask:0xf
    v_add_f32_dpp v93, v93, v93 row_ror:2 row_mask:0xf bank_mask:0xf
    v_add_f32_dpp v94, v94, v94 row_ror:2 row_mask:0xf bank_mask:0xf
    v_add_f32_dpp v95, v95, v95 row_ror:2 row_mask:0xf bank_mask:0xf
    v_add_f32 v128, v128, v132
    v_add_f32 v129, v129, v133
    v_add_f32 v130, v130, v134
    v_add_f32 v131, v131, v135
    v_add_f32_dpp v92, v92, v92 row_ror:4 row_mask:0xf bank_mask:0xf
    v_add_f32_dpp v93, v93, v93 row_ror:4 row_mask:0xf bank_mask:0xf
    v_add_f32_dpp v94, v94, v94 row_ror:4 row_mask:0xf bank_mask:0xf
    v_add_f32_dpp v95, v95, v95 row_ror:4 row_mask:0xf bank_mask:0xf
    v_cvt_pk_bf16_f32 v136, v128, v129
    v_cvt_pk_bf16_f32 v137, v130, v131
    v_add_f32_dpp v92, v92, v92 row_ror:8 row_mask:0xf bank_mask:0xf
    v_add_f32_dpp v93, v93, v93 row_ror:8 row_mask:0xf bank_mask:0xf
    v_add_f32_dpp v94, v94, v94 row_ror:8 row_mask:0xf bank_mask:0xf
    v_add_f32_dpp v95, v95, v95 row_ror:8 row_mask:0xf bank_mask:0xf
    v_cvt_pk_bf16_f32 v138, v92, v93
    v_cvt_pk_bf16_f32 v139, v94, v95
    ds_write_b128 v7, v[136:139]
    v_add_u32 v187, 1, v187
    ds_write_b32 v184, v187
    s_setprio 1
    v_mfma_f32_32x32x16_bf16 v[48:63], v[104:107], v[12:15], 0
    v_exp_f32 v32, v32
    ds_read_b128 v[96:99], v3 offset:16384
    v_exp_f32 v33, v33
    ds_read_b128 v[100:103], v3 offset:17408
    v_exp_f32 v34, v34
    ds_read_b128 v[120:123], v3 offset:14336
    v_exp_f32 v35, v35
    v_mfma_f32_32x32x16_bf16 v[72:87], v[124:127], v[68:71], v[72:87]
    v_exp_f32 v36, v36
    ds_read_b128 v[124:127], v3 offset:15360
    v_exp_f32 v37, v37
    v_exp_f32 v38, v38
    v_exp_f32 v39, v39
    v_mfma_f32_16x16x32_bf16 v[88:91], v[28:31], v[68:71], v[88:91]
    v_cvt_pk_bf16_f32 v64, v32, v33
    v_cvt_pk_bf16_f32 v65, v34, v35
    v_cvt_pk_bf16_f32 v66, v36, v37
    v_cvt_pk_bf16_f32 v67, v38, v39
    v_mfma_f32_32x32x16_bf16 v[48:63], v[108:111], v[16:19], v[48:63]
    v_exp_f32 v40, v40
    v_exp_f32 v41, v41
    v_exp_f32 v42, v42
    v_exp_f32 v43, v43
    v_mfma_f32_32x32x16_bf16 v[72:87], v[112:115], v[64:67], v[72:87]
    v_exp_f32 v44, v44
    v_exp_f32 v45, v45
    v_exp_f32 v46, v46
    v_exp_f32 v47, v47
    s_waitcnt lgkmcnt(0)
    s_setprio 0
    v_mfma_f32_16x16x32_bf16 v[88:91], v[28:31], v[64:67], v[88:91]
    v_cvt_pk_bf16_f32 v68, v40, v41
    v_cvt_pk_bf16_f32 v69, v42, v43
    v_cvt_pk_bf16_f32 v70, v44, v45
    v_cvt_pk_bf16_f32 v71, v46, v47
    s_setprio 1
    v_mfma_f32_32x32x16_bf16 v[32:47], v[96:99], v[12:15], 0
    v_exp_f32 v48, v48
    ds_read_b128 v[104:107], v3 offset:20480
    v_exp_f32 v49, v49
    ds_read_b128 v[108:111], v3 offset:21504
    v_exp_f32 v50, v50
    ds_read_b128 v[112:115], v3 offset:18432
    v_exp_f32 v51, v51
    v_mfma_f32_32x32x16_bf16 v[72:87], v[116:119], v[68:71], v[72:87]
    v_exp_f32 v52, v52
    ds_read_b128 v[116:119], v3 offset:19456
    v_exp_f32 v53, v53
    v_exp_f32 v54, v54
    v_exp_f32 v55, v55
    v_mfma_f32_16x16x32_bf16 v[88:91], v[28:31], v[68:71], v[88:91]
    v_cvt_pk_bf16_f32 v64, v48, v49
    v_cvt_pk_bf16_f32 v65, v50, v51
    v_cvt_pk_bf16_f32 v66, v52, v53
    v_cvt_pk_bf16_f32 v67, v54, v55
    v_mfma_f32_32x32x16_bf16 v[32:47], v[100:103], v[16:19], v[32:47]
    v_exp_f32 v56, v56
    v_exp_f32 v57, v57
    v_exp_f32 v58, v58
    v_exp_f32 v59, v59
    v_mfma_f32_32x32x16_bf16 v[72:87], v[120:123], v[64:67], v[72:87]
    v_exp_f32 v60, v60
    v_exp_f32 v61, v61
    v_exp_f32 v62, v62
    v_exp_f32 v63, v63
    s_waitcnt lgkmcnt(0)
    s_setprio 0
    v_mfma_f32_16x16x32_bf16 v[88:91], v[28:31], v[64:67], v[88:91]
    v_cvt_pk_bf16_f32 v68, v56, v57
    v_cvt_pk_bf16_f32 v69, v58, v59
    v_cvt_pk_bf16_f32 v70, v60, v61
    v_cvt_pk_bf16_f32 v71, v62, v63
    s_setprio 1
    v_mfma_f32_32x32x16_bf16 v[48:63], v[104:107], v[12:15], 0
    v_exp_f32 v32, v32
    ds_read_b128 v[96:99], v3 offset:24576
    v_exp_f32 v33, v33
    ds_read_b128 v[100:103], v3 offset:25600
    v_exp_f32 v34, v34
    ds_read_b128 v[120:123], v3 offset:22528
    v_exp_f32 v35, v35
    v_mfma_f32_32x32x16_bf16 v[72:87], v[124:127], v[68:71], v[72:87]
    v_exp_f32 v36, v36
    ds_read_b128 v[124:127], v3 offset:23552
    v_exp_f32 v37, v37
    v_exp_f32 v38, v38
    v_exp_f32 v39, v39
    v_mfma_f32_16x16x32_bf16 v[88:91], v[28:31], v[68:71], v[88:91]
    v_cvt_pk_bf16_f32 v64, v32, v33
    v_cvt_pk_bf16_f32 v65, v34, v35
    v_cvt_pk_bf16_f32 v66, v36, v37
    v_cvt_pk_bf16_f32 v67, v38, v39
    v_mfma_f32_32x32x16_bf16 v[48:63], v[108:111], v[16:19], v[48:63]
    v_exp_f32 v40, v40
    v_exp_f32 v41, v41
    v_exp_f32 v42, v42
    v_exp_f32 v43, v43
    v_mfma_f32_32x32x16_bf16 v[72:87], v[112:115], v[64:67], v[72:87]
    v_exp_f32 v44, v44
    v_exp_f32 v45, v45
    v_exp_f32 v46, v46
    v_exp_f32 v47, v47
    s_waitcnt lgkmcnt(0)
    s_setprio 0
    v_mfma_f32_16x16x32_bf16 v[88:91], v[28:31], v[64:67], v[88:91]
    v_cvt_pk_bf16_f32 v68, v40, v41
    v_cvt_pk_bf16_f32 v69, v42, v43
    v_cvt_pk_bf16_f32 v70, v44, v45
    v_cvt_pk_bf16_f32 v71, v46, v47
    s_setprio 1
    v_mfma_f32_32x32x16_bf16 v[32:47], v[96:99], v[12:15], 0
    v_exp_f32 v48, v48
    ds_read_b128 v[104:107], v3 offset:28672
    v_exp_f32 v49, v49
    ds_read_b128 v[108:111], v3 offset:29696
    v_exp_f32 v50, v50
    ds_read_b128 v[112:115], v3 offset:26624
    v_exp_f32 v51, v51
    v_mfma_f32_32x32x16_bf16 v[72:87], v[116:119], v[68:71], v[72:87]
    v_exp_f32 v52, v52
    ds_read_b128 v[116:119], v3 offset:27648
    v_exp_f32 v53, v53
    v_exp_f32 v54, v54
    v_exp_f32 v55, v55
    v_mfma_f32_16x16x32_bf16 v[88:91], v[28:31], v[68:71], v[88:91]
    v_cvt_pk_bf16_f32 v64, v48, v49
    v_cvt_pk_bf16_f32 v65, v50, v51
    v_cvt_pk_bf16_f32 v66, v52, v53
    v_cvt_pk_bf16_f32 v67, v54, v55
    v_mfma_f32_32x32x16_bf16 v[32:47], v[100:103], v[16:19], v[32:47]
    v_exp_f32 v56, v56
    v_exp_f32 v57, v57
    v_exp_f32 v58, v58
    v_exp_f32 v59, v59
    v_mfma_f32_32x32x16_bf16 v[72:87], v[120:123], v[64:67], v[72:87]
    v_exp_f32 v60, v60
    v_exp_f32 v61, v61
    ds_read_b32 v186, v185
    v_exp_f32 v62, v62
    v_exp_f32 v63, v63
    s_waitcnt lgkmcnt(0)
    s_setprio 0
    v_mfma_f32_16x16x32_bf16 v[88:91], v[28:31], v[64:67], v[88:91]
    v_cvt_pk_bf16_f32 v68, v56, v57
    v_cvt_pk_bf16_f32 v69, v58, v59
    v_cvt_pk_bf16_f32 v70, v60, v61
    v_cvt_pk_bf16_f32 v71, v62, v63
    v_cmp_ge_u32 vcc, v186, v187
    s_cmp_eq_u64 vcc, -1
    s_cbranch_scc0 L_attn_kernel_1_spin

L_attn_kernel_1_go:
    ds_read_b64 v[160:161], v8 offset:0
    ds_read_b64 v[168:169], v8 offset:8
    ds_read_b64 v[162:163], v8 offset:1024
    ds_read_b64 v[170:171], v8 offset:1032
    ds_read_b64 v[164:165], v8 offset:2048
    ds_read_b64 v[172:173], v8 offset:2056
    ds_read_b64 v[166:167], v8 offset:3072
    ds_read_b64 v[174:175], v8 offset:3080
    s_setprio 1
    v_mfma_f32_32x32x16_bf16 v[48:63], v[104:107], v[12:15], 0
    v_exp_f32 v32, v32
    ds_read_b128 v[96:99], v4 offset:0
    v_exp_f32 v33, v33
    ds_read_b128 v[100:103], v4 offset:1024
    v_exp_f32 v34, v34
    ds_read_b128 v[120:123], v3 offset:30720
    v_exp_f32 v35, v35
    v_mfma_f32_32x32x16_bf16 v[72:87], v[124:127], v[68:71], v[72:87]
    v_exp_f32 v36, v36
    ds_read_b128 v[124:127], v3 offset:31744
    v_exp_f32 v37, v37
    buffer_load_dwordx4 v2, s[12:15], s20 offen offset:0 lds
    v_exp_f32 v38, v38
    buffer_load_dwordx4 v2, s[12:15], s20 offen offset:1024 lds
    v_exp_f32 v39, v39
    v_mfma_f32_16x16x32_bf16 v[88:91], v[28:31], v[68:71], v[88:91]
    v_cvt_pk_bf16_f32 v64, v32, v33
    v_cvt_pk_bf16_f32 v65, v34, v35
    v_cvt_pk_bf16_f32 v66, v36, v37
    v_cvt_pk_bf16_f32 v67, v38, v39
    v_mfma_f32_32x32x16_bf16 v[48:63], v[108:111], v[16:19], v[48:63]
    v_exp_f32 v40, v40
    buffer_load_dwordx4 v2, s[12:15], s20 offen offset:2048 lds
    v_exp_f32 v41, v41
    buffer_load_dwordx4 v2, s[12:15], s20 offen offset:3072 lds
    v_exp_f32 v42, v42
    s_add_u32 s27, s27, 1
    s_add_u32 s20, s20, 32768
    s_cmp_ge_u32 s27, 8
    s_cselect_b32 s20, 0x40000000, s20
    s_add_u32 s21, s21, 32768
    s_and_b32 s21, s21, 131071
    s_mov_b32 m0, s21
    v_exp_f32 v43, v43
    v_mfma_f32_32x32x16_bf16 v[72:87], v[112:115], v[64:67], v[72:87]
    v_exp_f32 v44, v44
    v_exp_f32 v45, v45
    v_exp_f32 v46, v46
    v_exp_f32 v47, v47
    s_waitcnt lgkmcnt(0)
    s_setprio 0
    v_mfma_f32_16x16x32_bf16 v[88:91], v[28:31], v[64:67], v[88:91]
    v_cvt_pk_bf16_f32 v68, v40, v41
    v_cvt_pk_bf16_f32 v69, v42, v43
    v_cvt_pk_bf16_f32 v70, v44, v45
    v_cvt_pk_bf16_f32 v71, v46, v47
    v_mfma_f32_32x32x16_bf16 v[128:143], v[160:163], v[20:23], 0
    v_mfma_f32_32x32x16_bf16 v[144:159], v[168:171], v[20:23], 0
    v_mfma_f32_32x32x16_bf16 v[128:143], v[164:167], v[24:27], v[128:143]
    v_mfma_f32_32x32x16_bf16 v[144:159], v[172:175], v[24:27], v[144:159]
    s_setprio 1
    v_mfma_f32_32x32x16_bf16 v[32:47], v[96:99], v[12:15], 0
    v_exp_f32 v48, v48
    ds_read_b128 v[104:107], v4 offset:4096
    v_exp_f32 v49, v49
    ds_read_b128 v[108:111], v4 offset:5120
    v_exp_f32 v50, v50
    ds_read_b128 v[112:115], v4 offset:2048
    v_exp_f32 v51, v51
    v_mfma_f32_32x32x16_bf16 v[72:87], v[116:119], v[68:71], v[72:87]
    v_exp_f32 v52, v52
    ds_read_b128 v[116:119], v4 offset:3072
    v_exp_f32 v53, v53
    v_exp_f32 v54, v54
    v_exp_f32 v55, v55
    v_mfma_f32_16x16x32_bf16 v[88:91], v[28:31], v[68:71], v[88:91]
    v_cvt_pk_bf16_f32 v64, v48, v49
    v_cvt_pk_bf16_f32 v65, v50, v51
    v_cvt_pk_bf16_f32 v66, v52, v53
    v_cvt_pk_bf16_f32 v67, v54, v55
    v_mfma_f32_32x32x16_bf16 v[32:47], v[100:103], v[16:19], v[32:47]
    v_exp_f32 v56, v56
    v_exp_f32 v57, v57
    v_exp_f32 v58, v58
    v_exp_f32 v59, v59
    v_mfma_f32_32x32x16_bf16 v[72:87], v[120:123], v[64:67], v[72:87]
    v_exp_f32 v60, v60
    v_exp_f32 v61, v61
    v_exp_f32 v62, v62
    v_exp_f32 v63, v63
    s_waitcnt lgkmcnt(0)
    s_setprio 0
    v_mfma_f32_16x16x32_bf16 v[88:91], v[28:31], v[64:67], v[88:91]
    v_cvt_pk_bf16_f32 v68, v56, v57
    v_cvt_pk_bf16_f32 v69, v58, v59
    v_cvt_pk_bf16_f32 v70, v60, v61
    v_cvt_pk_bf16_f32 v71, v62, v63
    v_add_f32 v144, 0x358637bd, v144
    v_rcp_f32 v144, v144
    s_add_u32 s28, s23, 20971520
    v_mul_f32 v128, v128, v144
    v_mul_f32 v129, v129, v144
    v_mul_f32 v130, v130, v144
    v_mul_f32 v131, v131, v144
    v_mul_f32 v132, v132, v144
    v_mul_f32 v133, v133, v144
    v_mul_f32 v134, v134, v144
    v_mul_f32 v135, v135, v144
    v_mul_f32 v136, v136, v144
    v_mul_f32 v137, v137, v144
    v_mul_f32 v138, v138, v144
    v_mul_f32 v139, v139, v144
    v_mul_f32 v140, v140, v144
    v_mul_f32 v141, v141, v144
    v_mul_f32 v142, v142, v144
    v_mul_f32 v143, v143, v144
    v_cvt_pk_bf16_f32 v176, v128, v129
    v_cvt_pk_bf16_f32 v177, v130, v131
    v_cvt_pk_bf16_f32 v178, v132, v133
    v_cvt_pk_bf16_f32 v179, v134, v135
    v_cvt_pk_bf16_f32 v180, v136, v137
    v_cvt_pk_bf16_f32 v181, v138, v139
    v_cvt_pk_bf16_f32 v182, v140, v141
    v_cvt_pk_bf16_f32 v183, v142, v143
    buffer_store_dwordx4 v[176:179], v2, s[12:15], s28 offen sc0 sc1
    buffer_store_dwordx4 v[180:183], v2, s[12:15], s28 offen offset:1024 sc0 sc1
    s_add_u32 s33, s33, 32768
    s_and_b32 s33, s33, 131071
    v_mov_b32 v3, v4
    v_add_u32 v4, s33, v2

    s_mov_b32 s34, 6
L_attn_kernel_loop:
    s_setprio 1
    v_mfma_f32_32x32x16_bf16 v[48:63], v[104:107], v[12:15], 0
    v_exp_f32 v32, v32
    ds_read_b128 v[96:99], v3 offset:8192
    v_exp_f32 v33, v33
    ds_read_b128 v[100:103], v3 offset:9216
    v_exp_f32 v34, v34
    ds_read_b128 v[120:123], v3 offset:6144
    v_exp_f32 v35, v35
    v_mfma_f32_32x32x16_bf16 v[72:87], v[124:127], v[68:71], v[72:87]
    v_exp_f32 v36, v36
    ds_read_b128 v[124:127], v3 offset:7168
    v_exp_f32 v37, v37
    v_exp_f32 v38, v38
    v_exp_f32 v39, v39
    v_mfma_f32_16x16x32_bf16 v[88:91], v[28:31], v[68:71], v[88:91]
    v_cvt_pk_bf16_f32 v64, v32, v33
    v_cvt_pk_bf16_f32 v65, v34, v35
    v_cvt_pk_bf16_f32 v66, v36, v37
    v_cvt_pk_bf16_f32 v67, v38, v39
    v_mfma_f32_32x32x16_bf16 v[48:63], v[108:111], v[16:19], v[48:63]
    v_exp_f32 v40, v40
    v_exp_f32 v41, v41
    v_exp_f32 v42, v42
    v_exp_f32 v43, v43
    v_mfma_f32_32x32x16_bf16 v[72:87], v[112:115], v[64:67], v[72:87]
    v_exp_f32 v44, v44
    v_exp_f32 v45, v45
    v_exp_f32 v46, v46
    v_exp_f32 v47, v47
    s_waitcnt lgkmcnt(0)
    s_setprio 0
    v_mfma_f32_16x16x32_bf16 v[88:91], v[28:31], v[64:67], v[88:91]
    v_cvt_pk_bf16_f32 v68, v40, v41
    v_cvt_pk_bf16_f32 v69, v42, v43
    v_cvt_pk_bf16_f32 v70, v44, v45
    v_cvt_pk_bf16_f32 v71, v46, v47
    s_setprio 1
    v_mfma_f32_32x32x16_bf16 v[32:47], v[96:99], v[12:15], 0
    v_exp_f32 v48, v48
    ds_read_b128 v[104:107], v3 offset:12288
    v_exp_f32 v49, v49
    ds_read_b128 v[108:111], v3 offset:13312
    v_exp_f32 v50, v50
    ds_read_b128 v[112:115], v3 offset:10240
    v_exp_f32 v51, v51
    v_mfma_f32_32x32x16_bf16 v[72:87], v[116:119], v[68:71], v[72:87]
    v_exp_f32 v52, v52
    ds_read_b128 v[116:119], v3 offset:11264
    v_exp_f32 v53, v53
    v_exp_f32 v54, v54
    v_exp_f32 v55, v55
    v_mfma_f32_16x16x32_bf16 v[88:91], v[28:31], v[68:71], v[88:91]
    v_cvt_pk_bf16_f32 v64, v48, v49
    v_cvt_pk_bf16_f32 v65, v50, v51
    v_cvt_pk_bf16_f32 v66, v52, v53
    v_cvt_pk_bf16_f32 v67, v54, v55
    v_mfma_f32_32x32x16_bf16 v[32:47], v[100:103], v[16:19], v[32:47]
    v_exp_f32 v56, v56
    v_exp_f32 v57, v57
    v_exp_f32 v58, v58
    v_exp_f32 v59, v59
    v_mfma_f32_32x32x16_bf16 v[72:87], v[120:123], v[64:67], v[72:87]
    v_exp_f32 v60, v60
    v_exp_f32 v61, v61
    v_exp_f32 v62, v62
    v_exp_f32 v63, v63
    s_waitcnt lgkmcnt(0)
    s_setprio 0
    v_mfma_f32_16x16x32_bf16 v[88:91], v[28:31], v[64:67], v[88:91]
    v_cvt_pk_bf16_f32 v68, v56, v57
    v_cvt_pk_bf16_f32 v69, v58, v59
    v_cvt_pk_bf16_f32 v70, v60, v61
    v_cvt_pk_bf16_f32 v71, v62, v63
    s_waitcnt vmcnt(4)
    v_add_u32 v187, 1, v187
    ds_write_b32 v184, v187
    s_setprio 1
    v_mfma_f32_32x32x16_bf16 v[48:63], v[104:107], v[12:15], 0
    v_exp_f32 v32, v32
    ds_read_b128 v[96:99], v3 offset:16384
    v_exp_f32 v33, v33
    ds_read_b128 v[100:103], v3 offset:17408
    v_exp_f32 v34, v34
    ds_read_b128 v[120:123], v3 offset:14336
    v_exp_f32 v35, v35
    v_mfma_f32_32x32x16_bf16 v[72:87], v[124:127], v[68:71], v[72:87]
    v_exp_f32 v36, v36
    ds_read_b128 v[124:127], v3 offset:15360
    v_exp_f32 v37, v37
    v_exp_f32 v38, v38
    v_exp_f32 v39, v39
    v_mfma_f32_16x16x32_bf16 v[88:91], v[28:31], v[68:71], v[88:91]
    v_cvt_pk_bf16_f32 v64, v32, v33
    v_cvt_pk_bf16_f32 v65, v34, v35
    v_cvt_pk_bf16_f32 v66, v36, v37
    v_cvt_pk_bf16_f32 v67, v38, v39
    v_mfma_f32_32x32x16_bf16 v[48:63], v[108:111], v[16:19], v[48:63]
    v_exp_f32 v40, v40
    v_exp_f32 v41, v41
    v_exp_f32 v42, v42
    v_exp_f32 v43, v43
    v_mfma_f32_32x32x16_bf16 v[72:87], v[112:115], v[64:67], v[72:87]
    v_exp_f32 v44, v44
    v_exp_f32 v45, v45
    v_exp_f32 v46, v46
    v_exp_f32 v47, v47
    s_waitcnt lgkmcnt(0)
    s_setprio 0
    v_mfma_f32_16x16x32_bf16 v[88:91], v[28:31], v[64:67], v[88:91]
    v_cvt_pk_bf16_f32 v68, v40, v41
    v_cvt_pk_bf16_f32 v69, v42, v43
    v_cvt_pk_bf16_f32 v70, v44, v45
    v_cvt_pk_bf16_f32 v71, v46, v47
    s_setprio 1
    v_mfma_f32_32x32x16_bf16 v[32:47], v[96:99], v[12:15], 0
    v_exp_f32 v48, v48
    ds_read_b128 v[104:107], v3 offset:20480
    v_exp_f32 v49, v49
    ds_read_b128 v[108:111], v3 offset:21504
    v_exp_f32 v50, v50
    ds_read_b128 v[112:115], v3 offset:18432
    v_exp_f32 v51, v51
    v_mfma_f32_32x32x16_bf16 v[72:87], v[116:119], v[68:71], v[72:87]
    v_exp_f32 v52, v52
    ds_read_b128 v[116:119], v3 offset:19456
    v_exp_f32 v53, v53
    v_exp_f32 v54, v54
    v_exp_f32 v55, v55
    v_mfma_f32_16x16x32_bf16 v[88:91], v[28:31], v[68:71], v[88:91]
    v_cvt_pk_bf16_f32 v64, v48, v49
    v_cvt_pk_bf16_f32 v65, v50, v51
    v_cvt_pk_bf16_f32 v66, v52, v53
    v_cvt_pk_bf16_f32 v67, v54, v55
    v_mfma_f32_32x32x16_bf16 v[32:47], v[100:103], v[16:19], v[32:47]
    v_exp_f32 v56, v56
    v_exp_f32 v57, v57
    v_exp_f32 v58, v58
    v_exp_f32 v59, v59
    v_mfma_f32_32x32x16_bf16 v[72:87], v[120:123], v[64:67], v[72:87]
    v_exp_f32 v60, v60
    v_exp_f32 v61, v61
    v_exp_f32 v62, v62
    v_exp_f32 v63, v63
    s_waitcnt lgkmcnt(0)
    s_setprio 0
    v_mfma_f32_16x16x32_bf16 v[88:91], v[28:31], v[64:67], v[88:91]
    v_cvt_pk_bf16_f32 v68, v56, v57
    v_cvt_pk_bf16_f32 v69, v58, v59
    v_cvt_pk_bf16_f32 v70, v60, v61
    v_cvt_pk_bf16_f32 v71, v62, v63
    s_setprio 1
    v_mfma_f32_32x32x16_bf16 v[48:63], v[104:107], v[12:15], 0
    v_exp_f32 v32, v32
    ds_read_b128 v[96:99], v3 offset:24576
    v_exp_f32 v33, v33
    ds_read_b128 v[100:103], v3 offset:25600
    v_exp_f32 v34, v34
    ds_read_b128 v[120:123], v3 offset:22528
    v_exp_f32 v35, v35
    v_mfma_f32_32x32x16_bf16 v[72:87], v[124:127], v[68:71], v[72:87]
    v_exp_f32 v36, v36
    ds_read_b128 v[124:127], v3 offset:23552
    v_exp_f32 v37, v37
    v_exp_f32 v38, v38
    v_exp_f32 v39, v39
    v_mfma_f32_16x16x32_bf16 v[88:91], v[28:31], v[68:71], v[88:91]
    v_cvt_pk_bf16_f32 v64, v32, v33
    v_cvt_pk_bf16_f32 v65, v34, v35
    v_cvt_pk_bf16_f32 v66, v36, v37
    v_cvt_pk_bf16_f32 v67, v38, v39
    v_mfma_f32_32x32x16_bf16 v[48:63], v[108:111], v[16:19], v[48:63]
    v_exp_f32 v40, v40
    v_exp_f32 v41, v41
    v_exp_f32 v42, v42
    v_exp_f32 v43, v43
    v_mfma_f32_32x32x16_bf16 v[72:87], v[112:115], v[64:67], v[72:87]
    v_exp_f32 v44, v44
    v_exp_f32 v45, v45
    v_exp_f32 v46, v46
    v_exp_f32 v47, v47
    s_waitcnt lgkmcnt(0)
    s_setprio 0
    v_mfma_f32_16x16x32_bf16 v[88:91], v[28:31], v[64:67], v[88:91]
    v_cvt_pk_bf16_f32 v68, v40, v41
    v_cvt_pk_bf16_f32 v69, v42, v43
    v_cvt_pk_bf16_f32 v70, v44, v45
    v_cvt_pk_bf16_f32 v71, v46, v47
    s_setprio 1
    v_mfma_f32_32x32x16_bf16 v[32:47], v[96:99], v[12:15], 0
    v_exp_f32 v48, v48
    ds_read_b128 v[104:107], v3 offset:28672
    v_exp_f32 v49, v49
    ds_read_b128 v[108:111], v3 offset:29696
    v_exp_f32 v50, v50
    ds_read_b128 v[112:115], v3 offset:26624
    v_exp_f32 v51, v51
    v_mfma_f32_32x32x16_bf16 v[72:87], v[116:119], v[68:71], v[72:87]
    v_exp_f32 v52, v52
    ds_read_b128 v[116:119], v3 offset:27648
    v_exp_f32 v53, v53
    v_exp_f32 v54, v54
    v_exp_f32 v55, v55
    v_mfma_f32_16x16x32_bf16 v[88:91], v[28:31], v[68:71], v[88:91]
    v_cvt_pk_bf16_f32 v64, v48, v49
    v_cvt_pk_bf16_f32 v65, v50, v51
    v_cvt_pk_bf16_f32 v66, v52, v53
    v_cvt_pk_bf16_f32 v67, v54, v55
    v_mfma_f32_32x32x16_bf16 v[32:47], v[100:103], v[16:19], v[32:47]
    v_exp_f32 v56, v56
    v_exp_f32 v57, v57
    v_exp_f32 v58, v58
    v_exp_f32 v59, v59
    v_mfma_f32_32x32x16_bf16 v[72:87], v[120:123], v[64:67], v[72:87]
    v_exp_f32 v60, v60
    v_exp_f32 v61, v61
    ds_read_b32 v186, v185
    v_exp_f32 v62, v62
    v_exp_f32 v63, v63
    s_waitcnt lgkmcnt(0)
    s_setprio 0
    v_mfma_f32_16x16x32_bf16 v[88:91], v[28:31], v[64:67], v[88:91]
    v_cvt_pk_bf16_f32 v68, v56, v57
    v_cvt_pk_bf16_f32 v69, v58, v59
    v_cvt_pk_bf16_f32 v70, v60, v61
    v_cvt_pk_bf16_f32 v71, v62, v63
    v_cmp_ge_u32 vcc, v186, v187
    s_cmp_eq_u64 vcc, -1
    s_cbranch_scc0 L_attn_kernel_None_spin

L_attn_kernel_None_go:
    s_setprio 1
    v_mfma_f32_32x32x16_bf16 v[48:63], v[104:107], v[12:15], 0
    v_exp_f32 v32, v32
    ds_read_b128 v[96:99], v4 offset:0
    v_exp_f32 v33, v33
    ds_read_b128 v[100:103], v4 offset:1024
    v_exp_f32 v34, v34
    ds_read_b128 v[120:123], v3 offset:30720
    v_exp_f32 v35, v35
    v_mfma_f32_32x32x16_bf16 v[72:87], v[124:127], v[68:71], v[72:87]
    v_exp_f32 v36, v36
    ds_read_b128 v[124:127], v3 offset:31744
    v_exp_f32 v37, v37
    buffer_load_dwordx4 v2, s[12:15], s20 offen offset:0 lds
    v_exp_f32 v38, v38
    buffer_load_dwordx4 v2, s[12:15], s20 offen offset:1024 lds
    v_exp_f32 v39, v39
    v_mfma_f32_16x16x32_bf16 v[88:91], v[28:31], v[68:71], v[88:91]
    v_cvt_pk_bf16_f32 v64, v32, v33
    v_cvt_pk_bf16_f32 v65, v34, v35
    v_cvt_pk_bf16_f32 v66, v36, v37
    v_cvt_pk_bf16_f32 v67, v38, v39
    v_mfma_f32_32x32x16_bf16 v[48:63], v[108:111], v[16:19], v[48:63]
    v_exp_f32 v40, v40
    buffer_load_dwordx4 v2, s[12:15], s20 offen offset:2048 lds
    v_exp_f32 v41, v41
    buffer_load_dwordx4 v2, s[12:15], s20 offen offset:3072 lds
    v_exp_f32 v42, v42
    s_add_u32 s27, s27, 1
    s_add_u32 s20, s20, 32768
    s_cmp_ge_u32 s27, 8
    s_cselect_b32 s20, 0x40000000, s20
    s_add_u32 s21, s21, 32768
    s_and_b32 s21, s21, 131071
    s_mov_b32 m0, s21
    v_exp_f32 v43, v43
    v_mfma_f32_32x32x16_bf16 v[72:87], v[112:115], v[64:67], v[72:87]
    v_exp_f32 v44, v44
    v_exp_f32 v45, v45
    v_exp_f32 v46, v46
    v_exp_f32 v47, v47
    s_waitcnt lgkmcnt(0)
    s_setprio 0
    v_mfma_f32_16x16x32_bf16 v[88:91], v[28:31], v[64:67], v[88:91]
    v_cvt_pk_bf16_f32 v68, v40, v41
    v_cvt_pk_bf16_f32 v69, v42, v43
    v_cvt_pk_bf16_f32 v70, v44, v45
    v_cvt_pk_bf16_f32 v71, v46, v47
    s_setprio 1
    v_mfma_f32_32x32x16_bf16 v[32:47], v[96:99], v[12:15], 0
    v_exp_f32 v48, v48
    ds_read_b128 v[104:107], v4 offset:4096
    v_exp_f32 v49, v49
    ds_read_b128 v[108:111], v4 offset:5120
    v_exp_f32 v50, v50
    ds_read_b128 v[112:115], v4 offset:2048
    v_exp_f32 v51, v51
    v_mfma_f32_32x32x16_bf16 v[72:87], v[116:119], v[68:71], v[72:87]
    v_exp_f32 v52, v52
    ds_read_b128 v[116:119], v4 offset:3072
    v_exp_f32 v53, v53
    v_exp_f32 v54, v54
    v_exp_f32 v55, v55
    v_mfma_f32_16x16x32_bf16 v[88:91], v[28:31], v[68:71], v[88:91]
    v_cvt_pk_bf16_f32 v64, v48, v49
    v_cvt_pk_bf16_f32 v65, v50, v51
    v_cvt_pk_bf16_f32 v66, v52, v53
    v_cvt_pk_bf16_f32 v67, v54, v55
    v_mfma_f32_32x32x16_bf16 v[32:47], v[100:103], v[16:19], v[32:47]
    v_exp_f32 v56, v56
    v_exp_f32 v57, v57
    v_exp_f32 v58, v58
    v_exp_f32 v59, v59
    v_mfma_f32_32x32x16_bf16 v[72:87], v[120:123], v[64:67], v[72:87]
    v_exp_f32 v60, v60
    v_exp_f32 v61, v61
    v_exp_f32 v62, v62
    v_exp_f32 v63, v63
    s_waitcnt lgkmcnt(0)
    s_setprio 0
    v_mfma_f32_16x16x32_bf16 v[88:91], v[28:31], v[64:67], v[88:91]
    v_cvt_pk_bf16_f32 v68, v56, v57
    v_cvt_pk_bf16_f32 v69, v58, v59
    v_cvt_pk_bf16_f32 v70, v60, v61
    v_cvt_pk_bf16_f32 v71, v62, v63
    s_add_u32 s33, s33, 32768
    s_and_b32 s33, s33, 131071
    v_mov_b32 v3, v4
    v_add_u32 v4, s33, v2

    s_sub_u32 s34, s34, 1
    s_cmp_lg_u32 s34, 0
    s_cbranch_scc1 L_attn_kernel_loop

    v_mfma_f32_32x32x16_bf16 v[72:87], v[124:127], v[68:71], v[72:87]
    v_mfma_f32_16x16x32_bf16 v[88:91], v[28:31], v[68:71], v[88:91]
    s_waitcnt vmcnt(0) lgkmcnt(0)
    v_mov_b32 v5, 0x5d800000
    v_mov_b32 v6, 0x7e800000
    v_mov_b32 v7, 0x21800000
    s_add_u32 s30, s23, 16777216
    s_nop 6

    v_add_f32 v1, |v72|, |v73|
    v_add_f32 v1, v1, |v74|
    v_add_f32 v1, v1, |v75|
    v_add_f32 v1, v1, |v76|
    v_add_f32 v1, v1, |v77|
    v_add_f32 v1, v1, |v78|
    v_add_f32 v1, v1, |v79|
    v_add_f32 v1, v1, |v80|
    v_add_f32 v1, v1, |v81|
    v_add_f32 v1, v1, |v82|
    v_add_f32 v1, v1, |v83|
    v_add_f32 v1, v1, |v84|
    v_add_f32 v1, v1, |v85|
    v_add_f32 v1, v1, |v86|
    v_add_f32 v1, v1, |v87|
    v_cmp_lt_f32 vcc, v88, v5
    v_cmp_lt_f32 s[28:29], v1, v6
    s_and_b64 vcc, vcc, s[28:29]
    v_cmp_gt_f32 s[28:29], v88, v7
    s_and_b64 vcc, vcc, s[28:29]
    s_cmp_eq_u64 vcc, -1

    s_cbranch_scc0 L_attn_kernel_slow
L_attn_kernel_fin:
    v_rcp_f32 v1, v88
    s_nop 0
    v_mul_f32 v72, v72, v1
    v_mul_f32 v73, v73, v1
    v_mul_f32 v74, v74, v1
    v_mul_f32 v75, v75, v1
    v_mul_f32 v76, v76, v1
    v_mul_f32 v77, v77, v1
    v_mul_f32 v78, v78, v1
    v_mul_f32 v79, v79, v1
    v_mul_f32 v80, v80, v1
    v_mul_f32 v81, v81, v1
    v_mul_f32 v82, v82, v1
    v_mul_f32 v83, v83, v1
    v_mul_f32 v84, v84, v1
    v_mul_f32 v85, v85, v1
    v_mul_f32 v86, v86, v1
    v_mul_f32 v87, v87, v1
    v_cvt_pk_bf16_f32 v64, v72, v73
    v_cvt_pk_bf16_f32 v65, v74, v75
    v_cvt_pk_bf16_f32 v66, v76, v77
    v_cvt_pk_bf16_f32 v67, v78, v79
    v_cvt_pk_bf16_f32 v68, v80, v81
    v_cvt_pk_bf16_f32 v69, v82, v83
    v_cvt_pk_bf16_f32 v70, v84, v85
    v_cvt_pk_bf16_f32 v71, v86, v87
    buffer_store_dwordx4 v[64:67], v2, s[12:15], s30 offen sc0 sc1
    buffer_store_dwordx4 v[68:71], v2, s[12:15], s30 offen offset:1024 sc0 sc1
L_attn_kernel_end:
    s_endpgm
L_attn_kernel_0_spin:
    s_sleep 1
    ds_read_b32 v186, v185
    s_waitcnt lgkmcnt(0)
    v_cmp_ge_u32 vcc, v186, v187
    s_cmp_eq_u64 vcc, -1
    s_cbranch_scc0 L_attn_kernel_0_spin
    s_branch L_attn_kernel_0_go

L_attn_kernel_1_spin:
    s_sleep 1
    ds_read_b32 v186, v185
    s_waitcnt lgkmcnt(0)
    v_cmp_ge_u32 vcc, v186, v187
    s_cmp_eq_u64 vcc, -1
    s_cbranch_scc0 L_attn_kernel_1_spin
    s_branch L_attn_kernel_1_go

L_attn_kernel_None_spin:
    s_sleep 1
    ds_read_b32 v186, v185
    s_waitcnt lgkmcnt(0)
    v_cmp_ge_u32 vcc, v186, v187
    s_cmp_eq_u64 vcc, -1
    s_cbranch_scc0 L_attn_kernel_None_spin
    s_branch L_attn_kernel_None_go

L_attn_kernel_slow:
    s_mov_b32 s28, s19
    s_mov_b32 s29, 64
    v_mov_b32 v8, 0xff800000

L_attn_kernel_slowa:
    buffer_load_dwordx4 v[96:99], v2, s[12:15], s28 offen
    buffer_load_dwordx4 v[100:103], v2, s[12:15], s28 offen offset:1024
    s_waitcnt vmcnt(0)

    v_mfma_f32_32x32x16_bf16 v[32:47], v[96:99], v[12:15], 0
    v_mfma_f32_32x32x16_bf16 v[32:47], v[100:103], v[16:19], v[32:47]
    s_nop 7
    s_nop 3
    v_max3_f32 v1, v32, v33, v34
    v_max3_f32 v1, v1, v35, v36
    v_max3_f32 v1, v1, v37, v38
    v_max3_f32 v1, v1, v39, v40
    v_max3_f32 v1, v1, v41, v42
    v_max3_f32 v1, v1, v43, v44
    v_max3_f32 v1, v1, v45, v46
    v_max3_f32 v1, v1, v47, v8
    v_mov_b32 v8, v1
    s_add_u32 s28, s28, 4096
    s_sub_u32 s29, s29, 1
    s_cmp_lg_u32 s29, 0
    s_cbranch_scc1 L_attn_kernel_slowa
    s_nop 1
    v_permlane32_swap_b32 v1, v8
    s_nop 1
    v_max_f32 v1, v1, v8

    v_mul_f32 v128, -1.0, v1
    v_mul_f32 v129, -1.0, v1
    v_mul_f32 v130, -1.0, v1
    v_mul_f32 v131, -1.0, v1
    v_mul_f32 v132, -1.0, v1
    v_mul_f32 v133, -1.0, v1
    v_mul_f32 v134, -1.0, v1
    v_mul_f32 v135, -1.0, v1
    v_mul_f32 v136, -1.0, v1
    v_mul_f32 v137, -1.0, v1
    v_mul_f32 v138, -1.0, v1
    v_mul_f32 v139, -1.0, v1
    v_mul_f32 v140, -1.0, v1
    v_mul_f32 v141, -1.0, v1
    v_mul_f32 v142, -1.0, v1
    v_mul_f32 v143, -1.0, v1
    v_mov_b32 v72, 0
    v_mov_b32 v73, 0
    v_mov_b32 v74, 0
    v_mov_b32 v75, 0
    v_mov_b32 v76, 0
    v_mov_b32 v77, 0
    v_mov_b32 v78, 0
    v_mov_b32 v79, 0
    v_mov_b32 v80, 0
    v_mov_b32 v81, 0
    v_mov_b32 v82, 0
    v_mov_b32 v83, 0
    v_mov_b32 v84, 0
    v_mov_b32 v85, 0
    v_mov_b32 v86, 0
    v_mov_b32 v87, 0
    v_mov_b32 v88, 0
    v_mov_b32 v89, 0
    v_mov_b32 v90, 0
    v_mov_b32 v91, 0
    s_mov_b32 s28, s19
    s_mov_b32 s29, 64
L_attn_kernel_slowb:
    buffer_load_dwordx4 v[96:99], v2, s[12:15], s28 offen
    buffer_load_dwordx4 v[100:103], v2, s[12:15], s28 offen offset:1024
    buffer_load_dwordx4 v[112:115], v2, s[12:15], s28 offen offset:2048
    buffer_load_dwordx4 v[116:119], v2, s[12:15], s28 offen offset:3072
    s_waitcnt vmcnt(0)

    v_mfma_f32_32x32x16_bf16 v[32:47], v[96:99], v[12:15], v[128:143]
    v_mfma_f32_32x32x16_bf16 v[32:47], v[100:103], v[16:19], v[32:47]
    s_nop 7
    s_nop 3
    v_exp_f32 v32, v32
    v_exp_f32 v33, v33
    v_exp_f32 v34, v34
    v_exp_f32 v35, v35
    v_exp_f32 v36, v36
    v_exp_f32 v37, v37
    v_exp_f32 v38, v38
    v_exp_f32 v39, v39
    v_exp_f32 v40, v40
    v_exp_f32 v41, v41
    v_exp_f32 v42, v42
    v_exp_f32 v43, v43
    v_exp_f32 v44, v44
    v_exp_f32 v45, v45
    v_exp_f32 v46, v46
    v_exp_f32 v47, v47
    s_nop 0
    v_cvt_pk_bf16_f32 v64, v32, v33
    v_cvt_pk_bf16_f32 v65, v34, v35
    v_cvt_pk_bf16_f32 v66, v36, v37
    v_cvt_pk_bf16_f32 v67, v38, v39
    v_cvt_pk_bf16_f32 v68, v40, v41
    v_cvt_pk_bf16_f32 v69, v42, v43
    v_cvt_pk_bf16_f32 v70, v44, v45
    v_cvt_pk_bf16_f32 v71, v46, v47
    s_nop 1
    v_mfma_f32_32x32x16_bf16 v[72:87], v[112:115], v[64:67], v[72:87]
    v_mfma_f32_16x16x32_bf16 v[88:91], v[28:31], v[64:67], v[88:91]
    v_mfma_f32_32x32x16_bf16 v[72:87], v[116:119], v[68:71], v[72:87]
    v_mfma_f32_16x16x32_bf16 v[88:91], v[28:31], v[68:71], v[88:91]
    s_add_u32 s28, s28, 4096
    s_sub_u32 s29, s29, 1
    s_cmp_lg_u32 s29, 0
    s_cbranch_scc1 L_attn_kernel_slowb
    s_nop 7
    s_nop 3
    s_branch L_attn_kernel_fin

.globl oproj_kernel
.p2align 8
.type oproj_kernel,@function
oproj_kernel:

    s_cmp_ge_u32 s2, 256
    s_cbranch_scc1 L_oproj_kernel_end

    s_load_dwordx2 s[20:21], s[0:1], 16
    s_load_dwordx2 s[22:23], s[0:1], 40
    s_load_dwordx2 s[4:5], s[0:1], 48
    s_load_dwordx2 s[12:13], s[0:1], 64
    v_lshrrev_b32 v1, 6, v0
    v_and_b32 v0, 63, v0
    s_bfe_u32 s19, s2, 0x10002
    v_readfirstlane_b32 s16, v1
    s_and_b32 s17, s2, 3
    s_lshl_b32 s17, s17, 2
    s_bfe_u32 s28, s2, 0x20003
    s_add_u32 s17, s17, s28
    s_lshr_b32 s18, s2, 5
    v_lshlrev_b32 v2, 4, v0
    s_mov_b32 s14, 29360128
    s_mov_b32 s15, 0x20000
    s_mov_b32 s10, 2097152
    s_mov_b32 s11, 0x20000
    s_mov_b32 s6, 8388608
    s_mov_b32 s7, 0x20000

    s_getpc_b64 s[62:63]
L_oproj_kernel_pc:
    s_lshr_b32 s64, s2, 3
    s_lshl_b32 s64, s64, 2
    s_add_u32 s64, s64, s16
    s_lshl_b32 s64, s64, 1
    v_add_u32 v19, s64, v0
    v_lshlrev_b32 v19, 7, v19

    s_mov_b32 s64, L_code_end-L_oproj_kernel_pc-4
    v_min_u32 v19, s64, v19
    s_mov_b64 exec, 3
    global_load_dword v19, v19, s[62:63]
    s_mov_b64 exec, -1

    s_lshl_b32 s24, s17, 2
    s_add_u32 s24, s24, s16
    s_lshl_b32 s24, s24, 16
    s_lshl_b32 s28, s19, 22
    s_add_u32 s24, s24, s28
    s_add_u32 s24, s24, 16775168
    s_lshr_b32 s28, s16, 1
    s_lshl_b32 s28, s28, 4
    s_and_b32 s29, s16, 1
    s_lshl_b32 s30, s29, 2
    s_add_u32 s28, s28, s30
    s_lshl_b32 s28, s28, 11
    s_lshl_b32 s30, s18, 8
    s_add_u32 s28, s28, s30
    s_lshl_b32 s29, s29, 1
    v_bfe_u32 v1, v0, 2, 2
    v_lshlrev_b32 v1, 11, v1
    v_lshrrev_b32 v14, 4, v0
    v_lshl_add_u32 v1, v14, 6, v1
    v_and_b32 v14, 3, v0
    v_xor_b32 v14, s29, v14
    v_lshl_add_u32 v1, v14, 4, v1
    v_add_u32 v3, s28, v1
    v_add_u32 v4, 15360, v3
    s_mov_b32 s25, 0
    s_lshl_b32 s26, s16, 12
    s_mov_b32 m0, s26

    s_mul_i32 s27, s17, 0
    s_mul_i32 s28, s18, 0
    s_add_u32 s27, s27, s28
    s_and_b32 s28, s2, 7
    s_mul_i32 s28, s28, 4
    s_add_u32 s27, s27, s28
    s_and_b32 s27, s27, 31
    s_lshl_b32 s25, s27, 16
    s_lshl_b32 s27, s27, 11
    s_mov_b32 s31, s24
    s_add_u32 s24, s31, s27

    s_waitcnt lgkmcnt(0)
    s_cmp_eq_u32 s19, 0
    s_cselect_b32 s8, s20, s22
    s_cselect_b32 s9, s21, s23

    buffer_load_dwordx4 v3, s[8:11], s25 offen lds
    buffer_load_dwordx4 v4, s[8:11], s25 offen offset:1024 lds
    buffer_load_dwordx4 v2, s[12:15], s24 offen offset:2048 lds
    buffer_load_dwordx4 v2, s[12:15], s24 offen offset:3072 lds
    s_add_u32 s25, s25, 65536
    s_and_b32 s25, s25, 2097151
    s_lshr_b32 s27, s25, 5
    s_add_u32 s24, s31, s27
    s_add_u32 m0, s26, 16384
    s_nop 0
    buffer_load_dwordx4 v3, s[8:11], s25 offen lds
    buffer_load_dwordx4 v4, s[8:11], s25 offen offset:1024 lds
    buffer_load_dwordx4 v2, s[12:15], s24 offen offset:2048 lds
    buffer_load_dwordx4 v2, s[12:15], s24 offen offset:3072 lds
    s_add_u32 s25, s25, 65536
    s_and_b32 s25, s25, 2097151
    s_lshr_b32 s27, s25, 5
    s_add_u32 s24, s31, s27
    s_add_u32 m0, s26, 32768
    s_nop 0
    v_lshrrev_b32 v1, 4, v0
    v_lshlrev_b32 v14, 12, v1
    v_bfe_u32 v15, v0, 2, 2
    v_lshl_add_u32 v14, v15, 6, v14
    v_and_b32 v15, 3, v0
    v_lshl_add_u32 v14, v15, 3, v14
    v_and_b32 v1, 1, v1
    v_lshl_add_u32 v14, v1, 5, v14
    s_and_b32 s28, s16, 1
    s_lshl_b32 s28, s28, 9
    v_add_u32 v5, s28, v14
    v_xor_b32 v6, 32, v5
    v_add_u32 v7, 0x10000, v5
    v_add_u32 v8, 0x10000, v6
    v_add_u32 v9, 0x20000, v5
    v_add_u32 v10, 0x20000, v6
    v_lshrrev_b32 v1, 4, v0
    v_lshlrev_b32 v1, 9, v1
    v_and_b32 v14, 15, v0
    v_lshl_add_u32 v1, v14, 4, v1
    s_lshr_b32 s28, s16, 1
    s_lshl_b32 s28, s28, 13
    s_add_u32 s28, s28, 2048
    v_add_u32 v11, s28, v1
    v_add_u32 v12, 0x10000, v11
    v_add_u32 v13, 0x20000, v11

    buffer_load_dwordx4 v3, s[8:11], s25 offen lds
    buffer_load_dwordx4 v4, s[8:11], s25 offen offset:1024 lds
    buffer_load_dwordx4 v2, s[12:15], s24 offen offset:2048 lds
    buffer_load_dwordx4 v2, s[12:15], s24 offen offset:3072 lds
    s_add_u32 s25, s25, 65536
    s_and_b32 s25, s25, 2097151
    s_lshr_b32 s27, s25, 5
    s_add_u32 s24, s31, s27
    s_add_u32 m0, s26, 49152
    s_nop 0
    buffer_load_dwordx4 v3, s[8:11], s25 offen lds
    buffer_load_dwordx4 v4, s[8:11], s25 offen offset:1024 lds
    buffer_load_dwordx4 v2, s[12:15], s24 offen offset:2048 lds
    buffer_load_dwordx4 v2, s[12:15], s24 offen offset:3072 lds
    s_add_u32 s25, s25, 65536
    s_and_b32 s25, s25, 2097151
    s_lshr_b32 s27, s25, 5
    s_add_u32 s24, s31, s27
    s_add_u32 m0, s26, 65536
    s_nop 0
    buffer_load_dwordx4 v3, s[8:11], s25 offen lds
    buffer_load_dwordx4 v4, s[8:11], s25 offen offset:1024 lds
    buffer_load_dwordx4 v2, s[12:15], s24 offen offset:2048 lds
    buffer_load_dwordx4 v2, s[12:15], s24 offen offset:3072 lds
    s_add_u32 s25, s25, 65536
    s_and_b32 s25, s25, 2097151
    s_lshr_b32 s27, s25, 5
    s_add_u32 s24, s31, s27
    s_add_u32 m0, s26, 81920
    s_nop 0
    s_waitcnt vmcnt(16)
    s_barrier
    ds_read_b128 v[36:39], v11 offset:0
    ds_read_b64_tr_b16 v[20:21], v5 offset:0
    ds_read_b64_tr_b16 v[22:23], v5 offset:1024
    ds_read_b64_tr_b16 v[24:25], v6 offset:0
    ds_read_b64_tr_b16 v[26:27], v6 offset:1024
    ds_read_b64_tr_b16 v[28:29], v5 offset:256
    ds_read_b64_tr_b16 v[30:31], v5 offset:1280
    ds_read_b64_tr_b16 v[32:33], v6 offset:256
    ds_read_b64_tr_b16 v[34:35], v6 offset:1280
    ds_read_b128 v[40:43], v11 offset:256
    ds_read_b128 v[44:47], v11 offset:4096
    ds_read_b128 v[48:51], v11 offset:4352
    s_waitcnt lgkmcnt(9)
    v_mfma_f32_16x16x32_bf16 v[84:87], v[20:23], v[36:39], 0
    buffer_load_dwordx4 v3, s[8:11], s25 offen lds
    s_waitcnt lgkmcnt(7)
    v_mfma_f32_16x16x32_bf16 v[88:91], v[24:27], v[36:39], 0
    s_waitcnt lgkmcnt(5)
    v_mfma_f32_16x16x32_bf16 v[92:95], v[28:31], v[36:39], 0
    s_waitcnt lgkmcnt(0)
    s_waitcnt vmcnt(13)
    s_barrier
    v_mfma_f32_16x16x32_bf16 v[96:99], v[32:35], v[36:39], 0
    ds_read_b128 v[68:71], v11 offset:16384
    v_mfma_f32_16x16x32_bf16 v[100:103], v[20:23], v[40:43], 0
    buffer_load_dwordx4 v4, s[8:11], s25 offen offset:1024 lds
    ds_read_b64_tr_b16 v[52:53], v5 offset:16384
    v_mfma_f32_16x16x32_bf16 v[104:107], v[24:27], v[40:43], 0
    ds_read_b64_tr_b16 v[54:55], v5 offset:17408
    v_mfma_f32_16x16x32_bf16 v[108:111], v[28:31], v[40:43], 0
    ds_read_b64_tr_b16 v[56:57], v6 offset:16384
    v_mfma_f32_16x16x32_bf16 v[112:115], v[32:35], v[40:43], 0
    ds_read_b64_tr_b16 v[58:59], v6 offset:17408
    v_mfma_f32_16x16x32_bf16 v[116:119], v[20:23], v[44:47], 0
    buffer_load_dwordx4 v2, s[12:15], s24 offen offset:2048 lds
    ds_read_b64_tr_b16 v[60:61], v5 offset:16640
    v_mfma_f32_16x16x32_bf16 v[120:123], v[24:27], v[44:47], 0
    ds_read_b64_tr_b16 v[62:63], v5 offset:17664
    v_mfma_f32_16x16x32_bf16 v[124:127], v[28:31], v[44:47], 0
    ds_read_b64_tr_b16 v[64:65], v6 offset:16640
    v_mfma_f32_16x16x32_bf16 v[128:131], v[32:35], v[44:47], 0
    ds_read_b64_tr_b16 v[66:67], v6 offset:17664
    v_mfma_f32_16x16x32_bf16 v[132:135], v[20:23], v[48:51], 0
    buffer_load_dwordx4 v2, s[12:15], s24 offen offset:3072 lds
    s_add_u32 s25, s25, 65536
    s_and_b32 s25, s25, 2097151
    s_lshr_b32 s27, s25, 5
    s_add_u32 s24, s31, s27
    s_add_u32 m0, s26, 98304
    ds_read_b128 v[72:75], v11 offset:16640
    v_mfma_f32_16x16x32_bf16 v[136:139], v[24:27], v[48:51], 0
    ds_read_b128 v[76:79], v11 offset:20480
    v_mfma_f32_16x16x32_bf16 v[140:143], v[28:31], v[48:51], 0
    ds_read_b128 v[80:83], v11 offset:20736
    v_mfma_f32_16x16x32_bf16 v[144:147], v[32:35], v[48:51], 0
    s_waitcnt lgkmcnt(9)
    v_mfma_f32_16x16x32_bf16 v[84:87], v[52:55], v[68:71], v[84:87]
    buffer_load_dwordx4 v3, s[8:11], s25 offen lds
    s_waitcnt lgkmcnt(7)
    v_mfma_f32_16x16x32_bf16 v[88:91], v[56:59], v[68:71], v[88:91]
    s_waitcnt lgkmcnt(5)
    v_mfma_f32_16x16x32_bf16 v[92:95], v[60:63], v[68:71], v[92:95]
    s_waitcnt lgkmcnt(0)
    s_waitcnt vmcnt(13)
    s_barrier
    v_mfma_f32_16x16x32_bf16 v[96:99], v[64:67], v[68:71], v[96:99]
    ds_read_b128 v[36:39], v11 offset:32768
    v_mfma_f32_16x16x32_bf16 v[100:103], v[52:55], v[72:75], v[100:103]
    buffer_load_dwordx4 v4, s[8:11], s25 offen offset:1024 lds
    ds_read_b64_tr_b16 v[20:21], v5 offset:32768
    v_mfma_f32_16x16x32_bf16 v[104:107], v[56:59], v[72:75], v[104:107]
    ds_read_b64_tr_b16 v[22:23], v5 offset:33792
    v_mfma_f32_16x16x32_bf16 v[108:111], v[60:63], v[72:75], v[108:111]
    ds_read_b64_tr_b16 v[24:25], v6 offset:32768
    v_mfma_f32_16x16x32_bf16 v[112:115], v[64:67], v[72:75], v[112:115]
    ds_read_b64_tr_b16 v[26:27], v6 offset:33792
    v_mfma_f32_16x16x32_bf16 v[116:119], v[52:55], v[76:79], v[116:119]
    buffer_load_dwordx4 v2, s[12:15], s24 offen offset:2048 lds
    ds_read_b64_tr_b16 v[28:29], v5 offset:33024
    v_mfma_f32_16x16x32_bf16 v[120:123], v[56:59], v[76:79], v[120:123]
    ds_read_b64_tr_b16 v[30:31], v5 offset:34048
    v_mfma_f32_16x16x32_bf16 v[124:127], v[60:63], v[76:79], v[124:127]
    ds_read_b64_tr_b16 v[32:33], v6 offset:33024
    v_mfma_f32_16x16x32_bf16 v[128:131], v[64:67], v[76:79], v[128:131]
    ds_read_b64_tr_b16 v[34:35], v6 offset:34048
    v_mfma_f32_16x16x32_bf16 v[132:135], v[52:55], v[80:83], v[132:135]
    buffer_load_dwordx4 v2, s[12:15], s24 offen offset:3072 lds
    s_add_u32 s25, s25, 65536
    s_and_b32 s25, s25, 2097151
    s_lshr_b32 s27, s25, 5
    s_add_u32 s24, s31, s27
    s_add_u32 m0, s26, 114688
    ds_read_b128 v[40:43], v11 offset:33024
    v_mfma_f32_16x16x32_bf16 v[136:139], v[56:59], v[80:83], v[136:139]
    ds_read_b128 v[44:47], v11 offset:36864
    v_mfma_f32_16x16x32_bf16 v[140:143], v[60:63], v[80:83], v[140:143]
    ds_read_b128 v[48:51], v11 offset:37120
    v_mfma_f32_16x16x32_bf16 v[144:147], v[64:67], v[80:83], v[144:147]
    s_waitcnt lgkmcnt(9)
    v_mfma_f32_16x16x32_bf16 v[84:87], v[20:23], v[36:39], v[84:87]
    buffer_load_dwordx4 v3, s[8:11], s25 offen lds
    s_waitcnt lgkmcnt(7)
    v_mfma_f32_16x16x32_bf16 v[88:91], v[24:27], v[36:39], v[88:91]
    s_waitcnt lgkmcnt(5)
    v_mfma_f32_16x16x32_bf16 v[92:95], v[28:31], v[36:39], v[92:95]
    s_waitcnt lgkmcnt(0)
    s_waitcnt vmcnt(13)
    s_barrier
    v_mfma_f32_16x16x32_bf16 v[96:99], v[32:35], v[36:39], v[96:99]
    ds_read_b128 v[68:71], v11 offset:49152
    v_mfma_f32_16x16x32_bf16 v[100:103], v[20:23], v[40:43], v[100:103]
    buffer_load_dwordx4 v4, s[8:11], s25 offen offset:1024 lds
    ds_read_b64_tr_b16 v[52:53], v5 offset:49152
    v_mfma_f32_16x16x32_bf16 v[104:107], v[24:27], v[40:43], v[104:107]
    ds_read_b64_tr_b16 v[54:55], v5 offset:50176
    v_mfma_f32_16x16x32_bf16 v[108:111], v[28:31], v[40:43], v[108:111]
    ds_read_b64_tr_b16 v[56:57], v6 offset:49152
    v_mfma_f32_16x16x32_bf16 v[112:115], v[32:35], v[40:43], v[112:115]
    ds_read_b64_tr_b16 v[58:59], v6 offset:50176
    v_mfma_f32_16x16x32_bf16 v[116:119], v[20:23], v[44:47], v[116:119]
    buffer_load_dwordx4 v2, s[12:15], s24 offen offset:2048 lds
    ds_read_b64_tr_b16 v[60:61], v5 offset:49408
    v_mfma_f32_16x16x32_bf16 v[120:123], v[24:27], v[44:47], v[120:123]
    ds_read_b64_tr_b16 v[62:63], v5 offset:50432
    v_mfma_f32_16x16x32_bf16 v[124:127], v[28:31], v[44:47], v[124:127]
    ds_read_b64_tr_b16 v[64:65], v6 offset:49408
    v_mfma_f32_16x16x32_bf16 v[128:131], v[32:35], v[44:47], v[128:131]
    ds_read_b64_tr_b16 v[66:67], v6 offset:50432
    v_mfma_f32_16x16x32_bf16 v[132:135], v[20:23], v[48:51], v[132:135]
    buffer_load_dwordx4 v2, s[12:15], s24 offen offset:3072 lds
    s_add_u32 s25, s25, 65536
    s_and_b32 s25, s25, 2097151
    s_lshr_b32 s27, s25, 5
    s_add_u32 s24, s31, s27
    s_add_u32 m0, s26, 131072
    ds_read_b128 v[72:75], v11 offset:49408
    v_mfma_f32_16x16x32_bf16 v[136:139], v[24:27], v[48:51], v[136:139]
    ds_read_b128 v[76:79], v11 offset:53248
    v_mfma_f32_16x16x32_bf16 v[140:143], v[28:31], v[48:51], v[140:143]
    ds_read_b128 v[80:83], v11 offset:53504
    v_mfma_f32_16x16x32_bf16 v[144:147], v[32:35], v[48:51], v[144:147]
    s_waitcnt lgkmcnt(9)
    v_mfma_f32_16x16x32_bf16 v[84:87], v[52:55], v[68:71], v[84:87]
    buffer_load_dwordx4 v3, s[8:11], s25 offen lds
    s_waitcnt lgkmcnt(7)
    v_mfma_f32_16x16x32_bf16 v[88:91], v[56:59], v[68:71], v[88:91]
    s_waitcnt lgkmcnt(5)
    v_mfma_f32_16x16x32_bf16 v[92:95], v[60:63], v[68:71], v[92:95]
    s_waitcnt lgkmcnt(0)
    s_waitcnt vmcnt(13)
    s_barrier
    v_mfma_f32_16x16x32_bf16 v[96:99], v[64:67], v[68:71], v[96:99]
    ds_read_b128 v[36:39], v12 offset:0
    v_mfma_f32_16x16x32_bf16 v[100:103], v[52:55], v[72:75], v[100:103]
    buffer_load_dwordx4 v4, s[8:11], s25 offen offset:1024 lds
    ds_read_b64_tr_b16 v[20:21], v7 offset:0
    v_mfma_f32_16x16x32_bf16 v[104:107], v[56:59], v[72:75], v[104:107]
    ds_read_b64_tr_b16 v[22:23], v7 offset:1024
    v_mfma_f32_16x16x32_bf16 v[108:111], v[60:63], v[72:75], v[108:111]
    ds_read_b64_tr_b16 v[24:25], v8 offset:0
    v_mfma_f32_16x16x32_bf16 v[112:115], v[64:67], v[72:75], v[112:115]
    ds_read_b64_tr_b16 v[26:27], v8 offset:1024
    v_mfma_f32_16x16x32_bf16 v[116:119], v[52:55], v[76:79], v[116:119]
    buffer_load_dwordx4 v2, s[12:15], s24 offen offset:2048 lds
    ds_read_b64_tr_b16 v[28:29], v7 offset:256
    v_mfma_f32_16x16x32_bf16 v[120:123], v[56:59], v[76:79], v[120:123]
    ds_read_b64_tr_b16 v[30:31], v7 offset:1280
    v_mfma_f32_16x16x32_bf16 v[124:127], v[60:63], v[76:79], v[124:127]
    ds_read_b64_tr_b16 v[32:33], v8 offset:256
    v_mfma_f32_16x16x32_bf16 v[128:131], v[64:67], v[76:79], v[128:131]
    ds_read_b64_tr_b16 v[34:35], v8 offset:1280
    v_mfma_f32_16x16x32_bf16 v[132:135], v[52:55], v[80:83], v[132:135]
    buffer_load_dwordx4 v2, s[12:15], s24 offen offset:3072 lds
    s_add_u32 s25, s25, 65536
    s_and_b32 s25, s25, 2097151
    s_lshr_b32 s27, s25, 5
    s_add_u32 s24, s31, s27
    s_add_u32 m0, s26, 147456
    ds_read_b128 v[40:43], v12 offset:256
    v_mfma_f32_16x16x32_bf16 v[136:139], v[56:59], v[80:83], v[136:139]
    ds_read_b128 v[44:47], v12 offset:4096
    v_mfma_f32_16x16x32_bf16 v[140:143], v[60:63], v[80:83], v[140:143]
    ds_read_b128 v[48:51], v12 offset:4352
    v_mfma_f32_16x16x32_bf16 v[144:147], v[64:67], v[80:83], v[144:147]
    s_waitcnt lgkmcnt(9)
    v_mfma_f32_16x16x32_bf16 v[84:87], v[20:23], v[36:39], v[84:87]
    buffer_load_dwordx4 v3, s[8:11], s25 offen lds
    s_waitcnt lgkmcnt(7)
    v_mfma_f32_16x16x32_bf16 v[88:91], v[24:27], v[36:39], v[88:91]
    s_waitcnt lgkmcnt(5)
    v_mfma_f32_16x16x32_bf16 v[92:95], v[28:31], v[36:39], v[92:95]
    s_waitcnt lgkmcnt(0)
    s_waitcnt vmcnt(13)
    s_barrier
    v_mfma_f32_16x16x32_bf16 v[96:99], v[32:35], v[36:39], v[96:99]
    ds_read_b128 v[68:71], v12 offset:16384
    v_mfma_f32_16x16x32_bf16 v[100:103], v[20:23], v[40:43], v[100:103]
    buffer_load_dwordx4 v4, s[8:11], s25 offen offset:1024 lds
    ds_read_b64_tr_b16 v[52:53], v7 offset:16384
    v_mfma_f32_16x16x32_bf16 v[104:107], v[24:27], v[40:43], v[104:107]
    ds_read_b64_tr_b16 v[54:55], v7 offset:17408
    v_mfma_f32_16x16x32_bf16 v[108:111], v[28:31], v[40:43], v[108:111]
    ds_read_b64_tr_b16 v[56:57], v8 offset:16384
    v_mfma_f32_16x16x32_bf16 v[112:115], v[32:35], v[40:43], v[112:115]
    ds_read_b64_tr_b16 v[58:59], v8 offset:17408
    v_mfma_f32_16x16x32_bf16 v[116:119], v[20:23], v[44:47], v[116:119]
    buffer_load_dwordx4 v2, s[12:15], s24 offen offset:2048 lds
    ds_read_b64_tr_b16 v[60:61], v7 offset:16640
    v_mfma_f32_16x16x32_bf16 v[120:123], v[24:27], v[44:47], v[120:123]
    ds_read_b64_tr_b16 v[62:63], v7 offset:17664
    v_mfma_f32_16x16x32_bf16 v[124:127], v[28:31], v[44:47], v[124:127]
    ds_read_b64_tr_b16 v[64:65], v8 offset:16640
    v_mfma_f32_16x16x32_bf16 v[128:131], v[32:35], v[44:47], v[128:131]
    ds_read_b64_tr_b16 v[66:67], v8 offset:17664
    v_mfma_f32_16x16x32_bf16 v[132:135], v[20:23], v[48:51], v[132:135]
    buffer_load_dwordx4 v2, s[12:15], s24 offen offset:3072 lds
    s_add_u32 s25, s25, 65536
    s_and_b32 s25, s25, 2097151
    s_lshr_b32 s27, s25, 5
    s_add_u32 s24, s31, s27
    s_add_u32 m0, s26, 0
    ds_read_b128 v[72:75], v12 offset:16640
    v_mfma_f32_16x16x32_bf16 v[136:139], v[24:27], v[48:51], v[136:139]
    ds_read_b128 v[76:79], v12 offset:20480
    v_mfma_f32_16x16x32_bf16 v[140:143], v[28:31], v[48:51], v[140:143]
    ds_read_b128 v[80:83], v12 offset:20736
    v_mfma_f32_16x16x32_bf16 v[144:147], v[32:35], v[48:51], v[144:147]
    s_waitcnt lgkmcnt(9)
    v_mfma_f32_16x16x32_bf16 v[84:87], v[52:55], v[68:71], v[84:87]
    buffer_load_dwordx4 v3, s[8:11], s25 offen lds
    s_waitcnt lgkmcnt(7)
    v_mfma_f32_16x16x32_bf16 v[88:91], v[56:59], v[68:71], v[88:91]
    s_waitcnt lgkmcnt(5)
    v_mfma_f32_16x16x32_bf16 v[92:95], v[60:63], v[68:71], v[92:95]
    s_waitcnt lgkmcnt(0)
    s_waitcnt vmcnt(13)
    s_barrier
    v_mfma_f32_16x16x32_bf16 v[96:99], v[64:67], v[68:71], v[96:99]
    ds_read_b128 v[36:39], v12 offset:32768
    v_mfma_f32_16x16x32_bf16 v[100:103], v[52:55], v[72:75], v[100:103]
    buffer_load_dwordx4 v4, s[8:11], s25 offen offset:1024 lds
    ds_read_b64_tr_b16 v[20:21], v7 offset:32768
    v_mfma_f32_16x16x32_bf16 v[104:107], v[56:59], v[72:75], v[104:107]
    ds_read_b64_tr_b16 v[22:23], v7 offset:33792
    v_mfma_f32_16x16x32_bf16 v[108:111], v[60:63], v[72:75], v[108:111]
    ds_read_b64_tr_b16 v[24:25], v8 offset:32768
    v_mfma_f32_16x16x32_bf16 v[112:115], v[64:67], v[72:75], v[112:115]
    ds_read_b64_tr_b16 v[26:27], v8 offset:33792
    v_mfma_f32_16x16x32_bf16 v[116:119], v[52:55], v[76:79], v[116:119]
    buffer_load_dwordx4 v2, s[12:15], s24 offen offset:2048 lds
    ds_read_b64_tr_b16 v[28:29], v7 offset:33024
    v_mfma_f32_16x16x32_bf16 v[120:123], v[56:59], v[76:79], v[120:123]
    ds_read_b64_tr_b16 v[30:31], v7 offset:34048
    v_mfma_f32_16x16x32_bf16 v[124:127], v[60:63], v[76:79], v[124:127]
    ds_read_b64_tr_b16 v[32:33], v8 offset:33024
    v_mfma_f32_16x16x32_bf16 v[128:131], v[64:67], v[76:79], v[128:131]
    ds_read_b64_tr_b16 v[34:35], v8 offset:34048
    v_mfma_f32_16x16x32_bf16 v[132:135], v[52:55], v[80:83], v[132:135]
    buffer_load_dwordx4 v2, s[12:15], s24 offen offset:3072 lds
    s_add_u32 s25, s25, 65536
    s_and_b32 s25, s25, 2097151
    s_lshr_b32 s27, s25, 5
    s_add_u32 s24, s31, s27
    s_add_u32 m0, s26, 16384
    ds_read_b128 v[40:43], v12 offset:33024
    v_mfma_f32_16x16x32_bf16 v[136:139], v[56:59], v[80:83], v[136:139]
    ds_read_b128 v[44:47], v12 offset:36864
    v_mfma_f32_16x16x32_bf16 v[140:143], v[60:63], v[80:83], v[140:143]
    ds_read_b128 v[48:51], v12 offset:37120
    v_mfma_f32_16x16x32_bf16 v[144:147], v[64:67], v[80:83], v[144:147]
    s_waitcnt lgkmcnt(9)
    v_mfma_f32_16x16x32_bf16 v[84:87], v[20:23], v[36:39], v[84:87]
    buffer_load_dwordx4 v3, s[8:11], s25 offen lds
    s_waitcnt lgkmcnt(7)
    v_mfma_f32_16x16x32_bf16 v[88:91], v[24:27], v[36:39], v[88:91]
    s_waitcnt lgkmcnt(5)
    v_mfma_f32_16x16x32_bf16 v[92:95], v[28:31], v[36:39], v[92:95]
    s_waitcnt lgkmcnt(0)
    s_waitcnt vmcnt(13)
    s_barrier
    v_mfma_f32_16x16x32_bf16 v[96:99], v[32:35], v[36:39], v[96:99]
    ds_read_b128 v[68:71], v12 offset:49152
    v_mfma_f32_16x16x32_bf16 v[100:103], v[20:23], v[40:43], v[100:103]
    buffer_load_dwordx4 v4, s[8:11], s25 offen offset:1024 lds
    ds_read_b64_tr_b16 v[52:53], v7 offset:49152
    v_mfma_f32_16x16x32_bf16 v[104:107], v[24:27], v[40:43], v[104:107]
    ds_read_b64_tr_b16 v[54:55], v7 offset:50176
    v_mfma_f32_16x16x32_bf16 v[108:111], v[28:31], v[40:43], v[108:111]
    ds_read_b64_tr_b16 v[56:57], v8 offset:49152
    v_mfma_f32_16x16x32_bf16 v[112:115], v[32:35], v[40:43], v[112:115]
    ds_read_b64_tr_b16 v[58:59], v8 offset:50176
    v_mfma_f32_16x16x32_bf16 v[116:119], v[20:23], v[44:47], v[116:119]
    buffer_load_dwordx4 v2, s[12:15], s24 offen offset:2048 lds
    ds_read_b64_tr_b16 v[60:61], v7 offset:49408
    v_mfma_f32_16x16x32_bf16 v[120:123], v[24:27], v[44:47], v[120:123]
    ds_read_b64_tr_b16 v[62:63], v7 offset:50432
    v_mfma_f32_16x16x32_bf16 v[124:127], v[28:31], v[44:47], v[124:127]
    ds_read_b64_tr_b16 v[64:65], v8 offset:49408
    v_mfma_f32_16x16x32_bf16 v[128:131], v[32:35], v[44:47], v[128:131]
    ds_read_b64_tr_b16 v[66:67], v8 offset:50432
    v_mfma_f32_16x16x32_bf16 v[132:135], v[20:23], v[48:51], v[132:135]
    buffer_load_dwordx4 v2, s[12:15], s24 offen offset:3072 lds
    s_add_u32 s25, s25, 65536
    s_and_b32 s25, s25, 2097151
    s_lshr_b32 s27, s25, 5
    s_add_u32 s24, s31, s27
    s_add_u32 m0, s26, 32768
    ds_read_b128 v[72:75], v12 offset:49408
    v_mfma_f32_16x16x32_bf16 v[136:139], v[24:27], v[48:51], v[136:139]
    ds_read_b128 v[76:79], v12 offset:53248
    v_mfma_f32_16x16x32_bf16 v[140:143], v[28:31], v[48:51], v[140:143]
    ds_read_b128 v[80:83], v12 offset:53504
    v_mfma_f32_16x16x32_bf16 v[144:147], v[32:35], v[48:51], v[144:147]
    s_waitcnt lgkmcnt(9)
    v_mfma_f32_16x16x32_bf16 v[84:87], v[52:55], v[68:71], v[84:87]
    buffer_load_dwordx4 v3, s[8:11], s25 offen lds
    s_waitcnt lgkmcnt(7)
    v_mfma_f32_16x16x32_bf16 v[88:91], v[56:59], v[68:71], v[88:91]
    s_waitcnt lgkmcnt(5)
    v_mfma_f32_16x16x32_bf16 v[92:95], v[60:63], v[68:71], v[92:95]
    s_waitcnt lgkmcnt(0)
    s_waitcnt vmcnt(13)
    s_barrier
    v_mfma_f32_16x16x32_bf16 v[96:99], v[64:67], v[68:71], v[96:99]
    ds_read_b128 v[36:39], v13 offset:0
    v_mfma_f32_16x16x32_bf16 v[100:103], v[52:55], v[72:75], v[100:103]
    buffer_load_dwordx4 v4, s[8:11], s25 offen offset:1024 lds
    ds_read_b64_tr_b16 v[20:21], v9 offset:0
    v_mfma_f32_16x16x32_bf16 v[104:107], v[56:59], v[72:75], v[104:107]
    ds_read_b64_tr_b16 v[22:23], v9 offset:1024
    v_mfma_f32_16x16x32_bf16 v[108:111], v[60:63], v[72:75], v[108:111]
    ds_read_b64_tr_b16 v[24:25], v10 offset:0
    v_mfma_f32_16x16x32_bf16 v[112:115], v[64:67], v[72:75], v[112:115]
    ds_read_b64_tr_b16 v[26:27], v10 offset:1024
    v_mfma_f32_16x16x32_bf16 v[116:119], v[52:55], v[76:79], v[116:119]
    buffer_load_dwordx4 v2, s[12:15], s24 offen offset:2048 lds
    ds_read_b64_tr_b16 v[28:29], v9 offset:256
    v_mfma_f32_16x16x32_bf16 v[120:123], v[56:59], v[76:79], v[120:123]
    ds_read_b64_tr_b16 v[30:31], v9 offset:1280
    v_mfma_f32_16x16x32_bf16 v[124:127], v[60:63], v[76:79], v[124:127]
    ds_read_b64_tr_b16 v[32:33], v10 offset:256
    v_mfma_f32_16x16x32_bf16 v[128:131], v[64:67], v[76:79], v[128:131]
    ds_read_b64_tr_b16 v[34:35], v10 offset:1280
    v_mfma_f32_16x16x32_bf16 v[132:135], v[52:55], v[80:83], v[132:135]
    buffer_load_dwordx4 v2, s[12:15], s24 offen offset:3072 lds
    s_add_u32 s25, s25, 65536
    s_and_b32 s25, s25, 2097151
    s_lshr_b32 s27, s25, 5
    s_add_u32 s24, s31, s27
    s_add_u32 m0, s26, 49152
    ds_read_b128 v[40:43], v13 offset:256
    v_mfma_f32_16x16x32_bf16 v[136:139], v[56:59], v[80:83], v[136:139]
    ds_read_b128 v[44:47], v13 offset:4096
    v_mfma_f32_16x16x32_bf16 v[140:143], v[60:63], v[80:83], v[140:143]
    ds_read_b128 v[48:51], v13 offset:4352
    v_mfma_f32_16x16x32_bf16 v[144:147], v[64:67], v[80:83], v[144:147]
    s_waitcnt lgkmcnt(9)
    v_mfma_f32_16x16x32_bf16 v[84:87], v[20:23], v[36:39], v[84:87]
    buffer_load_dwordx4 v3, s[8:11], s25 offen lds
    s_waitcnt lgkmcnt(7)
    v_mfma_f32_16x16x32_bf16 v[88:91], v[24:27], v[36:39], v[88:91]
    s_waitcnt lgkmcnt(5)
    v_mfma_f32_16x16x32_bf16 v[92:95], v[28:31], v[36:39], v[92:95]
    s_waitcnt lgkmcnt(0)
    s_waitcnt vmcnt(13)
    s_barrier
    v_mfma_f32_16x16x32_bf16 v[96:99], v[32:35], v[36:39], v[96:99]
    ds_read_b128 v[68:71], v13 offset:16384
    v_mfma_f32_16x16x32_bf16 v[100:103], v[20:23], v[40:43], v[100:103]
    buffer_load_dwordx4 v4, s[8:11], s25 offen offset:1024 lds
    ds_read_b64_tr_b16 v[52:53], v9 offset:16384
    v_mfma_f32_16x16x32_bf16 v[104:107], v[24:27], v[40:43], v[104:107]
    ds_read_b64_tr_b16 v[54:55], v9 offset:17408
    v_mfma_f32_16x16x32_bf16 v[108:111], v[28:31], v[40:43], v[108:111]
    ds_read_b64_tr_b16 v[56:57], v10 offset:16384
    v_mfma_f32_16x16x32_bf16 v[112:115], v[32:35], v[40:43], v[112:115]
    ds_read_b64_tr_b16 v[58:59], v10 offset:17408
    v_mfma_f32_16x16x32_bf16 v[116:119], v[20:23], v[44:47], v[116:119]
    buffer_load_dwordx4 v2, s[12:15], s24 offen offset:2048 lds
    ds_read_b64_tr_b16 v[60:61], v9 offset:16640
    v_mfma_f32_16x16x32_bf16 v[120:123], v[24:27], v[44:47], v[120:123]
    ds_read_b64_tr_b16 v[62:63], v9 offset:17664
    v_mfma_f32_16x16x32_bf16 v[124:127], v[28:31], v[44:47], v[124:127]
    ds_read_b64_tr_b16 v[64:65], v10 offset:16640
    v_mfma_f32_16x16x32_bf16 v[128:131], v[32:35], v[44:47], v[128:131]
    ds_read_b64_tr_b16 v[66:67], v10 offset:17664
    v_mfma_f32_16x16x32_bf16 v[132:135], v[20:23], v[48:51], v[132:135]
    buffer_load_dwordx4 v2, s[12:15], s24 offen offset:3072 lds
    s_add_u32 s25, s25, 65536
    s_and_b32 s25, s25, 2097151
    s_lshr_b32 s27, s25, 5
    s_add_u32 s24, s31, s27
    s_add_u32 m0, s26, 65536
    ds_read_b128 v[72:75], v13 offset:16640
    v_mfma_f32_16x16x32_bf16 v[136:139], v[24:27], v[48:51], v[136:139]
    ds_read_b128 v[76:79], v13 offset:20480
    v_mfma_f32_16x16x32_bf16 v[140:143], v[28:31], v[48:51], v[140:143]
    ds_read_b128 v[80:83], v13 offset:20736
    v_mfma_f32_16x16x32_bf16 v[144:147], v[32:35], v[48:51], v[144:147]
    s_waitcnt lgkmcnt(9)
    v_mfma_f32_16x16x32_bf16 v[84:87], v[52:55], v[68:71], v[84:87]
    buffer_load_dwordx4 v3, s[8:11], s25 offen lds
    s_waitcnt lgkmcnt(7)
    v_mfma_f32_16x16x32_bf16 v[88:91], v[56:59], v[68:71], v[88:91]
    s_waitcnt lgkmcnt(5)
    v_mfma_f32_16x16x32_bf16 v[92:95], v[60:63], v[68:71], v[92:95]
    s_waitcnt lgkmcnt(0)
    s_waitcnt vmcnt(13)
    s_barrier
    v_mfma_f32_16x16x32_bf16 v[96:99], v[64:67], v[68:71], v[96:99]
    ds_read_b128 v[36:39], v11 offset:0
    v_mfma_f32_16x16x32_bf16 v[100:103], v[52:55], v[72:75], v[100:103]
    buffer_load_dwordx4 v4, s[8:11], s25 offen offset:1024 lds
    ds_read_b64_tr_b16 v[20:21], v5 offset:0
    v_mfma_f32_16x16x32_bf16 v[104:107], v[56:59], v[72:75], v[104:107]
    ds_read_b64_tr_b16 v[22:23], v5 offset:1024
    v_mfma_f32_16x16x32_bf16 v[108:111], v[60:63], v[72:75], v[108:111]
    ds_read_b64_tr_b16 v[24:25], v6 offset:0
    v_mfma_f32_16x16x32_bf16 v[112:115], v[64:67], v[72:75], v[112:115]
    ds_read_b64_tr_b16 v[26:27], v6 offset:1024
    v_mfma_f32_16x16x32_bf16 v[116:119], v[52:55], v[76:79], v[116:119]
    buffer_load_dwordx4 v2, s[12:15], s24 offen offset:2048 lds
    ds_read_b64_tr_b16 v[28:29], v5 offset:256
    v_mfma_f32_16x16x32_bf16 v[120:123], v[56:59], v[76:79], v[120:123]
    ds_read_b64_tr_b16 v[30:31], v5 offset:1280
    v_mfma_f32_16x16x32_bf16 v[124:127], v[60:63], v[76:79], v[124:127]
    ds_read_b64_tr_b16 v[32:33], v6 offset:256
    v_mfma_f32_16x16x32_bf16 v[128:131], v[64:67], v[76:79], v[128:131]
    ds_read_b64_tr_b16 v[34:35], v6 offset:1280
    v_mfma_f32_16x16x32_bf16 v[132:135], v[52:55], v[80:83], v[132:135]
    buffer_load_dwordx4 v2, s[12:15], s24 offen offset:3072 lds
    s_add_u32 s25, s25, 65536
    s_and_b32 s25, s25, 2097151
    s_lshr_b32 s27, s25, 5
    s_add_u32 s24, s31, s27
    s_add_u32 m0, s26, 81920
    ds_read_b128 v[40:43], v11 offset:256
    v_mfma_f32_16x16x32_bf16 v[136:139], v[56:59], v[80:83], v[136:139]
    ds_read_b128 v[44:47], v11 offset:4096
    v_mfma_f32_16x16x32_bf16 v[140:143], v[60:63], v[80:83], v[140:143]
    ds_read_b128 v[48:51], v11 offset:4352
    v_mfma_f32_16x16x32_bf16 v[144:147], v[64:67], v[80:83], v[144:147]
    s_waitcnt lgkmcnt(9)
    v_mfma_f32_16x16x32_bf16 v[84:87], v[20:23], v[36:39], v[84:87]
    buffer_load_dwordx4 v3, s[8:11], s25 offen lds
    s_waitcnt lgkmcnt(7)
    v_mfma_f32_16x16x32_bf16 v[88:91], v[24:27], v[36:39], v[88:91]
    s_waitcnt lgkmcnt(5)
    v_mfma_f32_16x16x32_bf16 v[92:95], v[28:31], v[36:39], v[92:95]
    s_waitcnt lgkmcnt(0)
    s_waitcnt vmcnt(13)
    s_barrier
    v_mfma_f32_16x16x32_bf16 v[96:99], v[32:35], v[36:39], v[96:99]
    ds_read_b128 v[68:71], v11 offset:16384
    v_mfma_f32_16x16x32_bf16 v[100:103], v[20:23], v[40:43], v[100:103]
    buffer_load_dwordx4 v4, s[8:11], s25 offen offset:1024 lds
    ds_read_b64_tr_b16 v[52:53], v5 offset:16384
    v_mfma_f32_16x16x32_bf16 v[104:107], v[24:27], v[40:43], v[104:107]
    ds_read_b64_tr_b16 v[54:55], v5 offset:17408
    v_mfma_f32_16x16x32_bf16 v[108:111], v[28:31], v[40:43], v[108:111]
    ds_read_b64_tr_b16 v[56:57], v6 offset:16384
    v_mfma_f32_16x16x32_bf16 v[112:115], v[32:35], v[40:43], v[112:115]
    ds_read_b64_tr_b16 v[58:59], v6 offset:17408
    v_mfma_f32_16x16x32_bf16 v[116:119], v[20:23], v[44:47], v[116:119]
    buffer_load_dwordx4 v2, s[12:15], s24 offen offset:2048 lds
    ds_read_b64_tr_b16 v[60:61], v5 offset:16640
    v_mfma_f32_16x16x32_bf16 v[120:123], v[24:27], v[44:47], v[120:123]
    ds_read_b64_tr_b16 v[62:63], v5 offset:17664
    v_mfma_f32_16x16x32_bf16 v[124:127], v[28:31], v[44:47], v[124:127]
    ds_read_b64_tr_b16 v[64:65], v6 offset:16640
    v_mfma_f32_16x16x32_bf16 v[128:131], v[32:35], v[44:47], v[128:131]
    ds_read_b64_tr_b16 v[66:67], v6 offset:17664
    v_mfma_f32_16x16x32_bf16 v[132:135], v[20:23], v[48:51], v[132:135]
    buffer_load_dwordx4 v2, s[12:15], s24 offen offset:3072 lds
    s_add_u32 s25, s25, 65536
    s_and_b32 s25, s25, 2097151
    s_lshr_b32 s27, s25, 5
    s_add_u32 s24, s31, s27
    s_add_u32 m0, s26, 98304
    ds_read_b128 v[72:75], v11 offset:16640
    v_mfma_f32_16x16x32_bf16 v[136:139], v[24:27], v[48:51], v[136:139]
    ds_read_b128 v[76:79], v11 offset:20480
    v_mfma_f32_16x16x32_bf16 v[140:143], v[28:31], v[48:51], v[140:143]
    ds_read_b128 v[80:83], v11 offset:20736
    v_mfma_f32_16x16x32_bf16 v[144:147], v[32:35], v[48:51], v[144:147]
    s_waitcnt lgkmcnt(9)
    v_mfma_f32_16x16x32_bf16 v[84:87], v[52:55], v[68:71], v[84:87]
    buffer_load_dwordx4 v3, s[8:11], s25 offen lds
    s_waitcnt lgkmcnt(7)
    v_mfma_f32_16x16x32_bf16 v[88:91], v[56:59], v[68:71], v[88:91]
    s_waitcnt lgkmcnt(5)
    v_mfma_f32_16x16x32_bf16 v[92:95], v[60:63], v[68:71], v[92:95]
    s_waitcnt lgkmcnt(0)
    s_waitcnt vmcnt(13)
    s_barrier
    v_mfma_f32_16x16x32_bf16 v[96:99], v[64:67], v[68:71], v[96:99]
    ds_read_b128 v[36:39], v11 offset:32768
    v_mfma_f32_16x16x32_bf16 v[100:103], v[52:55], v[72:75], v[100:103]
    buffer_load_dwordx4 v4, s[8:11], s25 offen offset:1024 lds
    ds_read_b64_tr_b16 v[20:21], v5 offset:32768
    v_mfma_f32_16x16x32_bf16 v[104:107], v[56:59], v[72:75], v[104:107]
    ds_read_b64_tr_b16 v[22:23], v5 offset:33792
    v_mfma_f32_16x16x32_bf16 v[108:111], v[60:63], v[72:75], v[108:111]
    ds_read_b64_tr_b16 v[24:25], v6 offset:32768
    v_mfma_f32_16x16x32_bf16 v[112:115], v[64:67], v[72:75], v[112:115]
    ds_read_b64_tr_b16 v[26:27], v6 offset:33792
    v_mfma_f32_16x16x32_bf16 v[116:119], v[52:55], v[76:79], v[116:119]
    buffer_load_dwordx4 v2, s[12:15], s24 offen offset:2048 lds
    ds_read_b64_tr_b16 v[28:29], v5 offset:33024
    v_mfma_f32_16x16x32_bf16 v[120:123], v[56:59], v[76:79], v[120:123]
    ds_read_b64_tr_b16 v[30:31], v5 offset:34048
    v_mfma_f32_16x16x32_bf16 v[124:127], v[60:63], v[76:79], v[124:127]
    ds_read_b64_tr_b16 v[32:33], v6 offset:33024
    v_mfma_f32_16x16x32_bf16 v[128:131], v[64:67], v[76:79], v[128:131]
    ds_read_b64_tr_b16 v[34:35], v6 offset:34048
    v_mfma_f32_16x16x32_bf16 v[132:135], v[52:55], v[80:83], v[132:135]
    buffer_load_dwordx4 v2, s[12:15], s24 offen offset:3072 lds
    s_add_u32 s25, s25, 65536
    s_and_b32 s25, s25, 2097151
    s_lshr_b32 s27, s25, 5
    s_add_u32 s24, s31, s27
    s_add_u32 m0, s26, 114688
    ds_read_b128 v[40:43], v11 offset:33024
    v_mfma_f32_16x16x32_bf16 v[136:139], v[56:59], v[80:83], v[136:139]
    ds_read_b128 v[44:47], v11 offset:36864
    v_mfma_f32_16x16x32_bf16 v[140:143], v[60:63], v[80:83], v[140:143]
    ds_read_b128 v[48:51], v11 offset:37120
    v_mfma_f32_16x16x32_bf16 v[144:147], v[64:67], v[80:83], v[144:147]
    s_waitcnt lgkmcnt(9)
    v_mfma_f32_16x16x32_bf16 v[84:87], v[20:23], v[36:39], v[84:87]
    buffer_load_dwordx4 v3, s[8:11], s25 offen lds
    s_waitcnt lgkmcnt(7)
    v_mfma_f32_16x16x32_bf16 v[88:91], v[24:27], v[36:39], v[88:91]
    s_waitcnt lgkmcnt(5)
    v_mfma_f32_16x16x32_bf16 v[92:95], v[28:31], v[36:39], v[92:95]
    s_waitcnt lgkmcnt(0)
    s_waitcnt vmcnt(13)
    s_barrier
    v_mfma_f32_16x16x32_bf16 v[96:99], v[32:35], v[36:39], v[96:99]
    ds_read_b128 v[68:71], v11 offset:49152
    v_mfma_f32_16x16x32_bf16 v[100:103], v[20:23], v[40:43], v[100:103]
    buffer_load_dwordx4 v4, s[8:11], s25 offen offset:1024 lds
    ds_read_b64_tr_b16 v[52:53], v5 offset:49152
    v_mfma_f32_16x16x32_bf16 v[104:107], v[24:27], v[40:43], v[104:107]
    ds_read_b64_tr_b16 v[54:55], v5 offset:50176
    v_mfma_f32_16x16x32_bf16 v[108:111], v[28:31], v[40:43], v[108:111]
    ds_read_b64_tr_b16 v[56:57], v6 offset:49152
    v_mfma_f32_16x16x32_bf16 v[112:115], v[32:35], v[40:43], v[112:115]
    ds_read_b64_tr_b16 v[58:59], v6 offset:50176
    v_mfma_f32_16x16x32_bf16 v[116:119], v[20:23], v[44:47], v[116:119]
    buffer_load_dwordx4 v2, s[12:15], s24 offen offset:2048 lds
    ds_read_b64_tr_b16 v[60:61], v5 offset:49408
    v_mfma_f32_16x16x32_bf16 v[120:123], v[24:27], v[44:47], v[120:123]
    ds_read_b64_tr_b16 v[62:63], v5 offset:50432
    v_mfma_f32_16x16x32_bf16 v[124:127], v[28:31], v[44:47], v[124:127]
    ds_read_b64_tr_b16 v[64:65], v6 offset:49408
    v_mfma_f32_16x16x32_bf16 v[128:131], v[32:35], v[44:47], v[128:131]
    ds_read_b64_tr_b16 v[66:67], v6 offset:50432
    v_mfma_f32_16x16x32_bf16 v[132:135], v[20:23], v[48:51], v[132:135]
    buffer_load_dwordx4 v2, s[12:15], s24 offen offset:3072 lds
    s_add_u32 s25, s25, 65536
    s_and_b32 s25, s25, 2097151
    s_lshr_b32 s27, s25, 5
    s_add_u32 s24, s31, s27
    s_add_u32 m0, s26, 131072
    ds_read_b128 v[72:75], v11 offset:49408
    v_mfma_f32_16x16x32_bf16 v[136:139], v[24:27], v[48:51], v[136:139]
    ds_read_b128 v[76:79], v11 offset:53248
    v_mfma_f32_16x16x32_bf16 v[140:143], v[28:31], v[48:51], v[140:143]
    ds_read_b128 v[80:83], v11 offset:53504
    v_mfma_f32_16x16x32_bf16 v[144:147], v[32:35], v[48:51], v[144:147]
    s_waitcnt lgkmcnt(9)
    v_mfma_f32_16x16x32_bf16 v[84:87], v[52:55], v[68:71], v[84:87]
    buffer_load_dwordx4 v3, s[8:11], s25 offen lds
    s_waitcnt lgkmcnt(7)
    v_mfma_f32_16x16x32_bf16 v[88:91], v[56:59], v[68:71], v[88:91]
    s_waitcnt lgkmcnt(5)
    v_mfma_f32_16x16x32_bf16 v[92:95], v[60:63], v[68:71], v[92:95]
    s_waitcnt lgkmcnt(0)
    s_waitcnt vmcnt(13)
    s_barrier
    v_mfma_f32_16x16x32_bf16 v[96:99], v[64:67], v[68:71], v[96:99]
    ds_read_b128 v[36:39], v12 offset:0
    v_mfma_f32_16x16x32_bf16 v[100:103], v[52:55], v[72:75], v[100:103]
    buffer_load_dwordx4 v4, s[8:11], s25 offen offset:1024 lds
    ds_read_b64_tr_b16 v[20:21], v7 offset:0
    v_mfma_f32_16x16x32_bf16 v[104:107], v[56:59], v[72:75], v[104:107]
    ds_read_b64_tr_b16 v[22:23], v7 offset:1024
    v_mfma_f32_16x16x32_bf16 v[108:111], v[60:63], v[72:75], v[108:111]
    ds_read_b64_tr_b16 v[24:25], v8 offset:0
    v_mfma_f32_16x16x32_bf16 v[112:115], v[64:67], v[72:75], v[112:115]
    ds_read_b64_tr_b16 v[26:27], v8 offset:1024
    v_mfma_f32_16x16x32_bf16 v[116:119], v[52:55], v[76:79], v[116:119]
    buffer_load_dwordx4 v2, s[12:15], s24 offen offset:2048 lds
    ds_read_b64_tr_b16 v[28:29], v7 offset:256
    v_mfma_f32_16x16x32_bf16 v[120:123], v[56:59], v[76:79], v[120:123]
    ds_read_b64_tr_b16 v[30:31], v7 offset:1280
    v_mfma_f32_16x16x32_bf16 v[124:127], v[60:63], v[76:79], v[124:127]
    ds_read_b64_tr_b16 v[32:33], v8 offset:256
    v_mfma_f32_16x16x32_bf16 v[128:131], v[64:67], v[76:79], v[128:131]
    ds_read_b64_tr_b16 v[34:35], v8 offset:1280
    v_mfma_f32_16x16x32_bf16 v[132:135], v[52:55], v[80:83], v[132:135]
    buffer_load_dwordx4 v2, s[12:15], s24 offen offset:3072 lds
    s_add_u32 s25, s25, 65536
    s_and_b32 s25, s25, 2097151
    s_lshr_b32 s27, s25, 5
    s_add_u32 s24, s31, s27
    s_add_u32 m0, s26, 147456
    ds_read_b128 v[40:43], v12 offset:256
    v_mfma_f32_16x16x32_bf16 v[136:139], v[56:59], v[80:83], v[136:139]
    ds_read_b128 v[44:47], v12 offset:4096
    v_mfma_f32_16x16x32_bf16 v[140:143], v[60:63], v[80:83], v[140:143]
    ds_read_b128 v[48:51], v12 offset:4352
    v_mfma_f32_16x16x32_bf16 v[144:147], v[64:67], v[80:83], v[144:147]
    s_waitcnt lgkmcnt(9)
    v_mfma_f32_16x16x32_bf16 v[84:87], v[20:23], v[36:39], v[84:87]
    buffer_load_dwordx4 v3, s[8:11], s25 offen lds
    s_waitcnt lgkmcnt(7)
    v_mfma_f32_16x16x32_bf16 v[88:91], v[24:27], v[36:39], v[88:91]
    s_waitcnt lgkmcnt(5)
    v_mfma_f32_16x16x32_bf16 v[92:95], v[28:31], v[36:39], v[92:95]
    s_waitcnt lgkmcnt(0)
    s_waitcnt vmcnt(13)
    s_barrier
    v_mfma_f32_16x16x32_bf16 v[96:99], v[32:35], v[36:39], v[96:99]
    ds_read_b128 v[68:71], v12 offset:16384
    v_mfma_f32_16x16x32_bf16 v[100:103], v[20:23], v[40:43], v[100:103]
    buffer_load_dwordx4 v4, s[8:11], s25 offen offset:1024 lds
    ds_read_b64_tr_b16 v[52:53], v7 offset:16384
    v_mfma_f32_16x16x32_bf16 v[104:107], v[24:27], v[40:43], v[104:107]
    ds_read_b64_tr_b16 v[54:55], v7 offset:17408
    v_mfma_f32_16x16x32_bf16 v[108:111], v[28:31], v[40:43], v[108:111]
    ds_read_b64_tr_b16 v[56:57], v8 offset:16384
    v_mfma_f32_16x16x32_bf16 v[112:115], v[32:35], v[40:43], v[112:115]
    ds_read_b64_tr_b16 v[58:59], v8 offset:17408
    v_mfma_f32_16x16x32_bf16 v[116:119], v[20:23], v[44:47], v[116:119]
    buffer_load_dwordx4 v2, s[12:15], s24 offen offset:2048 lds
    ds_read_b64_tr_b16 v[60:61], v7 offset:16640
    v_mfma_f32_16x16x32_bf16 v[120:123], v[24:27], v[44:47], v[120:123]
    ds_read_b64_tr_b16 v[62:63], v7 offset:17664
    v_mfma_f32_16x16x32_bf16 v[124:127], v[28:31], v[44:47], v[124:127]
    ds_read_b64_tr_b16 v[64:65], v8 offset:16640
    v_mfma_f32_16x16x32_bf16 v[128:131], v[32:35], v[44:47], v[128:131]
    ds_read_b64_tr_b16 v[66:67], v8 offset:17664
    v_mfma_f32_16x16x32_bf16 v[132:135], v[20:23], v[48:51], v[132:135]
    buffer_load_dwordx4 v2, s[12:15], s24 offen offset:3072 lds
    s_add_u32 s25, s25, 65536
    s_and_b32 s25, s25, 2097151
    s_lshr_b32 s27, s25, 5
    s_add_u32 s24, s31, s27
    s_add_u32 m0, s26, 0
    ds_read_b128 v[72:75], v12 offset:16640
    v_mfma_f32_16x16x32_bf16 v[136:139], v[24:27], v[48:51], v[136:139]
    ds_read_b128 v[76:79], v12 offset:20480
    v_mfma_f32_16x16x32_bf16 v[140:143], v[28:31], v[48:51], v[140:143]
    ds_read_b128 v[80:83], v12 offset:20736
    v_mfma_f32_16x16x32_bf16 v[144:147], v[32:35], v[48:51], v[144:147]
    s_waitcnt lgkmcnt(9)
    v_mfma_f32_16x16x32_bf16 v[84:87], v[52:55], v[68:71], v[84:87]
    buffer_load_dwordx4 v3, s[8:11], s25 offen lds
    s_waitcnt lgkmcnt(7)
    v_mfma_f32_16x16x32_bf16 v[88:91], v[56:59], v[68:71], v[88:91]
    s_waitcnt lgkmcnt(5)
    v_mfma_f32_16x16x32_bf16 v[92:95], v[60:63], v[68:71], v[92:95]
    s_waitcnt lgkmcnt(0)
    s_waitcnt vmcnt(13)
    s_barrier
    v_mfma_f32_16x16x32_bf16 v[96:99], v[64:67], v[68:71], v[96:99]
    ds_read_b128 v[36:39], v12 offset:32768
    v_mfma_f32_16x16x32_bf16 v[100:103], v[52:55], v[72:75], v[100:103]
    buffer_load_dwordx4 v4, s[8:11], s25 offen offset:1024 lds
    ds_read_b64_tr_b16 v[20:21], v7 offset:32768
    v_mfma_f32_16x16x32_bf16 v[104:107], v[56:59], v[72:75], v[104:107]
    ds_read_b64_tr_b16 v[22:23], v7 offset:33792
    v_mfma_f32_16x16x32_bf16 v[108:111], v[60:63], v[72:75], v[108:111]
    ds_read_b64_tr_b16 v[24:25], v8 offset:32768
    v_mfma_f32_16x16x32_bf16 v[112:115], v[64:67], v[72:75], v[112:115]
    ds_read_b64_tr_b16 v[26:27], v8 offset:33792
    v_mfma_f32_16x16x32_bf16 v[116:119], v[52:55], v[76:79], v[116:119]
    buffer_load_dwordx4 v2, s[12:15], s24 offen offset:2048 lds
    ds_read_b64_tr_b16 v[28:29], v7 offset:33024
    v_mfma_f32_16x16x32_bf16 v[120:123], v[56:59], v[76:79], v[120:123]
    ds_read_b64_tr_b16 v[30:31], v7 offset:34048
    v_mfma_f32_16x16x32_bf16 v[124:127], v[60:63], v[76:79], v[124:127]
    ds_read_b64_tr_b16 v[32:33], v8 offset:33024
    v_mfma_f32_16x16x32_bf16 v[128:131], v[64:67], v[76:79], v[128:131]
    ds_read_b64_tr_b16 v[34:35], v8 offset:34048
    v_mfma_f32_16x16x32_bf16 v[132:135], v[52:55], v[80:83], v[132:135]
    buffer_load_dwordx4 v2, s[12:15], s24 offen offset:3072 lds
    s_add_u32 s25, s25, 65536
    s_and_b32 s25, s25, 2097151
    s_lshr_b32 s27, s25, 5
    s_add_u32 s24, s31, s27
    s_add_u32 m0, s26, 16384
    ds_read_b128 v[40:43], v12 offset:33024
    v_mfma_f32_16x16x32_bf16 v[136:139], v[56:59], v[80:83], v[136:139]
    ds_read_b128 v[44:47], v12 offset:36864
    v_mfma_f32_16x16x32_bf16 v[140:143], v[60:63], v[80:83], v[140:143]
    ds_read_b128 v[48:51], v12 offset:37120
    v_mfma_f32_16x16x32_bf16 v[144:147], v[64:67], v[80:83], v[144:147]
    s_waitcnt lgkmcnt(9)
    v_mfma_f32_16x16x32_bf16 v[84:87], v[20:23], v[36:39], v[84:87]
    buffer_load_dwordx4 v3, s[8:11], s25 offen lds
    s_waitcnt lgkmcnt(7)
    v_mfma_f32_16x16x32_bf16 v[88:91], v[24:27], v[36:39], v[88:91]
    s_waitcnt lgkmcnt(5)
    v_mfma_f32_16x16x32_bf16 v[92:95], v[28:31], v[36:39], v[92:95]
    s_waitcnt lgkmcnt(0)
    s_waitcnt vmcnt(13)
    s_barrier
    v_mfma_f32_16x16x32_bf16 v[96:99], v[32:35], v[36:39], v[96:99]
    ds_read_b128 v[68:71], v12 offset:49152
    v_mfma_f32_16x16x32_bf16 v[100:103], v[20:23], v[40:43], v[100:103]
    buffer_load_dwordx4 v4, s[8:11], s25 offen offset:1024 lds
    ds_read_b64_tr_b16 v[52:53], v7 offset:49152
    v_mfma_f32_16x16x32_bf16 v[104:107], v[24:27], v[40:43], v[104:107]
    ds_read_b64_tr_b16 v[54:55], v7 offset:50176
    v_mfma_f32_16x16x32_bf16 v[108:111], v[28:31], v[40:43], v[108:111]
    ds_read_b64_tr_b16 v[56:57], v8 offset:49152
    v_mfma_f32_16x16x32_bf16 v[112:115], v[32:35], v[40:43], v[112:115]
    ds_read_b64_tr_b16 v[58:59], v8 offset:50176
    v_mfma_f32_16x16x32_bf16 v[116:119], v[20:23], v[44:47], v[116:119]
    buffer_load_dwordx4 v2, s[12:15], s24 offen offset:2048 lds
    ds_read_b64_tr_b16 v[60:61], v7 offset:49408
    v_mfma_f32_16x16x32_bf16 v[120:123], v[24:27], v[44:47], v[120:123]
    ds_read_b64_tr_b16 v[62:63], v7 offset:50432
    v_mfma_f32_16x16x32_bf16 v[124:127], v[28:31], v[44:47], v[124:127]
    ds_read_b64_tr_b16 v[64:65], v8 offset:49408
    v_mfma_f32_16x16x32_bf16 v[128:131], v[32:35], v[44:47], v[128:131]
    ds_read_b64_tr_b16 v[66:67], v8 offset:50432
    v_mfma_f32_16x16x32_bf16 v[132:135], v[20:23], v[48:51], v[132:135]
    buffer_load_dwordx4 v2, s[12:15], s24 offen offset:3072 lds
    s_add_u32 s25, s25, 65536
    s_and_b32 s25, s25, 2097151
    s_lshr_b32 s27, s25, 5
    s_add_u32 s24, s31, s27
    s_add_u32 m0, s26, 32768
    ds_read_b128 v[72:75], v12 offset:49408
    v_mfma_f32_16x16x32_bf16 v[136:139], v[24:27], v[48:51], v[136:139]
    ds_read_b128 v[76:79], v12 offset:53248
    v_mfma_f32_16x16x32_bf16 v[140:143], v[28:31], v[48:51], v[140:143]
    ds_read_b128 v[80:83], v12 offset:53504
    v_mfma_f32_16x16x32_bf16 v[144:147], v[32:35], v[48:51], v[144:147]
    s_waitcnt lgkmcnt(9)
    v_mfma_f32_16x16x32_bf16 v[84:87], v[52:55], v[68:71], v[84:87]
    buffer_load_dwordx4 v3, s[8:11], s25 offen lds
    s_waitcnt lgkmcnt(7)
    v_mfma_f32_16x16x32_bf16 v[88:91], v[56:59], v[68:71], v[88:91]
    s_waitcnt lgkmcnt(5)
    v_mfma_f32_16x16x32_bf16 v[92:95], v[60:63], v[68:71], v[92:95]
    s_waitcnt lgkmcnt(0)
    s_waitcnt vmcnt(13)
    s_barrier
    v_mfma_f32_16x16x32_bf16 v[96:99], v[64:67], v[68:71], v[96:99]
    ds_read_b128 v[36:39], v13 offset:0
    v_mfma_f32_16x16x32_bf16 v[100:103], v[52:55], v[72:75], v[100:103]
    buffer_load_dwordx4 v4, s[8:11], s25 offen offset:1024 lds
    ds_read_b64_tr_b16 v[20:21], v9 offset:0
    v_mfma_f32_16x16x32_bf16 v[104:107], v[56:59], v[72:75], v[104:107]
    ds_read_b64_tr_b16 v[22:23], v9 offset:1024
    v_mfma_f32_16x16x32_bf16 v[108:111], v[60:63], v[72:75], v[108:111]
    ds_read_b64_tr_b16 v[24:25], v10 offset:0
    v_mfma_f32_16x16x32_bf16 v[112:115], v[64:67], v[72:75], v[112:115]
    ds_read_b64_tr_b16 v[26:27], v10 offset:1024
    v_mfma_f32_16x16x32_bf16 v[116:119], v[52:55], v[76:79], v[116:119]
    buffer_load_dwordx4 v2, s[12:15], s24 offen offset:2048 lds
    ds_read_b64_tr_b16 v[28:29], v9 offset:256
    v_mfma_f32_16x16x32_bf16 v[120:123], v[56:59], v[76:79], v[120:123]
    ds_read_b64_tr_b16 v[30:31], v9 offset:1280
    v_mfma_f32_16x16x32_bf16 v[124:127], v[60:63], v[76:79], v[124:127]
    ds_read_b64_tr_b16 v[32:33], v10 offset:256
    v_mfma_f32_16x16x32_bf16 v[128:131], v[64:67], v[76:79], v[128:131]
    ds_read_b64_tr_b16 v[34:35], v10 offset:1280
    v_mfma_f32_16x16x32_bf16 v[132:135], v[52:55], v[80:83], v[132:135]
    buffer_load_dwordx4 v2, s[12:15], s24 offen offset:3072 lds
    s_add_u32 s25, s25, 65536
    s_and_b32 s25, s25, 2097151
    s_lshr_b32 s27, s25, 5
    s_add_u32 s24, s31, s27
    s_add_u32 m0, s26, 49152
    ds_read_b128 v[40:43], v13 offset:256
    v_mfma_f32_16x16x32_bf16 v[136:139], v[56:59], v[80:83], v[136:139]
    ds_read_b128 v[44:47], v13 offset:4096
    v_mfma_f32_16x16x32_bf16 v[140:143], v[60:63], v[80:83], v[140:143]
    ds_read_b128 v[48:51], v13 offset:4352
    v_mfma_f32_16x16x32_bf16 v[144:147], v[64:67], v[80:83], v[144:147]
    s_waitcnt lgkmcnt(9)
    v_mfma_f32_16x16x32_bf16 v[84:87], v[20:23], v[36:39], v[84:87]
    buffer_load_dwordx4 v3, s[8:11], s25 offen lds
    s_waitcnt lgkmcnt(7)
    v_mfma_f32_16x16x32_bf16 v[88:91], v[24:27], v[36:39], v[88:91]
    s_waitcnt lgkmcnt(5)
    v_mfma_f32_16x16x32_bf16 v[92:95], v[28:31], v[36:39], v[92:95]
    s_waitcnt lgkmcnt(0)
    s_waitcnt vmcnt(13)
    s_barrier
    v_mfma_f32_16x16x32_bf16 v[96:99], v[32:35], v[36:39], v[96:99]
    ds_read_b128 v[68:71], v13 offset:16384
    v_mfma_f32_16x16x32_bf16 v[100:103], v[20:23], v[40:43], v[100:103]
    buffer_load_dwordx4 v4, s[8:11], s25 offen offset:1024 lds
    ds_read_b64_tr_b16 v[52:53], v9 offset:16384
    v_mfma_f32_16x16x32_bf16 v[104:107], v[24:27], v[40:43], v[104:107]
    ds_read_b64_tr_b16 v[54:55], v9 offset:17408
    v_mfma_f32_16x16x32_bf16 v[108:111], v[28:31], v[40:43], v[108:111]
    ds_read_b64_tr_b16 v[56:57], v10 offset:16384
    v_mfma_f32_16x16x32_bf16 v[112:115], v[32:35], v[40:43], v[112:115]
    ds_read_b64_tr_b16 v[58:59], v10 offset:17408
    v_mfma_f32_16x16x32_bf16 v[116:119], v[20:23], v[44:47], v[116:119]
    buffer_load_dwordx4 v2, s[12:15], s24 offen offset:2048 lds
    ds_read_b64_tr_b16 v[60:61], v9 offset:16640
    v_mfma_f32_16x16x32_bf16 v[120:123], v[24:27], v[44:47], v[120:123]
    ds_read_b64_tr_b16 v[62:63], v9 offset:17664
    v_mfma_f32_16x16x32_bf16 v[124:127], v[28:31], v[44:47], v[124:127]
    ds_read_b64_tr_b16 v[64:65], v10 offset:16640
    v_mfma_f32_16x16x32_bf16 v[128:131], v[32:35], v[44:47], v[128:131]
    ds_read_b64_tr_b16 v[66:67], v10 offset:17664
    v_mfma_f32_16x16x32_bf16 v[132:135], v[20:23], v[48:51], v[132:135]
    buffer_load_dwordx4 v2, s[12:15], s24 offen offset:3072 lds
    s_add_u32 s25, s25, 65536
    s_and_b32 s25, s25, 2097151
    s_lshr_b32 s27, s25, 5
    s_add_u32 s24, s31, s27
    s_add_u32 m0, s26, 65536
    ds_read_b128 v[72:75], v13 offset:16640
    v_mfma_f32_16x16x32_bf16 v[136:139], v[24:27], v[48:51], v[136:139]
    ds_read_b128 v[76:79], v13 offset:20480
    v_mfma_f32_16x16x32_bf16 v[140:143], v[28:31], v[48:51], v[140:143]
    ds_read_b128 v[80:83], v13 offset:20736
    v_mfma_f32_16x16x32_bf16 v[144:147], v[32:35], v[48:51], v[144:147]
    s_waitcnt lgkmcnt(9)
    v_mfma_f32_16x16x32_bf16 v[84:87], v[52:55], v[68:71], v[84:87]
    buffer_load_dwordx4 v3, s[8:11], s25 offen lds
    s_waitcnt lgkmcnt(7)
    v_mfma_f32_16x16x32_bf16 v[88:91], v[56:59], v[68:71], v[88:91]
    s_waitcnt lgkmcnt(5)
    v_mfma_f32_16x16x32_bf16 v[92:95], v[60:63], v[68:71], v[92:95]
    s_waitcnt lgkmcnt(0)
    s_waitcnt vmcnt(13)
    s_barrier
    v_mfma_f32_16x16x32_bf16 v[96:99], v[64:67], v[68:71], v[96:99]
    ds_read_b128 v[36:39], v11 offset:0
    v_mfma_f32_16x16x32_bf16 v[100:103], v[52:55], v[72:75], v[100:103]
    buffer_load_dwordx4 v4, s[8:11], s25 offen offset:1024 lds
    ds_read_b64_tr_b16 v[20:21], v5 offset:0
    v_mfma_f32_16x16x32_bf16 v[104:107], v[56:59], v[72:75], v[104:107]
    ds_read_b64_tr_b16 v[22:23], v5 offset:1024
    v_mfma_f32_16x16x32_bf16 v[108:111], v[60:63], v[72:75], v[108:111]
    ds_read_b64_tr_b16 v[24:25], v6 offset:0
    v_mfma_f32_16x16x32_bf16 v[112:115], v[64:67], v[72:75], v[112:115]
    ds_read_b64_tr_b16 v[26:27], v6 offset:1024
    v_mfma_f32_16x16x32_bf16 v[116:119], v[52:55], v[76:79], v[116:119]
    buffer_load_dwordx4 v2, s[12:15], s24 offen offset:2048 lds
    ds_read_b64_tr_b16 v[28:29], v5 offset:256
    v_mfma_f32_16x16x32_bf16 v[120:123], v[56:59], v[76:79], v[120:123]
    ds_read_b64_tr_b16 v[30:31], v5 offset:1280
    v_mfma_f32_16x16x32_bf16 v[124:127], v[60:63], v[76:79], v[124:127]
    ds_read_b64_tr_b16 v[32:33], v6 offset:256
    v_mfma_f32_16x16x32_bf16 v[128:131], v[64:67], v[76:79], v[128:131]
    ds_read_b64_tr_b16 v[34:35], v6 offset:1280
    v_mfma_f32_16x16x32_bf16 v[132:135], v[52:55], v[80:83], v[132:135]
    buffer_load_dwordx4 v2, s[12:15], s24 offen offset:3072 lds
    s_add_u32 s25, s25, 65536
    s_and_b32 s25, s25, 2097151
    s_lshr_b32 s27, s25, 5
    s_add_u32 s24, s31, s27
    s_add_u32 m0, s26, 81920
    ds_read_b128 v[40:43], v11 offset:256
    v_mfma_f32_16x16x32_bf16 v[136:139], v[56:59], v[80:83], v[136:139]
    ds_read_b128 v[44:47], v11 offset:4096
    v_mfma_f32_16x16x32_bf16 v[140:143], v[60:63], v[80:83], v[140:143]
    ds_read_b128 v[48:51], v11 offset:4352
    v_mfma_f32_16x16x32_bf16 v[144:147], v[64:67], v[80:83], v[144:147]
    s_waitcnt lgkmcnt(9)
    v_mfma_f32_16x16x32_bf16 v[84:87], v[20:23], v[36:39], v[84:87]
    buffer_load_dwordx4 v3, s[8:11], s25 offen lds
    s_waitcnt lgkmcnt(7)
    v_mfma_f32_16x16x32_bf16 v[88:91], v[24:27], v[36:39], v[88:91]
    s_waitcnt lgkmcnt(5)
    v_mfma_f32_16x16x32_bf16 v[92:95], v[28:31], v[36:39], v[92:95]
    s_waitcnt lgkmcnt(0)
    s_waitcnt vmcnt(13)
    s_barrier
    v_mfma_f32_16x16x32_bf16 v[96:99], v[32:35], v[36:39], v[96:99]
    ds_read_b128 v[68:71], v11 offset:16384
    v_mfma_f32_16x16x32_bf16 v[100:103], v[20:23], v[40:43], v[100:103]
    buffer_load_dwordx4 v4, s[8:11], s25 offen offset:1024 lds
    ds_read_b64_tr_b16 v[52:53], v5 offset:16384
    v_mfma_f32_16x16x32_bf16 v[104:107], v[24:27], v[40:43], v[104:107]
    ds_read_b64_tr_b16 v[54:55], v5 offset:17408
    v_mfma_f32_16x16x32_bf16 v[108:111], v[28:31], v[40:43], v[108:111]
    ds_read_b64_tr_b16 v[56:57], v6 offset:16384
    v_mfma_f32_16x16x32_bf16 v[112:115], v[32:35], v[40:43], v[112:115]
    ds_read_b64_tr_b16 v[58:59], v6 offset:17408
    v_mfma_f32_16x16x32_bf16 v[116:119], v[20:23], v[44:47], v[116:119]
    buffer_load_dwordx4 v2, s[12:15], s24 offen offset:2048 lds
    ds_read_b64_tr_b16 v[60:61], v5 offset:16640
    v_mfma_f32_16x16x32_bf16 v[120:123], v[24:27], v[44:47], v[120:123]
    ds_read_b64_tr_b16 v[62:63], v5 offset:17664
    v_mfma_f32_16x16x32_bf16 v[124:127], v[28:31], v[44:47], v[124:127]
    ds_read_b64_tr_b16 v[64:65], v6 offset:16640
    v_mfma_f32_16x16x32_bf16 v[128:131], v[32:35], v[44:47], v[128:131]
    ds_read_b64_tr_b16 v[66:67], v6 offset:17664
    v_mfma_f32_16x16x32_bf16 v[132:135], v[20:23], v[48:51], v[132:135]
    buffer_load_dwordx4 v2, s[12:15], s24 offen offset:3072 lds
    s_add_u32 s25, s25, 65536
    s_and_b32 s25, s25, 2097151
    s_lshr_b32 s27, s25, 5
    s_add_u32 s24, s31, s27
    s_add_u32 m0, s26, 98304
    ds_read_b128 v[72:75], v11 offset:16640
    v_mfma_f32_16x16x32_bf16 v[136:139], v[24:27], v[48:51], v[136:139]
    ds_read_b128 v[76:79], v11 offset:20480
    v_mfma_f32_16x16x32_bf16 v[140:143], v[28:31], v[48:51], v[140:143]
    ds_read_b128 v[80:83], v11 offset:20736
    v_mfma_f32_16x16x32_bf16 v[144:147], v[32:35], v[48:51], v[144:147]
    s_waitcnt lgkmcnt(9)
    v_mfma_f32_16x16x32_bf16 v[84:87], v[52:55], v[68:71], v[84:87]
    buffer_load_dwordx4 v3, s[8:11], s25 offen lds
    s_waitcnt lgkmcnt(7)
    v_mfma_f32_16x16x32_bf16 v[88:91], v[56:59], v[68:71], v[88:91]
    s_waitcnt lgkmcnt(5)
    v_mfma_f32_16x16x32_bf16 v[92:95], v[60:63], v[68:71], v[92:95]
    s_waitcnt lgkmcnt(0)
    s_waitcnt vmcnt(13)
    s_barrier
    v_mfma_f32_16x16x32_bf16 v[96:99], v[64:67], v[68:71], v[96:99]
    ds_read_b128 v[36:39], v11 offset:32768
    v_mfma_f32_16x16x32_bf16 v[100:103], v[52:55], v[72:75], v[100:103]
    buffer_load_dwordx4 v4, s[8:11], s25 offen offset:1024 lds
    ds_read_b64_tr_b16 v[20:21], v5 offset:32768
    v_mfma_f32_16x16x32_bf16 v[104:107], v[56:59], v[72:75], v[104:107]
    ds_read_b64_tr_b16 v[22:23], v5 offset:33792
    v_mfma_f32_16x16x32_bf16 v[108:111], v[60:63], v[72:75], v[108:111]
    ds_read_b64_tr_b16 v[24:25], v6 offset:32768
    v_mfma_f32_16x16x32_bf16 v[112:115], v[64:67], v[72:75], v[112:115]
    ds_read_b64_tr_b16 v[26:27], v6 offset:33792
    v_mfma_f32_16x16x32_bf16 v[116:119], v[52:55], v[76:79], v[116:119]
    buffer_load_dwordx4 v2, s[12:15], s24 offen offset:2048 lds
    ds_read_b64_tr_b16 v[28:29], v5 offset:33024
    v_mfma_f32_16x16x32_bf16 v[120:123], v[56:59], v[76:79], v[120:123]
    ds_read_b64_tr_b16 v[30:31], v5 offset:34048
    v_mfma_f32_16x16x32_bf16 v[124:127], v[60:63], v[76:79], v[124:127]
    ds_read_b64_tr_b16 v[32:33], v6 offset:33024
    v_mfma_f32_16x16x32_bf16 v[128:131], v[64:67], v[76:79], v[128:131]
    ds_read_b64_tr_b16 v[34:35], v6 offset:34048
    v_mfma_f32_16x16x32_bf16 v[132:135], v[52:55], v[80:83], v[132:135]
    buffer_load_dwordx4 v2, s[12:15], s24 offen offset:3072 lds
    s_add_u32 s25, s25, 65536
    s_and_b32 s25, s25, 2097151
    s_lshr_b32 s27, s25, 5
    s_add_u32 s24, s31, s27
    s_add_u32 m0, s26, 114688
    ds_read_b128 v[40:43], v11 offset:33024
    v_mfma_f32_16x16x32_bf16 v[136:139], v[56:59], v[80:83], v[136:139]
    ds_read_b128 v[44:47], v11 offset:36864
    v_mfma_f32_16x16x32_bf16 v[140:143], v[60:63], v[80:83], v[140:143]
    ds_read_b128 v[48:51], v11 offset:37120
    v_mfma_f32_16x16x32_bf16 v[144:147], v[64:67], v[80:83], v[144:147]
    s_waitcnt lgkmcnt(9)
    v_mfma_f32_16x16x32_bf16 v[84:87], v[20:23], v[36:39], v[84:87]
    buffer_load_dwordx4 v3, s[8:11], s25 offen lds
    s_waitcnt lgkmcnt(7)
    v_mfma_f32_16x16x32_bf16 v[88:91], v[24:27], v[36:39], v[88:91]
    s_waitcnt lgkmcnt(5)
    v_mfma_f32_16x16x32_bf16 v[92:95], v[28:31], v[36:39], v[92:95]
    s_waitcnt lgkmcnt(0)
    s_waitcnt vmcnt(13)
    s_barrier
    v_mfma_f32_16x16x32_bf16 v[96:99], v[32:35], v[36:39], v[96:99]
    ds_read_b128 v[68:71], v11 offset:49152
    v_mfma_f32_16x16x32_bf16 v[100:103], v[20:23], v[40:43], v[100:103]
    buffer_load_dwordx4 v4, s[8:11], s25 offen offset:1024 lds
    ds_read_b64_tr_b16 v[52:53], v5 offset:49152
    v_mfma_f32_16x16x32_bf16 v[104:107], v[24:27], v[40:43], v[104:107]
    ds_read_b64_tr_b16 v[54:55], v5 offset:50176
    v_mfma_f32_16x16x32_bf16 v[108:111], v[28:31], v[40:43], v[108:111]
    ds_read_b64_tr_b16 v[56:57], v6 offset:49152
    v_mfma_f32_16x16x32_bf16 v[112:115], v[32:35], v[40:43], v[112:115]
    ds_read_b64_tr_b16 v[58:59], v6 offset:50176
    v_mfma_f32_16x16x32_bf16 v[116:119], v[20:23], v[44:47], v[116:119]
    buffer_load_dwordx4 v2, s[12:15], s24 offen offset:2048 lds
    ds_read_b64_tr_b16 v[60:61], v5 offset:49408
    v_mfma_f32_16x16x32_bf16 v[120:123], v[24:27], v[44:47], v[120:123]
    ds_read_b64_tr_b16 v[62:63], v5 offset:50432
    v_mfma_f32_16x16x32_bf16 v[124:127], v[28:31], v[44:47], v[124:127]
    ds_read_b64_tr_b16 v[64:65], v6 offset:49408
    v_mfma_f32_16x16x32_bf16 v[128:131], v[32:35], v[44:47], v[128:131]
    ds_read_b64_tr_b16 v[66:67], v6 offset:50432
    v_mfma_f32_16x16x32_bf16 v[132:135], v[20:23], v[48:51], v[132:135]
    buffer_load_dwordx4 v2, s[12:15], s24 offen offset:3072 lds
    s_add_u32 s25, s25, 65536
    s_and_b32 s25, s25, 2097151
    s_lshr_b32 s27, s25, 5
    s_add_u32 s24, s31, s27
    s_add_u32 m0, s26, 131072
    ds_read_b128 v[72:75], v11 offset:49408
    v_mfma_f32_16x16x32_bf16 v[136:139], v[24:27], v[48:51], v[136:139]
    ds_read_b128 v[76:79], v11 offset:53248
    v_mfma_f32_16x16x32_bf16 v[140:143], v[28:31], v[48:51], v[140:143]
    ds_read_b128 v[80:83], v11 offset:53504
    v_mfma_f32_16x16x32_bf16 v[144:147], v[32:35], v[48:51], v[144:147]
    s_waitcnt lgkmcnt(9)
    v_mfma_f32_16x16x32_bf16 v[84:87], v[52:55], v[68:71], v[84:87]
    buffer_load_dwordx4 v3, s[8:11], s25 offen lds
    s_waitcnt lgkmcnt(7)
    v_mfma_f32_16x16x32_bf16 v[88:91], v[56:59], v[68:71], v[88:91]
    s_waitcnt lgkmcnt(5)
    v_mfma_f32_16x16x32_bf16 v[92:95], v[60:63], v[68:71], v[92:95]
    s_waitcnt lgkmcnt(0)
    s_waitcnt vmcnt(13)
    s_barrier
    v_mfma_f32_16x16x32_bf16 v[96:99], v[64:67], v[68:71], v[96:99]
    ds_read_b128 v[36:39], v12 offset:0
    v_mfma_f32_16x16x32_bf16 v[100:103], v[52:55], v[72:75], v[100:103]
    buffer_load_dwordx4 v4, s[8:11], s25 offen offset:1024 lds
    ds_read_b64_tr_b16 v[20:21], v7 offset:0
    v_mfma_f32_16x16x32_bf16 v[104:107], v[56:59], v[72:75], v[104:107]
    ds_read_b64_tr_b16 v[22:23], v7 offset:1024
    v_mfma_f32_16x16x32_bf16 v[108:111], v[60:63], v[72:75], v[108:111]
    ds_read_b64_tr_b16 v[24:25], v8 offset:0
    v_mfma_f32_16x16x32_bf16 v[112:115], v[64:67], v[72:75], v[112:115]
    ds_read_b64_tr_b16 v[26:27], v8 offset:1024
    v_mfma_f32_16x16x32_bf16 v[116:119], v[52:55], v[76:79], v[116:119]
    buffer_load_dwordx4 v2, s[12:15], s24 offen offset:2048 lds
    ds_read_b64_tr_b16 v[28:29], v7 offset:256
    v_mfma_f32_16x16x32_bf16 v[120:123], v[56:59], v[76:79], v[120:123]
    ds_read_b64_tr_b16 v[30:31], v7 offset:1280
    v_mfma_f32_16x16x32_bf16 v[124:127], v[60:63], v[76:79], v[124:127]
    ds_read_b64_tr_b16 v[32:33], v8 offset:256
    v_mfma_f32_16x16x32_bf16 v[128:131], v[64:67], v[76:79], v[128:131]
    ds_read_b64_tr_b16 v[34:35], v8 offset:1280
    v_mfma_f32_16x16x32_bf16 v[132:135], v[52:55], v[80:83], v[132:135]
    buffer_load_dwordx4 v2, s[12:15], s24 offen offset:3072 lds
    s_add_u32 s25, s25, 65536
    s_and_b32 s25, s25, 2097151
    s_lshr_b32 s27, s25, 5
    s_add_u32 s24, s31, s27
    s_add_u32 m0, s26, 147456
    ds_read_b128 v[40:43], v12 offset:256
    v_mfma_f32_16x16x32_bf16 v[136:139], v[56:59], v[80:83], v[136:139]
    ds_read_b128 v[44:47], v12 offset:4096
    v_mfma_f32_16x16x32_bf16 v[140:143], v[60:63], v[80:83], v[140:143]
    ds_read_b128 v[48:51], v12 offset:4352
    v_mfma_f32_16x16x32_bf16 v[144:147], v[64:67], v[80:83], v[144:147]
    s_waitcnt lgkmcnt(9)
    v_mfma_f32_16x16x32_bf16 v[84:87], v[20:23], v[36:39], v[84:87]
    buffer_load_dwordx4 v3, s[8:11], s25 offen lds
    s_waitcnt lgkmcnt(7)
    v_mfma_f32_16x16x32_bf16 v[88:91], v[24:27], v[36:39], v[88:91]
    s_waitcnt lgkmcnt(5)
    v_mfma_f32_16x16x32_bf16 v[92:95], v[28:31], v[36:39], v[92:95]
    s_waitcnt lgkmcnt(0)
    s_waitcnt vmcnt(13)
    s_barrier
    v_mfma_f32_16x16x32_bf16 v[96:99], v[32:35], v[36:39], v[96:99]
    ds_read_b128 v[68:71], v12 offset:16384
    v_mfma_f32_16x16x32_bf16 v[100:103], v[20:23], v[40:43], v[100:103]
    buffer_load_dwordx4 v4, s[8:11], s25 offen offset:1024 lds
    ds_read_b64_tr_b16 v[52:53], v7 offset:16384
    v_mfma_f32_16x16x32_bf16 v[104:107], v[24:27], v[40:43], v[104:107]
    ds_read_b64_tr_b16 v[54:55], v7 offset:17408
    v_mfma_f32_16x16x32_bf16 v[108:111], v[28:31], v[40:43], v[108:111]
    ds_read_b64_tr_b16 v[56:57], v8 offset:16384
    v_mfma_f32_16x16x32_bf16 v[112:115], v[32:35], v[40:43], v[112:115]
    ds_read_b64_tr_b16 v[58:59], v8 offset:17408
    v_mfma_f32_16x16x32_bf16 v[116:119], v[20:23], v[44:47], v[116:119]
    buffer_load_dwordx4 v2, s[12:15], s24 offen offset:2048 lds
    ds_read_b64_tr_b16 v[60:61], v7 offset:16640
    v_mfma_f32_16x16x32_bf16 v[120:123], v[24:27], v[44:47], v[120:123]
    ds_read_b64_tr_b16 v[62:63], v7 offset:17664
    v_mfma_f32_16x16x32_bf16 v[124:127], v[28:31], v[44:47], v[124:127]
    ds_read_b64_tr_b16 v[64:65], v8 offset:16640
    v_mfma_f32_16x16x32_bf16 v[128:131], v[32:35], v[44:47], v[128:131]
    ds_read_b64_tr_b16 v[66:67], v8 offset:17664
    v_mfma_f32_16x16x32_bf16 v[132:135], v[20:23], v[48:51], v[132:135]
    buffer_load_dwordx4 v2, s[12:15], s24 offen offset:3072 lds
    s_add_u32 s25, s25, 65536
    s_and_b32 s25, s25, 2097151
    s_lshr_b32 s27, s25, 5
    s_add_u32 s24, s31, s27
    s_add_u32 m0, s26, 0
    ds_read_b128 v[72:75], v12 offset:16640
    v_mfma_f32_16x16x32_bf16 v[136:139], v[24:27], v[48:51], v[136:139]
    ds_read_b128 v[76:79], v12 offset:20480
    v_mfma_f32_16x16x32_bf16 v[140:143], v[28:31], v[48:51], v[140:143]
    ds_read_b128 v[80:83], v12 offset:20736
    v_mfma_f32_16x16x32_bf16 v[144:147], v[32:35], v[48:51], v[144:147]
    s_waitcnt lgkmcnt(9)
    v_mfma_f32_16x16x32_bf16 v[84:87], v[52:55], v[68:71], v[84:87]
    buffer_load_dwordx4 v3, s[8:11], s25 offen lds
    s_waitcnt lgkmcnt(7)
    v_mfma_f32_16x16x32_bf16 v[88:91], v[56:59], v[68:71], v[88:91]
    s_waitcnt lgkmcnt(5)
    v_mfma_f32_16x16x32_bf16 v[92:95], v[60:63], v[68:71], v[92:95]
    s_waitcnt lgkmcnt(0)
    s_waitcnt vmcnt(13)
    s_barrier
    v_mfma_f32_16x16x32_bf16 v[96:99], v[64:67], v[68:71], v[96:99]
    ds_read_b128 v[36:39], v12 offset:32768
    v_mfma_f32_16x16x32_bf16 v[100:103], v[52:55], v[72:75], v[100:103]
    buffer_load_dwordx4 v4, s[8:11], s25 offen offset:1024 lds
    ds_read_b64_tr_b16 v[20:21], v7 offset:32768
    v_mfma_f32_16x16x32_bf16 v[104:107], v[56:59], v[72:75], v[104:107]
    ds_read_b64_tr_b16 v[22:23], v7 offset:33792
    v_mfma_f32_16x16x32_bf16 v[108:111], v[60:63], v[72:75], v[108:111]
    ds_read_b64_tr_b16 v[24:25], v8 offset:32768
    v_mfma_f32_16x16x32_bf16 v[112:115], v[64:67], v[72:75], v[112:115]
    ds_read_b64_tr_b16 v[26:27], v8 offset:33792
    v_mfma_f32_16x16x32_bf16 v[116:119], v[52:55], v[76:79], v[116:119]
    buffer_load_dwordx4 v2, s[12:15], s24 offen offset:2048 lds
    ds_read_b64_tr_b16 v[28:29], v7 offset:33024
    v_mfma_f32_16x16x32_bf16 v[120:123], v[56:59], v[76:79], v[120:123]
    ds_read_b64_tr_b16 v[30:31], v7 offset:34048
    v_mfma_f32_16x16x32_bf16 v[124:127], v[60:63], v[76:79], v[124:127]
    ds_read_b64_tr_b16 v[32:33], v8 offset:33024
    v_mfma_f32_16x16x32_bf16 v[128:131], v[64:67], v[76:79], v[128:131]
    ds_read_b64_tr_b16 v[34:35], v8 offset:34048
    v_mfma_f32_16x16x32_bf16 v[132:135], v[52:55], v[80:83], v[132:135]
    buffer_load_dwordx4 v2, s[12:15], s24 offen offset:3072 lds
    s_add_u32 s25, s25, 65536
    s_and_b32 s25, s25, 2097151
    s_lshr_b32 s27, s25, 5
    s_add_u32 s24, s31, s27
    s_add_u32 m0, s26, 16384
    ds_read_b128 v[40:43], v12 offset:33024
    v_mfma_f32_16x16x32_bf16 v[136:139], v[56:59], v[80:83], v[136:139]
    ds_read_b128 v[44:47], v12 offset:36864
    v_mfma_f32_16x16x32_bf16 v[140:143], v[60:63], v[80:83], v[140:143]
    ds_read_b128 v[48:51], v12 offset:37120
    v_mfma_f32_16x16x32_bf16 v[144:147], v[64:67], v[80:83], v[144:147]
    s_waitcnt lgkmcnt(9)
    v_mfma_f32_16x16x32_bf16 v[84:87], v[20:23], v[36:39], v[84:87]
    buffer_load_dwordx4 v3, s[8:11], s25 offen lds
    s_waitcnt lgkmcnt(7)
    v_mfma_f32_16x16x32_bf16 v[88:91], v[24:27], v[36:39], v[88:91]
    s_waitcnt lgkmcnt(5)
    v_mfma_f32_16x16x32_bf16 v[92:95], v[28:31], v[36:39], v[92:95]
    s_waitcnt lgkmcnt(0)
    s_waitcnt vmcnt(13)
    s_barrier
    v_mfma_f32_16x16x32_bf16 v[96:99], v[32:35], v[36:39], v[96:99]
    ds_read_b128 v[68:71], v12 offset:49152
    v_mfma_f32_16x16x32_bf16 v[100:103], v[20:23], v[40:43], v[100:103]
    buffer_load_dwordx4 v4, s[8:11], s25 offen offset:1024 lds
    ds_read_b64_tr_b16 v[52:53], v7 offset:49152
    v_mfma_f32_16x16x32_bf16 v[104:107], v[24:27], v[40:43], v[104:107]
    ds_read_b64_tr_b16 v[54:55], v7 offset:50176
    v_mfma_f32_16x16x32_bf16 v[108:111], v[28:31], v[40:43], v[108:111]
    ds_read_b64_tr_b16 v[56:57], v8 offset:49152
    v_mfma_f32_16x16x32_bf16 v[112:115], v[32:35], v[40:43], v[112:115]
    ds_read_b64_tr_b16 v[58:59], v8 offset:50176
    v_mfma_f32_16x16x32_bf16 v[116:119], v[20:23], v[44:47], v[116:119]
    buffer_load_dwordx4 v2, s[12:15], s24 offen offset:2048 lds
    ds_read_b64_tr_b16 v[60:61], v7 offset:49408
    v_mfma_f32_16x16x32_bf16 v[120:123], v[24:27], v[44:47], v[120:123]
    ds_read_b64_tr_b16 v[62:63], v7 offset:50432
    v_mfma_f32_16x16x32_bf16 v[124:127], v[28:31], v[44:47], v[124:127]
    ds_read_b64_tr_b16 v[64:65], v8 offset:49408
    v_mfma_f32_16x16x32_bf16 v[128:131], v[32:35], v[44:47], v[128:131]
    ds_read_b64_tr_b16 v[66:67], v8 offset:50432
    v_mfma_f32_16x16x32_bf16 v[132:135], v[20:23], v[48:51], v[132:135]
    buffer_load_dwordx4 v2, s[12:15], s24 offen offset:3072 lds
    s_add_u32 s25, s25, 65536
    s_and_b32 s25, s25, 2097151
    s_lshr_b32 s27, s25, 5
    s_add_u32 s24, s31, s27
    s_add_u32 m0, s26, 32768
    ds_read_b128 v[72:75], v12 offset:49408
    v_mfma_f32_16x16x32_bf16 v[136:139], v[24:27], v[48:51], v[136:139]
    ds_read_b128 v[76:79], v12 offset:53248
    v_mfma_f32_16x16x32_bf16 v[140:143], v[28:31], v[48:51], v[140:143]
    ds_read_b128 v[80:83], v12 offset:53504
    v_mfma_f32_16x16x32_bf16 v[144:147], v[32:35], v[48:51], v[144:147]
    s_waitcnt lgkmcnt(9)
    v_mfma_f32_16x16x32_bf16 v[84:87], v[52:55], v[68:71], v[84:87]
    s_waitcnt lgkmcnt(7)
    v_mfma_f32_16x16x32_bf16 v[88:91], v[56:59], v[68:71], v[88:91]
    s_waitcnt lgkmcnt(5)
    v_mfma_f32_16x16x32_bf16 v[92:95], v[60:63], v[68:71], v[92:95]
    s_waitcnt lgkmcnt(0)
    s_waitcnt vmcnt(12)
    s_barrier
    v_mfma_f32_16x16x32_bf16 v[96:99], v[64:67], v[68:71], v[96:99]
    ds_read_b128 v[36:39], v13 offset:0
    v_mfma_f32_16x16x32_bf16 v[100:103], v[52:55], v[72:75], v[100:103]
    ds_read_b64_tr_b16 v[20:21], v9 offset:0
    v_mfma_f32_16x16x32_bf16 v[104:107], v[56:59], v[72:75], v[104:107]
    ds_read_b64_tr_b16 v[22:23], v9 offset:1024
    v_mfma_f32_16x16x32_bf16 v[108:111], v[60:63], v[72:75], v[108:111]
    ds_read_b64_tr_b16 v[24:25], v10 offset:0
    v_mfma_f32_16x16x32_bf16 v[112:115], v[64:67], v[72:75], v[112:115]
    ds_read_b64_tr_b16 v[26:27], v10 offset:1024
    v_mfma_f32_16x16x32_bf16 v[116:119], v[52:55], v[76:79], v[116:119]
    ds_read_b64_tr_b16 v[28:29], v9 offset:256
    v_mfma_f32_16x16x32_bf16 v[120:123], v[56:59], v[76:79], v[120:123]
    ds_read_b64_tr_b16 v[30:31], v9 offset:1280
    v_mfma_f32_16x16x32_bf16 v[124:127], v[60:63], v[76:79], v[124:127]
    ds_read_b64_tr_b16 v[32:33], v10 offset:256
    v_mfma_f32_16x16x32_bf16 v[128:131], v[64:67], v[76:79], v[128:131]
    ds_read_b64_tr_b16 v[34:35], v10 offset:1280
    v_mfma_f32_16x16x32_bf16 v[132:135], v[52:55], v[80:83], v[132:135]
    ds_read_b128 v[40:43], v13 offset:256
    v_mfma_f32_16x16x32_bf16 v[136:139], v[56:59], v[80:83], v[136:139]
    ds_read_b128 v[44:47], v13 offset:4096
    v_mfma_f32_16x16x32_bf16 v[140:143], v[60:63], v[80:83], v[140:143]
    ds_read_b128 v[48:51], v13 offset:4352
    v_mfma_f32_16x16x32_bf16 v[144:147], v[64:67], v[80:83], v[144:147]
    s_waitcnt lgkmcnt(9)
    v_mfma_f32_16x16x32_bf16 v[84:87], v[20:23], v[36:39], v[84:87]
    s_waitcnt lgkmcnt(7)
    v_mfma_f32_16x16x32_bf16 v[88:91], v[24:27], v[36:39], v[88:91]
    s_waitcnt lgkmcnt(5)
    v_mfma_f32_16x16x32_bf16 v[92:95], v[28:31], v[36:39], v[92:95]
    s_waitcnt lgkmcnt(0)
    s_waitcnt vmcnt(8)
    s_barrier
    v_mfma_f32_16x16x32_bf16 v[96:99], v[32:35], v[36:39], v[96:99]
    ds_read_b128 v[68:71], v13 offset:16384
    v_mfma_f32_16x16x32_bf16 v[100:103], v[20:23], v[40:43], v[100:103]
    ds_read_b64_tr_b16 v[52:53], v9 offset:16384
    v_mfma_f32_16x16x32_bf16 v[104:107], v[24:27], v[40:43], v[104:107]
    ds_read_b64_tr_b16 v[54:55], v9 offset:17408
    v_mfma_f32_16x16x32_bf16 v[108:111], v[28:31], v[40:43], v[108:111]
    ds_read_b64_tr_b16 v[56:57], v10 offset:16384
    v_mfma_f32_16x16x32_bf16 v[112:115], v[32:35], v[40:43], v[112:115]
    ds_read_b64_tr_b16 v[58:59], v10 offset:17408
    v_mfma_f32_16x16x32_bf16 v[116:119], v[20:23], v[44:47], v[116:119]
    ds_read_b64_tr_b16 v[60:61], v9 offset:16640
    v_mfma_f32_16x16x32_bf16 v[120:123], v[24:27], v[44:47], v[120:123]
    ds_read_b64_tr_b16 v[62:63], v9 offset:17664
    v_mfma_f32_16x16x32_bf16 v[124:127], v[28:31], v[44:47], v[124:127]
    ds_read_b64_tr_b16 v[64:65], v10 offset:16640
    v_mfma_f32_16x16x32_bf16 v[128:131], v[32:35], v[44:47], v[128:131]
    ds_read_b64_tr_b16 v[66:67], v10 offset:17664
    v_mfma_f32_16x16x32_bf16 v[132:135], v[20:23], v[48:51], v[132:135]
    ds_read_b128 v[72:75], v13 offset:16640
    v_mfma_f32_16x16x32_bf16 v[136:139], v[24:27], v[48:51], v[136:139]
    ds_read_b128 v[76:79], v13 offset:20480
    v_mfma_f32_16x16x32_bf16 v[140:143], v[28:31], v[48:51], v[140:143]
    ds_read_b128 v[80:83], v13 offset:20736
    v_mfma_f32_16x16x32_bf16 v[144:147], v[32:35], v[48:51], v[144:147]
    s_waitcnt lgkmcnt(9)
    v_mfma_f32_16x16x32_bf16 v[84:87], v[52:55], v[68:71], v[84:87]
    s_waitcnt lgkmcnt(7)
    v_mfma_f32_16x16x32_bf16 v[88:91], v[56:59], v[68:71], v[88:91]
    s_waitcnt lgkmcnt(5)
    v_mfma_f32_16x16x32_bf16 v[92:95], v[60:63], v[68:71], v[92:95]
    s_waitcnt lgkmcnt(0)
    s_waitcnt vmcnt(4)
    s_barrier
    v_mfma_f32_16x16x32_bf16 v[96:99], v[64:67], v[68:71], v[96:99]
    ds_read_b128 v[36:39], v11 offset:0
    v_mfma_f32_16x16x32_bf16 v[100:103], v[52:55], v[72:75], v[100:103]
    ds_read_b64_tr_b16 v[20:21], v5 offset:0
    v_mfma_f32_16x16x32_bf16 v[104:107], v[56:59], v[72:75], v[104:107]
    ds_read_b64_tr_b16 v[22:23], v5 offset:1024
    v_mfma_f32_16x16x32_bf16 v[108:111], v[60:63], v[72:75], v[108:111]
    ds_read_b64_tr_b16 v[24:25], v6 offset:0
    v_mfma_f32_16x16x32_bf16 v[112:115], v[64:67], v[72:75], v[112:115]
    ds_read_b64_tr_b16 v[26:27], v6 offset:1024
    v_mfma_f32_16x16x32_bf16 v[116:119], v[52:55], v[76:79], v[116:119]
    ds_read_b64_tr_b16 v[28:29], v5 offset:256
    v_mfma_f32_16x16x32_bf16 v[120:123], v[56:59], v[76:79], v[120:123]
    ds_read_b64_tr_b16 v[30:31], v5 offset:1280
    v_mfma_f32_16x16x32_bf16 v[124:127], v[60:63], v[76:79], v[124:127]
    ds_read_b64_tr_b16 v[32:33], v6 offset:256
    v_mfma_f32_16x16x32_bf16 v[128:131], v[64:67], v[76:79], v[128:131]
    ds_read_b64_tr_b16 v[34:35], v6 offset:1280
    v_mfma_f32_16x16x32_bf16 v[132:135], v[52:55], v[80:83], v[132:135]
    ds_read_b128 v[40:43], v11 offset:256
    v_mfma_f32_16x16x32_bf16 v[136:139], v[56:59], v[80:83], v[136:139]
    ds_read_b128 v[44:47], v11 offset:4096
    v_mfma_f32_16x16x32_bf16 v[140:143], v[60:63], v[80:83], v[140:143]
    ds_read_b128 v[48:51], v11 offset:4352
    v_mfma_f32_16x16x32_bf16 v[144:147], v[64:67], v[80:83], v[144:147]
    s_waitcnt lgkmcnt(9)
    v_mfma_f32_16x16x32_bf16 v[84:87], v[20:23], v[36:39], v[84:87]
    s_waitcnt lgkmcnt(7)
    v_mfma_f32_16x16x32_bf16 v[88:91], v[24:27], v[36:39], v[88:91]
    s_waitcnt lgkmcnt(5)
    v_mfma_f32_16x16x32_bf16 v[92:95], v[28:31], v[36:39], v[92:95]
    s_waitcnt lgkmcnt(0)
    s_waitcnt vmcnt(0)
    s_barrier
    v_mfma_f32_16x16x32_bf16 v[96:99], v[32:35], v[36:39], v[96:99]
    ds_read_b128 v[68:71], v11 offset:16384
    v_mfma_f32_16x16x32_bf16 v[100:103], v[20:23], v[40:43], v[100:103]
    ds_read_b64_tr_b16 v[52:53], v5 offset:16384
    v_mfma_f32_16x16x32_bf16 v[104:107], v[24:27], v[40:43], v[104:107]
    ds_read_b64_tr_b16 v[54:55], v5 offset:17408
    v_mfma_f32_16x16x32_bf16 v[108:111], v[28:31], v[40:43], v[108:111]
    ds_read_b64_tr_b16 v[56:57], v6 offset:16384
    v_mfma_f32_16x16x32_bf16 v[112:115], v[32:35], v[40:43], v[112:115]
    ds_read_b64_tr_b16 v[58:59], v6 offset:17408
    v_mfma_f32_16x16x32_bf16 v[116:119], v[20:23], v[44:47], v[116:119]
    ds_read_b64_tr_b16 v[60:61], v5 offset:16640
    v_mfma_f32_16x16x32_bf16 v[120:123], v[24:27], v[44:47], v[120:123]
    ds_read_b64_tr_b16 v[62:63], v5 offset:17664
    v_mfma_f32_16x16x32_bf16 v[124:127], v[28:31], v[44:47], v[124:127]
    ds_read_b64_tr_b16 v[64:65], v6 offset:16640
    v_mfma_f32_16x16x32_bf16 v[128:131], v[32:35], v[44:47], v[128:131]
    ds_read_b64_tr_b16 v[66:67], v6 offset:17664
    v_mfma_f32_16x16x32_bf16 v[132:135], v[20:23], v[48:51], v[132:135]
    ds_read_b128 v[72:75], v11 offset:16640
    v_mfma_f32_16x16x32_bf16 v[136:139], v[24:27], v[48:51], v[136:139]
    ds_read_b128 v[76:79], v11 offset:20480
    v_mfma_f32_16x16x32_bf16 v[140:143], v[28:31], v[48:51], v[140:143]
    ds_read_b128 v[80:83], v11 offset:20736
    v_mfma_f32_16x16x32_bf16 v[144:147], v[32:35], v[48:51], v[144:147]
    s_waitcnt lgkmcnt(9)
    v_mfma_f32_16x16x32_bf16 v[84:87], v[52:55], v[68:71], v[84:87]
    s_waitcnt lgkmcnt(7)
    v_mfma_f32_16x16x32_bf16 v[88:91], v[56:59], v[68:71], v[88:91]
    s_waitcnt lgkmcnt(5)
    v_mfma_f32_16x16x32_bf16 v[92:95], v[60:63], v[68:71], v[92:95]
    s_waitcnt lgkmcnt(3)
    v_mfma_f32_16x16x32_bf16 v[96:99], v[64:67], v[68:71], v[96:99]
    s_waitcnt lgkmcnt(2)
    v_mfma_f32_16x16x32_bf16 v[100:103], v[52:55], v[72:75], v[100:103]
    v_mfma_f32_16x16x32_bf16 v[104:107], v[56:59], v[72:75], v[104:107]
    v_mfma_f32_16x16x32_bf16 v[108:111], v[60:63], v[72:75], v[108:111]
    v_mfma_f32_16x16x32_bf16 v[112:115], v[64:67], v[72:75], v[112:115]
    s_waitcnt lgkmcnt(1)
    v_mfma_f32_16x16x32_bf16 v[116:119], v[52:55], v[76:79], v[116:119]
    v_mfma_f32_16x16x32_bf16 v[120:123], v[56:59], v[76:79], v[120:123]
    v_mfma_f32_16x16x32_bf16 v[124:127], v[60:63], v[76:79], v[124:127]
    v_mfma_f32_16x16x32_bf16 v[128:131], v[64:67], v[76:79], v[128:131]
    s_waitcnt lgkmcnt(0)
    v_mfma_f32_16x16x32_bf16 v[132:135], v[52:55], v[80:83], v[132:135]
    v_mfma_f32_16x16x32_bf16 v[136:139], v[56:59], v[80:83], v[136:139]
    v_mfma_f32_16x16x32_bf16 v[140:143], v[60:63], v[80:83], v[140:143]
    v_mfma_f32_16x16x32_bf16 v[144:147], v[64:67], v[80:83], v[144:147]
    v_and_b32 v1, 15, v0
    v_lshlrev_b32 v1, 12, v1
    v_bfe_u32 v14, v0, 4, 1
    v_lshl_add_u32 v1, v14, 5, v1
    v_lshrrev_b32 v14, 5, v0
    v_lshl_add_u32 v1, v14, 4, v1
    s_lshl_b32 s28, s17, 19
    s_lshr_b32 s29, s16, 1
    s_lshl_b32 s29, s29, 18
    s_add_u32 s28, s28, s29
    s_lshl_b32 s29, s19, 11
    s_add_u32 s28, s28, s29
    s_lshl_b32 s29, s18, 8
    s_add_u32 s28, s28, s29
    s_and_b32 s29, s16, 1
    s_lshl_b32 s29, s29, 7
    s_add_u32 s28, s28, s29

    v_cvt_pk_bf16_f32 v20, v84, v85
    v_cvt_pk_bf16_f32 v21, v86, v87
    v_cvt_pk_bf16_f32 v22, v88, v89
    v_cvt_pk_bf16_f32 v23, v90, v91
    s_nop 1
    v_permlane16_swap_b32 v20, v22
    v_permlane16_swap_b32 v21, v23
    buffer_store_dwordx4 v[20:23], v1, s[4:7], s28 offen offset:0 sc0 sc1

    v_cvt_pk_bf16_f32 v24, v92, v93
    v_cvt_pk_bf16_f32 v25, v94, v95
    v_cvt_pk_bf16_f32 v26, v96, v97
    v_cvt_pk_bf16_f32 v27, v98, v99
    s_nop 1
    v_permlane16_swap_b32 v24, v26
    v_permlane16_swap_b32 v25, v27
    buffer_store_dwordx4 v[24:27], v1, s[4:7], s28 offen offset:64 sc0 sc1

    s_add_u32 s28, s28, 65536
    v_cvt_pk_bf16_f32 v28, v100, v101
    v_cvt_pk_bf16_f32 v29, v102, v103
    v_cvt_pk_bf16_f32 v30, v104, v105
    v_cvt_pk_bf16_f32 v31, v106, v107
    s_nop 1
    v_permlane16_swap_b32 v28, v30
    v_permlane16_swap_b32 v29, v31
    buffer_store_dwordx4 v[28:31], v1, s[4:7], s28 offen offset:0 sc0 sc1

    v_cvt_pk_bf16_f32 v32, v108, v109
    v_cvt_pk_bf16_f32 v33, v110, v111
    v_cvt_pk_bf16_f32 v34, v112, v113
    v_cvt_pk_bf16_f32 v35, v114, v115
    s_nop 1
    v_permlane16_swap_b32 v32, v34
    v_permlane16_swap_b32 v33, v35
    buffer_store_dwordx4 v[32:35], v1, s[4:7], s28 offen offset:64 sc0 sc1

    s_add_u32 s28, s28, 65536
    v_cvt_pk_bf16_f32 v36, v116, v117
    v_cvt_pk_bf16_f32 v37, v118, v119
    v_cvt_pk_bf16_f32 v38, v120, v121
    v_cvt_pk_bf16_f32 v39, v122, v123
    s_nop 1
    v_permlane16_swap_b32 v36, v38
    v_permlane16_swap_b32 v37, v39
    buffer_store_dwordx4 v[36:39], v1, s[4:7], s28 offen offset:0 sc0 sc1

    v_cvt_pk_bf16_f32 v40, v124, v125
    v_cvt_pk_bf16_f32 v41, v126, v127
    v_cvt_pk_bf16_f32 v42, v128, v129
    v_cvt_pk_bf16_f32 v43, v130, v131
    s_nop 1
    v_permlane16_swap_b32 v40, v42
    v_permlane16_swap_b32 v41, v43
    buffer_store_dwordx4 v[40:43], v1, s[4:7], s28 offen offset:64 sc0 sc1

    s_add_u32 s28, s28, 65536
    v_cvt_pk_bf16_f32 v44, v132, v133
    v_cvt_pk_bf16_f32 v45, v134, v135
    v_cvt_pk_bf16_f32 v46, v136, v137
    v_cvt_pk_bf16_f32 v47, v138, v139
    s_nop 1
    v_permlane16_swap_b32 v44, v46
    v_permlane16_swap_b32 v45, v47
    buffer_store_dwordx4 v[44:47], v1, s[4:7], s28 offen offset:0 sc0 sc1

    v_cvt_pk_bf16_f32 v48, v140, v141
    v_cvt_pk_bf16_f32 v49, v142, v143
    v_cvt_pk_bf16_f32 v50, v144, v145
    v_cvt_pk_bf16_f32 v51, v146, v147
    s_nop 1
    v_permlane16_swap_b32 v48, v50
    v_permlane16_swap_b32 v49, v51
    buffer_store_dwordx4 v[48:51], v1, s[4:7], s28 offen offset:64 sc0 sc1

L_oproj_kernel_end:
    s_endpgm
L_code_end:
.section .rodata,"a"
.p2align 6
.amdhsa_kernel qkv_kernel
  .amdhsa_next_free_vgpr 512
  .amdhsa_next_free_sgpr 102
  .amdhsa_accum_offset 256
  .amdhsa_group_segment_fixed_size 0
  .amdhsa_kernarg_size 72
  .amdhsa_user_sgpr_count 2
  .amdhsa_user_sgpr_kernarg_segment_ptr 1
  .amdhsa_system_sgpr_workgroup_id_x 1
.end_amdhsa_kernel
.p2align 6
.amdhsa_kernel attn_kernel
  .amdhsa_next_free_vgpr 188
  .amdhsa_next_free_sgpr 102
  .amdhsa_accum_offset 188
  .amdhsa_group_segment_fixed_size 0
  .amdhsa_kernarg_size 72
  .amdhsa_user_sgpr_count 2
  .amdhsa_user_sgpr_kernarg_segment_ptr 1
  .amdhsa_system_sgpr_workgroup_id_x 1
.end_amdhsa_kernel
.p2align 6
.amdhsa_kernel oproj_kernel
  .amdhsa_next_free_vgpr 148
  .amdhsa_next_free_sgpr 102
  .amdhsa_accum_offset 148
  .amdhsa_group_segment_fixed_size 0
  .amdhsa_kernarg_size 72
  .amdhsa_user_sgpr_count 2
  .amdhsa_user_sgpr_kernarg_segment_ptr 1
  .amdhsa_system_sgpr_workgroup_id_x 1
.end_amdhsa_kernel
```
